```python
import torch

def _softmax(x, axis=-1):
    return torch.softmax(x, dim=axis)
def _gelu(x):
    return torch.nn.functional.gelu(x, approximate="tanh")
def _silu(x):
    return torch.nn.functional.silu(x)
def _sigmoid(x):
    return torch.sigmoid(x)
def _layernorm(x, axis=-1, eps=1e-5):
    m = x.mean(dim=axis, keepdim=True)
    v = x.var(dim=axis, keepdim=True, unbiased=False)
    return (x - m) / torch.sqrt(v + eps)
def _scatter_add(tgt, idx, src, axis=0):
    return tgt.clone().index_add_(axis, idx, src)
def _segment_sum(src, seg, n):
    out = torch.zeros((n,) + src.shape[1:], dtype=src.dtype)
    return out.index_add_(0, seg, src)
def _pad(x, pw):
    flat = tuple(v for pair in reversed(pw) for v in pair)
    return torch.nn.functional.pad(x, flat)

kernel_name = 'gather_scatter__molecular_angular_gemnet__graph'

def setup_inputs():

    _w = (lambda a: (lambda t: t.to(torch.bfloat16) if t.is_floating_point() else t)(torch.as_tensor(a)))
    N, deg, De, L = 50000, 16, 16, 2
    E = N * deg
    T = E * deg
    NR = 8
    dist = torch.rand(E).to(float)
    angle = (torch.rand(T) * torch.pi).to(float)
    centers = torch.linspace(0.0, 1.0, NR).to(float)
    ang_freq = torch.arange(1, L + 1).to(float)
    return {
        "m": _w((lambda *s: torch.randn(*s, dtype=torch.bfloat16) * 0.05)(E, De)),
        "idx_in": _w((lambda lo, hi, *s: torch.randint(lo, hi, s))(0, E, T).to(torch.int64)),
        "idx_out": _w((lambda lo, hi, *s: torch.randint(lo, hi, s))(0, E, T).to(torch.int64)),
        "dist": _w(dist),
        "angle": _w(angle),
        "centers": _w(centers),
        "ang_freq": _w(ang_freq),
        "w_rbf": _w((lambda *s: torch.randn(*s, dtype=torch.bfloat16) * 0.2)(NR, De)),
        "w_sbf": _w((lambda *s: torch.randn(*s, dtype=torch.bfloat16) * 0.2)(NR * L, De)),
        "w_down": _w((lambda *s: torch.randn(*s, dtype=torch.bfloat16) * 0.2)(De, De)),
        "w_up": _w((lambda *s: torch.randn(*s, dtype=torch.bfloat16) * 0.2)(De, De)),
    }

def reference(m, idx_in, idx_out, dist, angle, centers, ang_freq, w_rbf, w_sbf, w_down, w_up):
    E, De = m.shape[0], m.shape[1]
    NR = centers.shape[0]
    L = ang_freq.shape[0]
    rbf = torch.exp(-10.0 * (dist[:, None] - centers[None, :]) ** 2)
    cbf = torch.cos(ang_freq[None, :] * angle[:, None])
    rbf_t = rbf[idx_out]
    sbf = torch.reshape(rbf_t[:, :, None] * cbf[:, None, :], (-1, NR * L))
    x = (m[idx_in] @ w_down) * (sbf @ w_sbf)
    agg = _segment_sum(x, idx_out, E)
    return m + (agg @ w_up) * (rbf @ w_rbf)
```

```asm
; @launch kernel=bin_kernel grid=(256,1,1) block=(512,1,1) lds=163840
; @launch kernel=agg_kernel grid=(256,1,1) block=(512,1,1) lds=163840
.amdgcn_target "amdgcn-amd-amdhsa--gfx950"
.text
.globl bin_kernel
.p2align 8
.type bin_kernel,@function
bin_kernel:
    s_cmp_ge_u32 s2, 256
    s_cbranch_scc1 A_end
    s_load_dwordx4 s[36:39], s[0:1], 8
    s_load_dwordx2 s[40:41], s[0:1], 32
    s_load_dwordx2 s[44:45], s[0:1], 104
    s_load_dwordx2 s[42:43], s[0:1], 0
    s_load_dwordx2 s[62:63], s[0:1], 24
    s_mul_i32 s47, s2, 50000
    s_add_u32 s49, s47, 50000
    s_and_b32 s47, s47, 0xffffffc0
    s_and_b32 s49, s49, 0xffffffc0
    s_sub_u32 s49, s49, s47
    s_lshl_b32 s46, s47, 2
    s_lshl_b32 s47, s47, 1
    s_lshl_b32 s50, s49, 2
    s_lshl_b32 s51, s49, 1
    s_mul_i32 s48, s2, 318720
    v_lshlrev_b32 v1, 4, v0
    v_lshlrev_b32 v2, 3, v0
    v_mov_b32 v3, 1
    v_mov_b32 v4, 0
    v_mov_b32 v5, 0
    v_mov_b32 v6, 0
    v_mov_b32 v7, 0
    s_waitcnt lgkmcnt(0)
    s_add_u32 s4, s36, s46
    s_addc_u32 s5, s37, 0
    s_mov_b32 s6, s50
    s_mov_b32 s7, 0x20000
    s_add_u32 s8, s38, s46
    s_addc_u32 s9, s39, 0
    s_mov_b32 s10, s50
    s_mov_b32 s11, 0x20000
    s_add_u32 s12, s40, s47
    s_addc_u32 s13, s41, 0
    s_mov_b32 s14, s51
    s_mov_b32 s15, 0x20000
    s_mov_b32 s50, 0
    s_mov_b32 s51, 0
    buffer_load_dwordx4 v[56:59], v1, s[4:7], s50 offen nt
    buffer_load_dwordx4 v[60:63], v1, s[8:11], s50 offen nt
    buffer_load_dwordx2 v[40:41], v2, s[12:15], s51 offen nt
    s_mov_b32 s50, 8192
    s_mov_b32 s51, 4096
    buffer_load_dwordx4 v[64:67], v1, s[4:7], s50 offen nt
    buffer_load_dwordx4 v[68:71], v1, s[8:11], s50 offen nt
    buffer_load_dwordx2 v[42:43], v2, s[12:15], s51 offen nt
    s_mov_b32 s50, 16384
    s_mov_b32 s51, 8192
    buffer_load_dwordx4 v[72:75], v1, s[4:7], s50 offen nt
    buffer_load_dwordx4 v[76:79], v1, s[8:11], s50 offen nt
    buffer_load_dwordx2 v[44:45], v2, s[12:15], s51 offen nt
    s_mov_b32 s50, 24576
    s_mov_b32 s51, 12288
    buffer_load_dwordx4 v[80:83], v1, s[4:7], s50 offen nt
    buffer_load_dwordx4 v[84:87], v1, s[8:11], s50 offen nt
    buffer_load_dwordx2 v[46:47], v2, s[12:15], s51 offen nt
    s_mov_b32 s50, 32768
    s_mov_b32 s51, 16384
    buffer_load_dwordx4 v[88:91], v1, s[4:7], s50 offen nt
    buffer_load_dwordx4 v[92:95], v1, s[8:11], s50 offen nt
    buffer_load_dwordx2 v[48:49], v2, s[12:15], s51 offen nt
    s_mov_b32 s50, 40960
    s_mov_b32 s51, 20480
    buffer_load_dwordx4 v[96:99], v1, s[4:7], s50 offen nt
    buffer_load_dwordx4 v[100:103], v1, s[8:11], s50 offen nt
    buffer_load_dwordx2 v[50:51], v2, s[12:15], s51 offen nt
    s_mov_b32 s50, 49152
    s_mov_b32 s51, 24576
    buffer_load_dwordx4 v[104:107], v1, s[4:7], s50 offen nt
    buffer_load_dwordx4 v[108:111], v1, s[8:11], s50 offen nt
    buffer_load_dwordx2 v[52:53], v2, s[12:15], s51 offen nt
    s_mov_b32 s50, 57344
    s_mov_b32 s51, 28672
    buffer_load_dwordx4 v[112:115], v1, s[4:7], s50 offen nt
    buffer_load_dwordx4 v[116:119], v1, s[8:11], s50 offen nt
    buffer_load_dwordx2 v[54:55], v2, s[12:15], s51 offen nt
    ds_write_b128 v1, v[4:7] offset:0
    ds_write_b128 v1, v[4:7] offset:8192
    s_add_u32 s16, s44, s48
    s_addc_u32 s17, s45, 0
    s_mov_b32 s18, 106368
    s_mov_b32 s19, 0x20000
    s_add_u32 s20, s44, 81592576
    s_addc_u32 s21, s45, 0
    s_mov_b32 s22, 3145728
    s_mov_b32 s23, 0x20000
    s_mov_b32 s64, s42
    s_mov_b32 s65, s43
    s_mov_b32 s66, 25600000
    s_mov_b32 s67, 0x20000
    s_mov_b32 s68, s62
    s_mov_b32 s69, s63
    s_mov_b32 s70, 1600000
    s_mov_b32 s71, 0x20000
    s_mov_b32 s24, 1374390
    s_mov_b32 s25, 3125
    s_mov_b32 s26, -415
    s_mov_b32 s53, 5217
    s_mov_b32 s27, 0xffff0000
    s_mov_b32 s28, 0xffff
    s_mov_b32 s29, 17728
    s_mov_b32 s33, 0x07060302
    s_sub_u32 s32, s49, 49152
    s_lshr_b32 s32, s32, 2
    v_cmp_gt_u32 s[30:31], s32, v0
    v_lshrrev_b32 v8, 6, v0
    s_waitcnt lgkmcnt(0)
    v_readfirstlane_b32 s3, v8
    v_mov_b32 v8, 61740
    s_barrier
    s_waitcnt vmcnt(21)
    v_or_b32 v12, 3, v60
    v_or_b32 v13, 3, v61
    v_or_b32 v14, 3, v62
    v_or_b32 v15, 3, v63
    v_mul_hi_u32_u24 v12, s24, v12
    v_mul_hi_u32_u24 v13, s24, v13
    v_mul_hi_u32_u24 v14, s24, v14
    v_mul_hi_u32_u24 v15, s24, v15
    v_bfe_u32 v16, v12, 3, 2
    v_bfe_u32 v17, v13, 3, 2
    v_bfe_u32 v18, v14, 3, 2
    v_bfe_u32 v19, v15, 3, 2
    v_mad_i32_i24 v20, v16, s26, v8
    v_mad_i32_i24 v21, v17, s26, v8
    v_mad_i32_i24 v22, v18, s26, v8
    v_mad_i32_i24 v23, v19, s26, v8
    v_mad_u32_u24 v16, v16, s53, v56
    v_mad_u32_u24 v17, v17, s53, v57
    v_mad_u32_u24 v18, v18, s53, v58
    v_mad_u32_u24 v19, v19, s53, v59
    v_mul_hi_u32_u24 v16, v20, v16
    v_mul_hi_u32_u24 v17, v21, v17
    v_mul_hi_u32_u24 v18, v22, v18
    v_mul_hi_u32_u24 v19, v23, v19
    v_mul_u32_u24 v20, s25, v12
    v_mul_u32_u24 v21, s25, v13
    v_mul_u32_u24 v22, s25, v14
    v_mul_u32_u24 v23, s25, v15
    v_and_b32 v20, -4, v20
    v_and_b32 v21, -4, v21
    v_and_b32 v22, -4, v22
    v_and_b32 v23, -4, v23
    v_sub_u32 v20, v60, v20
    v_sub_u32 v21, v61, v21
    v_sub_u32 v22, v62, v22
    v_sub_u32 v23, v63, v23
    v_lshl_or_b32 v16, v16, 8, v12
    v_lshl_or_b32 v17, v17, 8, v13
    v_lshl_or_b32 v18, v18, 8, v14
    v_lshl_or_b32 v19, v19, 8, v15
    v_lshlrev_b32 v16, 2, v16
    v_lshlrev_b32 v17, 2, v17
    v_lshlrev_b32 v18, 2, v18
    v_lshlrev_b32 v19, 2, v19
    v_and_b32 v12, 15, v20
    v_and_b32 v13, 15, v21
    v_and_b32 v14, 15, v22
    v_and_b32 v15, 15, v23
    ds_add_u32 v16, v3
    v_lshrrev_b32 v20, 4, v20
    v_lshl_or_b32 v12, v56, 4, v12
    ds_add_u32 v17, v3
    v_lshrrev_b32 v21, 4, v21
    v_lshl_or_b32 v13, v57, 4, v13
    ds_add_u32 v18, v3
    v_lshrrev_b32 v22, 4, v22
    v_lshl_or_b32 v14, v58, 4, v14
    ds_add_u32 v19, v3
    v_lshrrev_b32 v23, 4, v23
    v_lshl_or_b32 v15, v59, 4, v15
    v_lshl_or_b32 v56, v12, 8, v20
    v_lshl_or_b32 v57, v40, 16, v16
    v_lshl_or_b32 v58, v13, 8, v21
    v_and_or_b32 v59, v40, s27, v17
    v_lshl_or_b32 v60, v14, 8, v22
    v_lshl_or_b32 v61, v41, 16, v18
    v_lshl_or_b32 v62, v15, 8, v23
    v_and_or_b32 v63, v41, s27, v19
    s_mov_b32 s50, 65536
    s_mov_b32 s51, 32768
    buffer_load_dwordx4 v[120:123], v1, s[4:7], s50 offen nt
    buffer_load_dwordx4 v[124:127], v1, s[8:11], s50 offen nt
    buffer_load_dwordx2 v[40:41], v2, s[12:15], s51 offen nt
    s_waitcnt vmcnt(21)
    v_or_b32 v12, 3, v68
    v_or_b32 v13, 3, v69
    v_or_b32 v14, 3, v70
    v_or_b32 v15, 3, v71
    v_mul_hi_u32_u24 v12, s24, v12
    v_mul_hi_u32_u24 v13, s24, v13
    v_mul_hi_u32_u24 v14, s24, v14
    v_mul_hi_u32_u24 v15, s24, v15
    v_bfe_u32 v16, v12, 3, 2
    v_bfe_u32 v17, v13, 3, 2
    v_bfe_u32 v18, v14, 3, 2
    v_bfe_u32 v19, v15, 3, 2
    v_mad_i32_i24 v20, v16, s26, v8
    v_mad_i32_i24 v21, v17, s26, v8
    v_mad_i32_i24 v22, v18, s26, v8
    v_mad_i32_i24 v23, v19, s26, v8
    v_mad_u32_u24 v16, v16, s53, v64
    v_mad_u32_u24 v17, v17, s53, v65
    v_mad_u32_u24 v18, v18, s53, v66
    v_mad_u32_u24 v19, v19, s53, v67
    v_mul_hi_u32_u24 v16, v20, v16
    v_mul_hi_u32_u24 v17, v21, v17
    v_mul_hi_u32_u24 v18, v22, v18
    v_mul_hi_u32_u24 v19, v23, v19
    v_mul_u32_u24 v20, s25, v12
    v_mul_u32_u24 v21, s25, v13
    v_mul_u32_u24 v22, s25, v14
    v_mul_u32_u24 v23, s25, v15
    v_and_b32 v20, -4, v20
    v_and_b32 v21, -4, v21
    v_and_b32 v22, -4, v22
    v_and_b32 v23, -4, v23
    v_sub_u32 v20, v68, v20
    v_sub_u32 v21, v69, v21
    v_sub_u32 v22, v70, v22
    v_sub_u32 v23, v71, v23
    v_lshl_or_b32 v16, v16, 8, v12
    v_lshl_or_b32 v17, v17, 8, v13
    v_lshl_or_b32 v18, v18, 8, v14
    v_lshl_or_b32 v19, v19, 8, v15
    v_lshlrev_b32 v16, 2, v16
    v_lshlrev_b32 v17, 2, v17
    v_lshlrev_b32 v18, 2, v18
    v_lshlrev_b32 v19, 2, v19
    v_and_b32 v12, 15, v20
    v_and_b32 v13, 15, v21
    v_and_b32 v14, 15, v22
    v_and_b32 v15, 15, v23
    ds_add_u32 v16, v3
    v_lshrrev_b32 v20, 4, v20
    v_lshl_or_b32 v12, v64, 4, v12
    ds_add_u32 v17, v3
    v_lshrrev_b32 v21, 4, v21
    v_lshl_or_b32 v13, v65, 4, v13
    ds_add_u32 v18, v3
    v_lshrrev_b32 v22, 4, v22
    v_lshl_or_b32 v14, v66, 4, v14
    ds_add_u32 v19, v3
    v_lshrrev_b32 v23, 4, v23
    v_lshl_or_b32 v15, v67, 4, v15
    v_lshl_or_b32 v64, v12, 8, v20
    v_lshl_or_b32 v65, v42, 16, v16
    v_lshl_or_b32 v66, v13, 8, v21
    v_and_or_b32 v67, v42, s27, v17
    v_lshl_or_b32 v68, v14, 8, v22
    v_lshl_or_b32 v69, v43, 16, v18
    v_lshl_or_b32 v70, v15, 8, v23
    v_and_or_b32 v71, v43, s27, v19
    s_mov_b32 s50, 73728
    s_mov_b32 s51, 36864
    buffer_load_dwordx4 v[128:131], v1, s[4:7], s50 offen nt
    buffer_load_dwordx4 v[132:135], v1, s[8:11], s50 offen nt
    buffer_load_dwordx2 v[42:43], v2, s[12:15], s51 offen nt
    s_waitcnt vmcnt(21)
    v_or_b32 v12, 3, v76
    v_or_b32 v13, 3, v77
    v_or_b32 v14, 3, v78
    v_or_b32 v15, 3, v79
    v_mul_hi_u32_u24 v12, s24, v12
    v_mul_hi_u32_u24 v13, s24, v13
    v_mul_hi_u32_u24 v14, s24, v14
    v_mul_hi_u32_u24 v15, s24, v15
    v_bfe_u32 v16, v12, 3, 2
    v_bfe_u32 v17, v13, 3, 2
    v_bfe_u32 v18, v14, 3, 2
    v_bfe_u32 v19, v15, 3, 2
    v_mad_i32_i24 v20, v16, s26, v8
    v_mad_i32_i24 v21, v17, s26, v8
    v_mad_i32_i24 v22, v18, s26, v8
    v_mad_i32_i24 v23, v19, s26, v8
    v_mad_u32_u24 v16, v16, s53, v72
    v_mad_u32_u24 v17, v17, s53, v73
    v_mad_u32_u24 v18, v18, s53, v74
    v_mad_u32_u24 v19, v19, s53, v75
    v_mul_hi_u32_u24 v16, v20, v16
    v_mul_hi_u32_u24 v17, v21, v17
    v_mul_hi_u32_u24 v18, v22, v18
    v_mul_hi_u32_u24 v19, v23, v19
    v_mul_u32_u24 v20, s25, v12
    v_mul_u32_u24 v21, s25, v13
    v_mul_u32_u24 v22, s25, v14
    v_mul_u32_u24 v23, s25, v15
    v_and_b32 v20, -4, v20
    v_and_b32 v21, -4, v21
    v_and_b32 v22, -4, v22
    v_and_b32 v23, -4, v23
    v_sub_u32 v20, v76, v20
    v_sub_u32 v21, v77, v21
    v_sub_u32 v22, v78, v22
    v_sub_u32 v23, v79, v23
    v_lshl_or_b32 v16, v16, 8, v12
    v_lshl_or_b32 v17, v17, 8, v13
    v_lshl_or_b32 v18, v18, 8, v14
    v_lshl_or_b32 v19, v19, 8, v15
    v_lshlrev_b32 v16, 2, v16
    v_lshlrev_b32 v17, 2, v17
    v_lshlrev_b32 v18, 2, v18
    v_lshlrev_b32 v19, 2, v19
    v_and_b32 v12, 15, v20
    v_and_b32 v13, 15, v21
    v_and_b32 v14, 15, v22
    v_and_b32 v15, 15, v23
    ds_add_u32 v16, v3
    v_lshrrev_b32 v20, 4, v20
    v_lshl_or_b32 v12, v72, 4, v12
    ds_add_u32 v17, v3
    v_lshrrev_b32 v21, 4, v21
    v_lshl_or_b32 v13, v73, 4, v13
    ds_add_u32 v18, v3
    v_lshrrev_b32 v22, 4, v22
    v_lshl_or_b32 v14, v74, 4, v14
    ds_add_u32 v19, v3
    v_lshrrev_b32 v23, 4, v23
    v_lshl_or_b32 v15, v75, 4, v15
    v_lshl_or_b32 v72, v12, 8, v20
    v_lshl_or_b32 v73, v44, 16, v16
    v_lshl_or_b32 v74, v13, 8, v21
    v_and_or_b32 v75, v44, s27, v17
    v_lshl_or_b32 v76, v14, 8, v22
    v_lshl_or_b32 v77, v45, 16, v18
    v_lshl_or_b32 v78, v15, 8, v23
    v_and_or_b32 v79, v45, s27, v19
    s_mov_b32 s50, 81920
    s_mov_b32 s51, 40960
    buffer_load_dwordx4 v[136:139], v1, s[4:7], s50 offen nt
    buffer_load_dwordx4 v[140:143], v1, s[8:11], s50 offen nt
    buffer_load_dwordx2 v[44:45], v2, s[12:15], s51 offen nt
    s_waitcnt vmcnt(21)
    v_or_b32 v12, 3, v84
    v_or_b32 v13, 3, v85
    v_or_b32 v14, 3, v86
    v_or_b32 v15, 3, v87
    v_mul_hi_u32_u24 v12, s24, v12
    v_mul_hi_u32_u24 v13, s24, v13
    v_mul_hi_u32_u24 v14, s24, v14
    v_mul_hi_u32_u24 v15, s24, v15
    v_bfe_u32 v16, v12, 3, 2
    v_bfe_u32 v17, v13, 3, 2
    v_bfe_u32 v18, v14, 3, 2
    v_bfe_u32 v19, v15, 3, 2
    v_mad_i32_i24 v20, v16, s26, v8
    v_mad_i32_i24 v21, v17, s26, v8
    v_mad_i32_i24 v22, v18, s26, v8
    v_mad_i32_i24 v23, v19, s26, v8
    v_mad_u32_u24 v16, v16, s53, v80
    v_mad_u32_u24 v17, v17, s53, v81
    v_mad_u32_u24 v18, v18, s53, v82
    v_mad_u32_u24 v19, v19, s53, v83
    v_mul_hi_u32_u24 v16, v20, v16
    v_mul_hi_u32_u24 v17, v21, v17
    v_mul_hi_u32_u24 v18, v22, v18
    v_mul_hi_u32_u24 v19, v23, v19
    v_mul_u32_u24 v20, s25, v12
    v_mul_u32_u24 v21, s25, v13
    v_mul_u32_u24 v22, s25, v14
    v_mul_u32_u24 v23, s25, v15
    v_and_b32 v20, -4, v20
    v_and_b32 v21, -4, v21
    v_and_b32 v22, -4, v22
    v_and_b32 v23, -4, v23
    v_sub_u32 v20, v84, v20
    v_sub_u32 v21, v85, v21
    v_sub_u32 v22, v86, v22
    v_sub_u32 v23, v87, v23
    v_lshl_or_b32 v16, v16, 8, v12
    v_lshl_or_b32 v17, v17, 8, v13
    v_lshl_or_b32 v18, v18, 8, v14
    v_lshl_or_b32 v19, v19, 8, v15
    v_lshlrev_b32 v16, 2, v16
    v_lshlrev_b32 v17, 2, v17
    v_lshlrev_b32 v18, 2, v18
    v_lshlrev_b32 v19, 2, v19
    v_and_b32 v12, 15, v20
    v_and_b32 v13, 15, v21
    v_and_b32 v14, 15, v22
    v_and_b32 v15, 15, v23
    ds_add_u32 v16, v3
    v_lshrrev_b32 v20, 4, v20
    v_lshl_or_b32 v12, v80, 4, v12
    ds_add_u32 v17, v3
    v_lshrrev_b32 v21, 4, v21
    v_lshl_or_b32 v13, v81, 4, v13
    ds_add_u32 v18, v3
    v_lshrrev_b32 v22, 4, v22
    v_lshl_or_b32 v14, v82, 4, v14
    ds_add_u32 v19, v3
    v_lshrrev_b32 v23, 4, v23
    v_lshl_or_b32 v15, v83, 4, v15
    v_lshl_or_b32 v80, v12, 8, v20
    v_lshl_or_b32 v81, v46, 16, v16
    v_lshl_or_b32 v82, v13, 8, v21
    v_and_or_b32 v83, v46, s27, v17
    v_lshl_or_b32 v84, v14, 8, v22
    v_lshl_or_b32 v85, v47, 16, v18
    v_lshl_or_b32 v86, v15, 8, v23
    v_and_or_b32 v87, v47, s27, v19
    s_mov_b32 s50, 90112
    s_mov_b32 s51, 45056
    buffer_load_dwordx4 v[144:147], v1, s[4:7], s50 offen nt
    buffer_load_dwordx4 v[148:151], v1, s[8:11], s50 offen nt
    buffer_load_dwordx2 v[46:47], v2, s[12:15], s51 offen nt
    s_waitcnt vmcnt(21)
    v_or_b32 v12, 3, v92
    v_or_b32 v13, 3, v93
    v_or_b32 v14, 3, v94
    v_or_b32 v15, 3, v95
    v_mul_hi_u32_u24 v12, s24, v12
    v_mul_hi_u32_u24 v13, s24, v13
    v_mul_hi_u32_u24 v14, s24, v14
    v_mul_hi_u32_u24 v15, s24, v15
    v_bfe_u32 v16, v12, 3, 2
    v_bfe_u32 v17, v13, 3, 2
    v_bfe_u32 v18, v14, 3, 2
    v_bfe_u32 v19, v15, 3, 2
    v_mad_i32_i24 v20, v16, s26, v8
    v_mad_i32_i24 v21, v17, s26, v8
    v_mad_i32_i24 v22, v18, s26, v8
    v_mad_i32_i24 v23, v19, s26, v8
    v_mad_u32_u24 v16, v16, s53, v88
    v_mad_u32_u24 v17, v17, s53, v89
    v_mad_u32_u24 v18, v18, s53, v90
    v_mad_u32_u24 v19, v19, s53, v91
    v_mul_hi_u32_u24 v16, v20, v16
    v_mul_hi_u32_u24 v17, v21, v17
    v_mul_hi_u32_u24 v18, v22, v18
    v_mul_hi_u32_u24 v19, v23, v19
    v_mul_u32_u24 v20, s25, v12
    v_mul_u32_u24 v21, s25, v13
    v_mul_u32_u24 v22, s25, v14
    v_mul_u32_u24 v23, s25, v15
    v_and_b32 v20, -4, v20
    v_and_b32 v21, -4, v21
    v_and_b32 v22, -4, v22
    v_and_b32 v23, -4, v23
    v_sub_u32 v20, v92, v20
    v_sub_u32 v21, v93, v21
    v_sub_u32 v22, v94, v22
    v_sub_u32 v23, v95, v23
    v_lshl_or_b32 v16, v16, 8, v12
    v_lshl_or_b32 v17, v17, 8, v13
    v_lshl_or_b32 v18, v18, 8, v14
    v_lshl_or_b32 v19, v19, 8, v15
    v_lshlrev_b32 v16, 2, v16
    v_lshlrev_b32 v17, 2, v17
    v_lshlrev_b32 v18, 2, v18
    v_lshlrev_b32 v19, 2, v19
    v_and_b32 v12, 15, v20
    v_and_b32 v13, 15, v21
    v_and_b32 v14, 15, v22
    v_and_b32 v15, 15, v23
    ds_add_u32 v16, v3
    v_lshrrev_b32 v20, 4, v20
    v_lshl_or_b32 v12, v88, 4, v12
    ds_add_u32 v17, v3
    v_lshrrev_b32 v21, 4, v21
    v_lshl_or_b32 v13, v89, 4, v13
    ds_add_u32 v18, v3
    v_lshrrev_b32 v22, 4, v22
    v_lshl_or_b32 v14, v90, 4, v14
    ds_add_u32 v19, v3
    v_lshrrev_b32 v23, 4, v23
    v_lshl_or_b32 v15, v91, 4, v15
    v_lshl_or_b32 v88, v12, 8, v20
    v_lshl_or_b32 v89, v48, 16, v16
    v_lshl_or_b32 v90, v13, 8, v21
    v_and_or_b32 v91, v48, s27, v17
    v_lshl_or_b32 v92, v14, 8, v22
    v_lshl_or_b32 v93, v49, 16, v18
    v_lshl_or_b32 v94, v15, 8, v23
    v_and_or_b32 v95, v49, s27, v19
    s_mov_b32 s50, 98304
    s_mov_b32 s51, 49152
    buffer_load_dwordx4 v[152:155], v1, s[4:7], s50 offen nt
    buffer_load_dwordx4 v[156:159], v1, s[8:11], s50 offen nt
    buffer_load_dwordx2 v[48:49], v2, s[12:15], s51 offen nt
    s_waitcnt vmcnt(21)
    v_or_b32 v12, 3, v100
    v_or_b32 v13, 3, v101
    v_or_b32 v14, 3, v102
    v_or_b32 v15, 3, v103
    v_mul_hi_u32_u24 v12, s24, v12
    v_mul_hi_u32_u24 v13, s24, v13
    v_mul_hi_u32_u24 v14, s24, v14
    v_mul_hi_u32_u24 v15, s24, v15
    v_bfe_u32 v16, v12, 3, 2
    v_bfe_u32 v17, v13, 3, 2
    v_bfe_u32 v18, v14, 3, 2
    v_bfe_u32 v19, v15, 3, 2
    v_mad_i32_i24 v20, v16, s26, v8
    v_mad_i32_i24 v21, v17, s26, v8
    v_mad_i32_i24 v22, v18, s26, v8
    v_mad_i32_i24 v23, v19, s26, v8
    v_mad_u32_u24 v16, v16, s53, v96
    v_mad_u32_u24 v17, v17, s53, v97
    v_mad_u32_u24 v18, v18, s53, v98
    v_mad_u32_u24 v19, v19, s53, v99
    v_mul_hi_u32_u24 v16, v20, v16
    v_mul_hi_u32_u24 v17, v21, v17
    v_mul_hi_u32_u24 v18, v22, v18
    v_mul_hi_u32_u24 v19, v23, v19
    v_mul_u32_u24 v20, s25, v12
    v_mul_u32_u24 v21, s25, v13
    v_mul_u32_u24 v22, s25, v14
    v_mul_u32_u24 v23, s25, v15
    v_and_b32 v20, -4, v20
    v_and_b32 v21, -4, v21
    v_and_b32 v22, -4, v22
    v_and_b32 v23, -4, v23
    v_sub_u32 v20, v100, v20
    v_sub_u32 v21, v101, v21
    v_sub_u32 v22, v102, v22
    v_sub_u32 v23, v103, v23
    v_lshl_or_b32 v16, v16, 8, v12
    v_lshl_or_b32 v17, v17, 8, v13
    v_lshl_or_b32 v18, v18, 8, v14
    v_lshl_or_b32 v19, v19, 8, v15
    v_lshlrev_b32 v16, 2, v16
    v_lshlrev_b32 v17, 2, v17
    v_lshlrev_b32 v18, 2, v18
    v_lshlrev_b32 v19, 2, v19
    v_and_b32 v12, 15, v20
    v_and_b32 v13, 15, v21
    v_and_b32 v14, 15, v22
    v_and_b32 v15, 15, v23
    ds_add_u32 v16, v3
    v_lshrrev_b32 v20, 4, v20
    v_lshl_or_b32 v12, v96, 4, v12
    ds_add_u32 v17, v3
    v_lshrrev_b32 v21, 4, v21
    v_lshl_or_b32 v13, v97, 4, v13
    ds_add_u32 v18, v3
    v_lshrrev_b32 v22, 4, v22
    v_lshl_or_b32 v14, v98, 4, v14
    ds_add_u32 v19, v3
    v_lshrrev_b32 v23, 4, v23
    v_lshl_or_b32 v15, v99, 4, v15
    v_lshl_or_b32 v96, v12, 8, v20
    v_lshl_or_b32 v97, v50, 16, v16
    v_lshl_or_b32 v98, v13, 8, v21
    v_and_or_b32 v99, v50, s27, v17
    v_lshl_or_b32 v100, v14, 8, v22
    v_lshl_or_b32 v101, v51, 16, v18
    v_lshl_or_b32 v102, v15, 8, v23
    v_and_or_b32 v103, v51, s27, v19
    s_mov_b32 s50, 106496
    s_mov_b32 s51, 53248
    buffer_load_dwordx4 v[160:163], v1, s[4:7], s50 offen nt
    buffer_load_dwordx4 v[164:167], v1, s[8:11], s50 offen nt
    buffer_load_dwordx2 v[50:51], v2, s[12:15], s51 offen nt
    s_waitcnt vmcnt(21)
    v_or_b32 v12, 3, v108
    v_or_b32 v13, 3, v109
    v_or_b32 v14, 3, v110
    v_or_b32 v15, 3, v111
    v_mul_hi_u32_u24 v12, s24, v12
    v_mul_hi_u32_u24 v13, s24, v13
    v_mul_hi_u32_u24 v14, s24, v14
    v_mul_hi_u32_u24 v15, s24, v15
    v_bfe_u32 v16, v12, 3, 2
    v_bfe_u32 v17, v13, 3, 2
    v_bfe_u32 v18, v14, 3, 2
    v_bfe_u32 v19, v15, 3, 2
    v_mad_i32_i24 v20, v16, s26, v8
    v_mad_i32_i24 v21, v17, s26, v8
    v_mad_i32_i24 v22, v18, s26, v8
    v_mad_i32_i24 v23, v19, s26, v8
    v_mad_u32_u24 v16, v16, s53, v104
    v_mad_u32_u24 v17, v17, s53, v105
    v_mad_u32_u24 v18, v18, s53, v106
    v_mad_u32_u24 v19, v19, s53, v107
    v_mul_hi_u32_u24 v16, v20, v16
    v_mul_hi_u32_u24 v17, v21, v17
    v_mul_hi_u32_u24 v18, v22, v18
    v_mul_hi_u32_u24 v19, v23, v19
    v_mul_u32_u24 v20, s25, v12
    v_mul_u32_u24 v21, s25, v13
    v_mul_u32_u24 v22, s25, v14
    v_mul_u32_u24 v23, s25, v15
    v_and_b32 v20, -4, v20
    v_and_b32 v21, -4, v21
    v_and_b32 v22, -4, v22
    v_and_b32 v23, -4, v23
    v_sub_u32 v20, v108, v20
    v_sub_u32 v21, v109, v21
    v_sub_u32 v22, v110, v22
    v_sub_u32 v23, v111, v23
    v_lshl_or_b32 v16, v16, 8, v12
    v_lshl_or_b32 v17, v17, 8, v13
    v_lshl_or_b32 v18, v18, 8, v14
    v_lshl_or_b32 v19, v19, 8, v15
    v_lshlrev_b32 v16, 2, v16
    v_lshlrev_b32 v17, 2, v17
    v_lshlrev_b32 v18, 2, v18
    v_lshlrev_b32 v19, 2, v19
    v_and_b32 v12, 15, v20
    v_and_b32 v13, 15, v21
    v_and_b32 v14, 15, v22
    v_and_b32 v15, 15, v23
    ds_add_u32 v16, v3
    v_lshrrev_b32 v20, 4, v20
    v_lshl_or_b32 v12, v104, 4, v12
    ds_add_u32 v17, v3
    v_lshrrev_b32 v21, 4, v21
    v_lshl_or_b32 v13, v105, 4, v13
    ds_add_u32 v18, v3
    v_lshrrev_b32 v22, 4, v22
    v_lshl_or_b32 v14, v106, 4, v14
    ds_add_u32 v19, v3
    v_lshrrev_b32 v23, 4, v23
    v_lshl_or_b32 v15, v107, 4, v15
    v_lshl_or_b32 v104, v12, 8, v20
    v_lshl_or_b32 v105, v52, 16, v16
    v_lshl_or_b32 v106, v13, 8, v21
    v_and_or_b32 v107, v52, s27, v17
    v_lshl_or_b32 v108, v14, 8, v22
    v_lshl_or_b32 v109, v53, 16, v18
    v_lshl_or_b32 v110, v15, 8, v23
    v_and_or_b32 v111, v53, s27, v19
    s_mov_b32 s50, 114688
    s_mov_b32 s51, 57344
    buffer_load_dwordx4 v[168:171], v1, s[4:7], s50 offen nt
    buffer_load_dwordx4 v[172:175], v1, s[8:11], s50 offen nt
    buffer_load_dwordx2 v[52:53], v2, s[12:15], s51 offen nt
    s_waitcnt vmcnt(21)
    v_or_b32 v12, 3, v116
    v_or_b32 v13, 3, v117
    v_or_b32 v14, 3, v118
    v_or_b32 v15, 3, v119
    v_mul_hi_u32_u24 v12, s24, v12
    v_mul_hi_u32_u24 v13, s24, v13
    v_mul_hi_u32_u24 v14, s24, v14
    v_mul_hi_u32_u24 v15, s24, v15
    v_bfe_u32 v16, v12, 3, 2
    v_bfe_u32 v17, v13, 3, 2
    v_bfe_u32 v18, v14, 3, 2
    v_bfe_u32 v19, v15, 3, 2
    v_mad_i32_i24 v20, v16, s26, v8
    v_mad_i32_i24 v21, v17, s26, v8
    v_mad_i32_i24 v22, v18, s26, v8
    v_mad_i32_i24 v23, v19, s26, v8
    v_mad_u32_u24 v16, v16, s53, v112
    v_mad_u32_u24 v17, v17, s53, v113
    v_mad_u32_u24 v18, v18, s53, v114
    v_mad_u32_u24 v19, v19, s53, v115
    v_mul_hi_u32_u24 v16, v20, v16
    v_mul_hi_u32_u24 v17, v21, v17
    v_mul_hi_u32_u24 v18, v22, v18
    v_mul_hi_u32_u24 v19, v23, v19
    v_mul_u32_u24 v20, s25, v12
    v_mul_u32_u24 v21, s25, v13
    v_mul_u32_u24 v22, s25, v14
    v_mul_u32_u24 v23, s25, v15
    v_and_b32 v20, -4, v20
    v_and_b32 v21, -4, v21
    v_and_b32 v22, -4, v22
    v_and_b32 v23, -4, v23
    v_sub_u32 v20, v116, v20
    v_sub_u32 v21, v117, v21
    v_sub_u32 v22, v118, v22
    v_sub_u32 v23, v119, v23
    v_lshl_or_b32 v16, v16, 8, v12
    v_lshl_or_b32 v17, v17, 8, v13
    v_lshl_or_b32 v18, v18, 8, v14
    v_lshl_or_b32 v19, v19, 8, v15
    v_lshlrev_b32 v16, 2, v16
    v_lshlrev_b32 v17, 2, v17
    v_lshlrev_b32 v18, 2, v18
    v_lshlrev_b32 v19, 2, v19
    v_and_b32 v12, 15, v20
    v_and_b32 v13, 15, v21
    v_and_b32 v14, 15, v22
    v_and_b32 v15, 15, v23
    ds_add_u32 v16, v3
    v_lshrrev_b32 v20, 4, v20
    v_lshl_or_b32 v12, v112, 4, v12
    ds_add_u32 v17, v3
    v_lshrrev_b32 v21, 4, v21
    v_lshl_or_b32 v13, v113, 4, v13
    ds_add_u32 v18, v3
    v_lshrrev_b32 v22, 4, v22
    v_lshl_or_b32 v14, v114, 4, v14
    ds_add_u32 v19, v3
    v_lshrrev_b32 v23, 4, v23
    v_lshl_or_b32 v15, v115, 4, v15
    v_lshl_or_b32 v112, v12, 8, v20
    v_lshl_or_b32 v113, v54, 16, v16
    v_lshl_or_b32 v114, v13, 8, v21
    v_and_or_b32 v115, v54, s27, v17
    v_lshl_or_b32 v116, v14, 8, v22
    v_lshl_or_b32 v117, v55, 16, v18
    v_lshl_or_b32 v118, v15, 8, v23
    v_and_or_b32 v119, v55, s27, v19
    s_mov_b32 s50, 122880
    s_mov_b32 s51, 61440
    buffer_load_dwordx4 v[176:179], v1, s[4:7], s50 offen nt
    buffer_load_dwordx4 v[180:183], v1, s[8:11], s50 offen nt
    buffer_load_dwordx2 v[54:55], v2, s[12:15], s51 offen nt
    s_waitcnt vmcnt(21)
    v_or_b32 v12, 3, v124
    v_or_b32 v13, 3, v125
    v_or_b32 v14, 3, v126
    v_or_b32 v15, 3, v127
    v_mul_hi_u32_u24 v12, s24, v12
    v_mul_hi_u32_u24 v13, s24, v13
    v_mul_hi_u32_u24 v14, s24, v14
    v_mul_hi_u32_u24 v15, s24, v15
    v_bfe_u32 v16, v12, 3, 2
    v_bfe_u32 v17, v13, 3, 2
    v_bfe_u32 v18, v14, 3, 2
    v_bfe_u32 v19, v15, 3, 2
    v_mad_i32_i24 v20, v16, s26, v8
    v_mad_i32_i24 v21, v17, s26, v8
    v_mad_i32_i24 v22, v18, s26, v8
    v_mad_i32_i24 v23, v19, s26, v8
    v_mad_u32_u24 v16, v16, s53, v120
    v_mad_u32_u24 v17, v17, s53, v121
    v_mad_u32_u24 v18, v18, s53, v122
    v_mad_u32_u24 v19, v19, s53, v123
    v_mul_hi_u32_u24 v16, v20, v16
    v_mul_hi_u32_u24 v17, v21, v17
    v_mul_hi_u32_u24 v18, v22, v18
    v_mul_hi_u32_u24 v19, v23, v19
    v_mul_u32_u24 v20, s25, v12
    v_mul_u32_u24 v21, s25, v13
    v_mul_u32_u24 v22, s25, v14
    v_mul_u32_u24 v23, s25, v15
    v_and_b32 v20, -4, v20
    v_and_b32 v21, -4, v21
    v_and_b32 v22, -4, v22
    v_and_b32 v23, -4, v23
    v_sub_u32 v20, v124, v20
    v_sub_u32 v21, v125, v21
    v_sub_u32 v22, v126, v22
    v_sub_u32 v23, v127, v23
    v_lshl_or_b32 v16, v16, 8, v12
    v_lshl_or_b32 v17, v17, 8, v13
    v_lshl_or_b32 v18, v18, 8, v14
    v_lshl_or_b32 v19, v19, 8, v15
    v_lshlrev_b32 v16, 2, v16
    v_lshlrev_b32 v17, 2, v17
    v_lshlrev_b32 v18, 2, v18
    v_lshlrev_b32 v19, 2, v19
    v_and_b32 v12, 15, v20
    v_and_b32 v13, 15, v21
    v_and_b32 v14, 15, v22
    v_and_b32 v15, 15, v23
    ds_add_u32 v16, v3
    v_lshrrev_b32 v20, 4, v20
    v_lshl_or_b32 v12, v120, 4, v12
    ds_add_u32 v17, v3
    v_lshrrev_b32 v21, 4, v21
    v_lshl_or_b32 v13, v121, 4, v13
    ds_add_u32 v18, v3
    v_lshrrev_b32 v22, 4, v22
    v_lshl_or_b32 v14, v122, 4, v14
    ds_add_u32 v19, v3
    v_lshrrev_b32 v23, 4, v23
    v_lshl_or_b32 v15, v123, 4, v15
    v_lshl_or_b32 v120, v12, 8, v20
    v_lshl_or_b32 v121, v40, 16, v16
    v_lshl_or_b32 v122, v13, 8, v21
    v_and_or_b32 v123, v40, s27, v17
    v_lshl_or_b32 v124, v14, 8, v22
    v_lshl_or_b32 v125, v41, 16, v18
    v_lshl_or_b32 v126, v15, 8, v23
    v_and_or_b32 v127, v41, s27, v19
    s_mov_b32 s50, 131072
    s_mov_b32 s51, 65536
    buffer_load_dwordx4 v[184:187], v1, s[4:7], s50 offen nt
    buffer_load_dwordx4 v[188:191], v1, s[8:11], s50 offen nt
    buffer_load_dwordx2 v[40:41], v2, s[12:15], s51 offen nt
    s_waitcnt vmcnt(21)
    v_or_b32 v12, 3, v132
    v_or_b32 v13, 3, v133
    v_or_b32 v14, 3, v134
    v_or_b32 v15, 3, v135
    v_mul_hi_u32_u24 v12, s24, v12
    v_mul_hi_u32_u24 v13, s24, v13
    v_mul_hi_u32_u24 v14, s24, v14
    v_mul_hi_u32_u24 v15, s24, v15
    v_bfe_u32 v16, v12, 3, 2
    v_bfe_u32 v17, v13, 3, 2
    v_bfe_u32 v18, v14, 3, 2
    v_bfe_u32 v19, v15, 3, 2
    v_mad_i32_i24 v20, v16, s26, v8
    v_mad_i32_i24 v21, v17, s26, v8
    v_mad_i32_i24 v22, v18, s26, v8
    v_mad_i32_i24 v23, v19, s26, v8
    v_mad_u32_u24 v16, v16, s53, v128
    v_mad_u32_u24 v17, v17, s53, v129
    v_mad_u32_u24 v18, v18, s53, v130
    v_mad_u32_u24 v19, v19, s53, v131
    v_mul_hi_u32_u24 v16, v20, v16
    v_mul_hi_u32_u24 v17, v21, v17
    v_mul_hi_u32_u24 v18, v22, v18
    v_mul_hi_u32_u24 v19, v23, v19
    v_mul_u32_u24 v20, s25, v12
    v_mul_u32_u24 v21, s25, v13
    v_mul_u32_u24 v22, s25, v14
    v_mul_u32_u24 v23, s25, v15
    v_and_b32 v20, -4, v20
    v_and_b32 v21, -4, v21
    v_and_b32 v22, -4, v22
    v_and_b32 v23, -4, v23
    v_sub_u32 v20, v132, v20
    v_sub_u32 v21, v133, v21
    v_sub_u32 v22, v134, v22
    v_sub_u32 v23, v135, v23
    v_lshl_or_b32 v16, v16, 8, v12
    v_lshl_or_b32 v17, v17, 8, v13
    v_lshl_or_b32 v18, v18, 8, v14
    v_lshl_or_b32 v19, v19, 8, v15
    v_lshlrev_b32 v16, 2, v16
    v_lshlrev_b32 v17, 2, v17
    v_lshlrev_b32 v18, 2, v18
    v_lshlrev_b32 v19, 2, v19
    v_and_b32 v12, 15, v20
    v_and_b32 v13, 15, v21
    v_and_b32 v14, 15, v22
    v_and_b32 v15, 15, v23
    ds_add_u32 v16, v3
    v_lshrrev_b32 v20, 4, v20
    v_lshl_or_b32 v12, v128, 4, v12
    ds_add_u32 v17, v3
    v_lshrrev_b32 v21, 4, v21
    v_lshl_or_b32 v13, v129, 4, v13
    ds_add_u32 v18, v3
    v_lshrrev_b32 v22, 4, v22
    v_lshl_or_b32 v14, v130, 4, v14
    ds_add_u32 v19, v3
    v_lshrrev_b32 v23, 4, v23
    v_lshl_or_b32 v15, v131, 4, v15
    v_lshl_or_b32 v128, v12, 8, v20
    v_lshl_or_b32 v129, v42, 16, v16
    v_lshl_or_b32 v130, v13, 8, v21
    v_and_or_b32 v131, v42, s27, v17
    v_lshl_or_b32 v132, v14, 8, v22
    v_lshl_or_b32 v133, v43, 16, v18
    v_lshl_or_b32 v134, v15, 8, v23
    v_and_or_b32 v135, v43, s27, v19
    s_mov_b32 s50, 139264
    s_mov_b32 s51, 69632
    buffer_load_dwordx4 v[192:195], v1, s[4:7], s50 offen nt
    buffer_load_dwordx4 v[196:199], v1, s[8:11], s50 offen nt
    buffer_load_dwordx2 v[42:43], v2, s[12:15], s51 offen nt
    s_waitcnt vmcnt(21)
    v_or_b32 v12, 3, v140
    v_or_b32 v13, 3, v141
    v_or_b32 v14, 3, v142
    v_or_b32 v15, 3, v143
    v_mul_hi_u32_u24 v12, s24, v12
    v_mul_hi_u32_u24 v13, s24, v13
    v_mul_hi_u32_u24 v14, s24, v14
    v_mul_hi_u32_u24 v15, s24, v15
    v_bfe_u32 v16, v12, 3, 2
    v_bfe_u32 v17, v13, 3, 2
    v_bfe_u32 v18, v14, 3, 2
    v_bfe_u32 v19, v15, 3, 2
    v_mad_i32_i24 v20, v16, s26, v8
    v_mad_i32_i24 v21, v17, s26, v8
    v_mad_i32_i24 v22, v18, s26, v8
    v_mad_i32_i24 v23, v19, s26, v8
    v_mad_u32_u24 v16, v16, s53, v136
    v_mad_u32_u24 v17, v17, s53, v137
    v_mad_u32_u24 v18, v18, s53, v138
    v_mad_u32_u24 v19, v19, s53, v139
    v_mul_hi_u32_u24 v16, v20, v16
    v_mul_hi_u32_u24 v17, v21, v17
    v_mul_hi_u32_u24 v18, v22, v18
    v_mul_hi_u32_u24 v19, v23, v19
    v_mul_u32_u24 v20, s25, v12
    v_mul_u32_u24 v21, s25, v13
    v_mul_u32_u24 v22, s25, v14
    v_mul_u32_u24 v23, s25, v15
    v_and_b32 v20, -4, v20
    v_and_b32 v21, -4, v21
    v_and_b32 v22, -4, v22
    v_and_b32 v23, -4, v23
    v_sub_u32 v20, v140, v20
    v_sub_u32 v21, v141, v21
    v_sub_u32 v22, v142, v22
    v_sub_u32 v23, v143, v23
    v_lshl_or_b32 v16, v16, 8, v12
    v_lshl_or_b32 v17, v17, 8, v13
    v_lshl_or_b32 v18, v18, 8, v14
    v_lshl_or_b32 v19, v19, 8, v15
    v_lshlrev_b32 v16, 2, v16
    v_lshlrev_b32 v17, 2, v17
    v_lshlrev_b32 v18, 2, v18
    v_lshlrev_b32 v19, 2, v19
    v_and_b32 v12, 15, v20
    v_and_b32 v13, 15, v21
    v_and_b32 v14, 15, v22
    v_and_b32 v15, 15, v23
    ds_add_u32 v16, v3
    v_lshrrev_b32 v20, 4, v20
    v_lshl_or_b32 v12, v136, 4, v12
    ds_add_u32 v17, v3
    v_lshrrev_b32 v21, 4, v21
    v_lshl_or_b32 v13, v137, 4, v13
    ds_add_u32 v18, v3
    v_lshrrev_b32 v22, 4, v22
    v_lshl_or_b32 v14, v138, 4, v14
    ds_add_u32 v19, v3
    v_lshrrev_b32 v23, 4, v23
    v_lshl_or_b32 v15, v139, 4, v15
    v_lshl_or_b32 v136, v12, 8, v20
    v_lshl_or_b32 v137, v44, 16, v16
    v_lshl_or_b32 v138, v13, 8, v21
    v_and_or_b32 v139, v44, s27, v17
    v_lshl_or_b32 v140, v14, 8, v22
    v_lshl_or_b32 v141, v45, 16, v18
    v_lshl_or_b32 v142, v15, 8, v23
    v_and_or_b32 v143, v45, s27, v19
    s_mov_b32 s50, 147456
    s_mov_b32 s51, 73728
    buffer_load_dwordx4 v[200:203], v1, s[4:7], s50 offen nt
    buffer_load_dwordx4 v[204:207], v1, s[8:11], s50 offen nt
    buffer_load_dwordx2 v[44:45], v2, s[12:15], s51 offen nt
    s_waitcnt vmcnt(21)
    v_or_b32 v12, 3, v148
    v_or_b32 v13, 3, v149
    v_or_b32 v14, 3, v150
    v_or_b32 v15, 3, v151
    v_mul_hi_u32_u24 v12, s24, v12
    v_mul_hi_u32_u24 v13, s24, v13
    v_mul_hi_u32_u24 v14, s24, v14
    v_mul_hi_u32_u24 v15, s24, v15
    v_bfe_u32 v16, v12, 3, 2
    v_bfe_u32 v17, v13, 3, 2
    v_bfe_u32 v18, v14, 3, 2
    v_bfe_u32 v19, v15, 3, 2
    v_mad_i32_i24 v20, v16, s26, v8
    v_mad_i32_i24 v21, v17, s26, v8
    v_mad_i32_i24 v22, v18, s26, v8
    v_mad_i32_i24 v23, v19, s26, v8
    v_mad_u32_u24 v16, v16, s53, v144
    v_mad_u32_u24 v17, v17, s53, v145
    v_mad_u32_u24 v18, v18, s53, v146
    v_mad_u32_u24 v19, v19, s53, v147
    v_mul_hi_u32_u24 v16, v20, v16
    v_mul_hi_u32_u24 v17, v21, v17
    v_mul_hi_u32_u24 v18, v22, v18
    v_mul_hi_u32_u24 v19, v23, v19
    v_mul_u32_u24 v20, s25, v12
    v_mul_u32_u24 v21, s25, v13
    v_mul_u32_u24 v22, s25, v14
    v_mul_u32_u24 v23, s25, v15
    v_and_b32 v20, -4, v20
    v_and_b32 v21, -4, v21
    v_and_b32 v22, -4, v22
    v_and_b32 v23, -4, v23
    v_sub_u32 v20, v148, v20
    v_sub_u32 v21, v149, v21
    v_sub_u32 v22, v150, v22
    v_sub_u32 v23, v151, v23
    v_lshl_or_b32 v16, v16, 8, v12
    v_lshl_or_b32 v17, v17, 8, v13
    v_lshl_or_b32 v18, v18, 8, v14
    v_lshl_or_b32 v19, v19, 8, v15
    v_lshlrev_b32 v16, 2, v16
    v_lshlrev_b32 v17, 2, v17
    v_lshlrev_b32 v18, 2, v18
    v_lshlrev_b32 v19, 2, v19
    v_and_b32 v12, 15, v20
    v_and_b32 v13, 15, v21
    v_and_b32 v14, 15, v22
    v_and_b32 v15, 15, v23
    ds_add_u32 v16, v3
    v_lshrrev_b32 v20, 4, v20
    v_lshl_or_b32 v12, v144, 4, v12
    ds_add_u32 v17, v3
    v_lshrrev_b32 v21, 4, v21
    v_lshl_or_b32 v13, v145, 4, v13
    ds_add_u32 v18, v3
    v_lshrrev_b32 v22, 4, v22
    v_lshl_or_b32 v14, v146, 4, v14
    ds_add_u32 v19, v3
    v_lshrrev_b32 v23, 4, v23
    v_lshl_or_b32 v15, v147, 4, v15
    v_lshl_or_b32 v144, v12, 8, v20
    v_lshl_or_b32 v145, v46, 16, v16
    v_lshl_or_b32 v146, v13, 8, v21
    v_and_or_b32 v147, v46, s27, v17
    v_lshl_or_b32 v148, v14, 8, v22
    v_lshl_or_b32 v149, v47, 16, v18
    v_lshl_or_b32 v150, v15, 8, v23
    v_and_or_b32 v151, v47, s27, v19
    s_mov_b32 s50, 155648
    s_mov_b32 s51, 77824
    buffer_load_dwordx4 v[208:211], v1, s[4:7], s50 offen nt
    buffer_load_dwordx4 v[212:215], v1, s[8:11], s50 offen nt
    buffer_load_dwordx2 v[46:47], v2, s[12:15], s51 offen nt
    s_waitcnt vmcnt(21)
    v_or_b32 v12, 3, v156
    v_or_b32 v13, 3, v157
    v_or_b32 v14, 3, v158
    v_or_b32 v15, 3, v159
    v_mul_hi_u32_u24 v12, s24, v12
    v_mul_hi_u32_u24 v13, s24, v13
    v_mul_hi_u32_u24 v14, s24, v14
    v_mul_hi_u32_u24 v15, s24, v15
    v_bfe_u32 v16, v12, 3, 2
    v_bfe_u32 v17, v13, 3, 2
    v_bfe_u32 v18, v14, 3, 2
    v_bfe_u32 v19, v15, 3, 2
    v_mad_i32_i24 v20, v16, s26, v8
    v_mad_i32_i24 v21, v17, s26, v8
    v_mad_i32_i24 v22, v18, s26, v8
    v_mad_i32_i24 v23, v19, s26, v8
    v_mad_u32_u24 v16, v16, s53, v152
    v_mad_u32_u24 v17, v17, s53, v153
    v_mad_u32_u24 v18, v18, s53, v154
    v_mad_u32_u24 v19, v19, s53, v155
    v_mul_hi_u32_u24 v16, v20, v16
    v_mul_hi_u32_u24 v17, v21, v17
    v_mul_hi_u32_u24 v18, v22, v18
    v_mul_hi_u32_u24 v19, v23, v19
    v_mul_u32_u24 v20, s25, v12
    v_mul_u32_u24 v21, s25, v13
    v_mul_u32_u24 v22, s25, v14
    v_mul_u32_u24 v23, s25, v15
    v_and_b32 v20, -4, v20
    v_and_b32 v21, -4, v21
    v_and_b32 v22, -4, v22
    v_and_b32 v23, -4, v23
    v_sub_u32 v20, v156, v20
    v_sub_u32 v21, v157, v21
    v_sub_u32 v22, v158, v22
    v_sub_u32 v23, v159, v23
    v_lshl_or_b32 v16, v16, 8, v12
    v_lshl_or_b32 v17, v17, 8, v13
    v_lshl_or_b32 v18, v18, 8, v14
    v_lshl_or_b32 v19, v19, 8, v15
    v_lshlrev_b32 v16, 2, v16
    v_lshlrev_b32 v17, 2, v17
    v_lshlrev_b32 v18, 2, v18
    v_lshlrev_b32 v19, 2, v19
    v_and_b32 v12, 15, v20
    v_and_b32 v13, 15, v21
    v_and_b32 v14, 15, v22
    v_and_b32 v15, 15, v23
    ds_add_u32 v16, v3
    v_lshrrev_b32 v20, 4, v20
    v_lshl_or_b32 v12, v152, 4, v12
    ds_add_u32 v17, v3
    v_lshrrev_b32 v21, 4, v21
    v_lshl_or_b32 v13, v153, 4, v13
    ds_add_u32 v18, v3
    v_lshrrev_b32 v22, 4, v22
    v_lshl_or_b32 v14, v154, 4, v14
    ds_add_u32 v19, v3
    v_lshrrev_b32 v23, 4, v23
    v_lshl_or_b32 v15, v155, 4, v15
    v_lshl_or_b32 v152, v12, 8, v20
    v_lshl_or_b32 v153, v48, 16, v16
    v_lshl_or_b32 v154, v13, 8, v21
    v_and_or_b32 v155, v48, s27, v17
    v_lshl_or_b32 v156, v14, 8, v22
    v_lshl_or_b32 v157, v49, 16, v18
    v_lshl_or_b32 v158, v15, 8, v23
    v_and_or_b32 v159, v49, s27, v19
    s_mov_b32 s50, 163840
    s_mov_b32 s51, 81920
    buffer_load_dwordx4 v[216:219], v1, s[4:7], s50 offen nt
    buffer_load_dwordx4 v[220:223], v1, s[8:11], s50 offen nt
    buffer_load_dwordx2 v[48:49], v2, s[12:15], s51 offen nt
    s_waitcnt vmcnt(21)
    v_or_b32 v12, 3, v164
    v_or_b32 v13, 3, v165
    v_or_b32 v14, 3, v166
    v_or_b32 v15, 3, v167
    v_mul_hi_u32_u24 v12, s24, v12
    v_mul_hi_u32_u24 v13, s24, v13
    v_mul_hi_u32_u24 v14, s24, v14
    v_mul_hi_u32_u24 v15, s24, v15
    v_bfe_u32 v16, v12, 3, 2
    v_bfe_u32 v17, v13, 3, 2
    v_bfe_u32 v18, v14, 3, 2
    v_bfe_u32 v19, v15, 3, 2
    v_mad_i32_i24 v20, v16, s26, v8
    v_mad_i32_i24 v21, v17, s26, v8
    v_mad_i32_i24 v22, v18, s26, v8
    v_mad_i32_i24 v23, v19, s26, v8
    v_mad_u32_u24 v16, v16, s53, v160
    v_mad_u32_u24 v17, v17, s53, v161
    v_mad_u32_u24 v18, v18, s53, v162
    v_mad_u32_u24 v19, v19, s53, v163
    v_mul_hi_u32_u24 v16, v20, v16
    v_mul_hi_u32_u24 v17, v21, v17
    v_mul_hi_u32_u24 v18, v22, v18
    v_mul_hi_u32_u24 v19, v23, v19
    v_mul_u32_u24 v20, s25, v12
    v_mul_u32_u24 v21, s25, v13
    v_mul_u32_u24 v22, s25, v14
    v_mul_u32_u24 v23, s25, v15
    v_and_b32 v20, -4, v20
    v_and_b32 v21, -4, v21
    v_and_b32 v22, -4, v22
    v_and_b32 v23, -4, v23
    v_sub_u32 v20, v164, v20
    v_sub_u32 v21, v165, v21
    v_sub_u32 v22, v166, v22
    v_sub_u32 v23, v167, v23
    v_lshl_or_b32 v16, v16, 8, v12
    v_lshl_or_b32 v17, v17, 8, v13
    v_lshl_or_b32 v18, v18, 8, v14
    v_lshl_or_b32 v19, v19, 8, v15
    v_lshlrev_b32 v16, 2, v16
    v_lshlrev_b32 v17, 2, v17
    v_lshlrev_b32 v18, 2, v18
    v_lshlrev_b32 v19, 2, v19
    v_and_b32 v12, 15, v20
    v_and_b32 v13, 15, v21
    v_and_b32 v14, 15, v22
    v_and_b32 v15, 15, v23
    ds_add_u32 v16, v3
    v_lshrrev_b32 v20, 4, v20
    v_lshl_or_b32 v12, v160, 4, v12
    ds_add_u32 v17, v3
    v_lshrrev_b32 v21, 4, v21
    v_lshl_or_b32 v13, v161, 4, v13
    ds_add_u32 v18, v3
    v_lshrrev_b32 v22, 4, v22
    v_lshl_or_b32 v14, v162, 4, v14
    ds_add_u32 v19, v3
    v_lshrrev_b32 v23, 4, v23
    v_lshl_or_b32 v15, v163, 4, v15
    v_lshl_or_b32 v160, v12, 8, v20
    v_lshl_or_b32 v161, v50, 16, v16
    v_lshl_or_b32 v162, v13, 8, v21
    v_and_or_b32 v163, v50, s27, v17
    v_lshl_or_b32 v164, v14, 8, v22
    v_lshl_or_b32 v165, v51, 16, v18
    v_lshl_or_b32 v166, v15, 8, v23
    v_and_or_b32 v167, v51, s27, v19
    s_mov_b32 s50, 172032
    s_mov_b32 s51, 86016
    buffer_load_dwordx4 v[224:227], v1, s[4:7], s50 offen nt
    buffer_load_dwordx4 v[228:231], v1, s[8:11], s50 offen nt
    buffer_load_dwordx2 v[50:51], v2, s[12:15], s51 offen nt
    s_waitcnt vmcnt(21)
    v_or_b32 v12, 3, v172
    v_or_b32 v13, 3, v173
    v_or_b32 v14, 3, v174
    v_or_b32 v15, 3, v175
    v_mul_hi_u32_u24 v12, s24, v12
    v_mul_hi_u32_u24 v13, s24, v13
    v_mul_hi_u32_u24 v14, s24, v14
    v_mul_hi_u32_u24 v15, s24, v15
    v_bfe_u32 v16, v12, 3, 2
    v_bfe_u32 v17, v13, 3, 2
    v_bfe_u32 v18, v14, 3, 2
    v_bfe_u32 v19, v15, 3, 2
    v_mad_i32_i24 v20, v16, s26, v8
    v_mad_i32_i24 v21, v17, s26, v8
    v_mad_i32_i24 v22, v18, s26, v8
    v_mad_i32_i24 v23, v19, s26, v8
    v_mad_u32_u24 v16, v16, s53, v168
    v_mad_u32_u24 v17, v17, s53, v169
    v_mad_u32_u24 v18, v18, s53, v170
    v_mad_u32_u24 v19, v19, s53, v171
    v_mul_hi_u32_u24 v16, v20, v16
    v_mul_hi_u32_u24 v17, v21, v17
    v_mul_hi_u32_u24 v18, v22, v18
    v_mul_hi_u32_u24 v19, v23, v19
    v_mul_u32_u24 v20, s25, v12
    v_mul_u32_u24 v21, s25, v13
    v_mul_u32_u24 v22, s25, v14
    v_mul_u32_u24 v23, s25, v15
    v_and_b32 v20, -4, v20
    v_and_b32 v21, -4, v21
    v_and_b32 v22, -4, v22
    v_and_b32 v23, -4, v23
    v_sub_u32 v20, v172, v20
    v_sub_u32 v21, v173, v21
    v_sub_u32 v22, v174, v22
    v_sub_u32 v23, v175, v23
    v_lshl_or_b32 v16, v16, 8, v12
    v_lshl_or_b32 v17, v17, 8, v13
    v_lshl_or_b32 v18, v18, 8, v14
    v_lshl_or_b32 v19, v19, 8, v15
    v_lshlrev_b32 v16, 2, v16
    v_lshlrev_b32 v17, 2, v17
    v_lshlrev_b32 v18, 2, v18
    v_lshlrev_b32 v19, 2, v19
    v_and_b32 v12, 15, v20
    v_and_b32 v13, 15, v21
    v_and_b32 v14, 15, v22
    v_and_b32 v15, 15, v23
    ds_add_u32 v16, v3
    v_lshrrev_b32 v20, 4, v20
    v_lshl_or_b32 v12, v168, 4, v12
    ds_add_u32 v17, v3
    v_lshrrev_b32 v21, 4, v21
    v_lshl_or_b32 v13, v169, 4, v13
    ds_add_u32 v18, v3
    v_lshrrev_b32 v22, 4, v22
    v_lshl_or_b32 v14, v170, 4, v14
    ds_add_u32 v19, v3
    v_lshrrev_b32 v23, 4, v23
    v_lshl_or_b32 v15, v171, 4, v15
    v_lshl_or_b32 v168, v12, 8, v20
    v_lshl_or_b32 v169, v52, 16, v16
    v_lshl_or_b32 v170, v13, 8, v21
    v_and_or_b32 v171, v52, s27, v17
    v_lshl_or_b32 v172, v14, 8, v22
    v_lshl_or_b32 v173, v53, 16, v18
    v_lshl_or_b32 v174, v15, 8, v23
    v_and_or_b32 v175, v53, s27, v19
    s_mov_b32 s50, 180224
    s_mov_b32 s51, 90112
    buffer_load_dwordx4 v[232:235], v1, s[4:7], s50 offen nt
    buffer_load_dwordx4 v[236:239], v1, s[8:11], s50 offen nt
    buffer_load_dwordx2 v[52:53], v2, s[12:15], s51 offen nt
    s_waitcnt vmcnt(21)
    v_or_b32 v12, 3, v180
    v_or_b32 v13, 3, v181
    v_or_b32 v14, 3, v182
    v_or_b32 v15, 3, v183
    v_mul_hi_u32_u24 v12, s24, v12
    v_mul_hi_u32_u24 v13, s24, v13
    v_mul_hi_u32_u24 v14, s24, v14
    v_mul_hi_u32_u24 v15, s24, v15
    v_bfe_u32 v16, v12, 3, 2
    v_bfe_u32 v17, v13, 3, 2
    v_bfe_u32 v18, v14, 3, 2
    v_bfe_u32 v19, v15, 3, 2
    v_mad_i32_i24 v20, v16, s26, v8
    v_mad_i32_i24 v21, v17, s26, v8
    v_mad_i32_i24 v22, v18, s26, v8
    v_mad_i32_i24 v23, v19, s26, v8
    v_mad_u32_u24 v16, v16, s53, v176
    v_mad_u32_u24 v17, v17, s53, v177
    v_mad_u32_u24 v18, v18, s53, v178
    v_mad_u32_u24 v19, v19, s53, v179
    v_mul_hi_u32_u24 v16, v20, v16
    v_mul_hi_u32_u24 v17, v21, v17
    v_mul_hi_u32_u24 v18, v22, v18
    v_mul_hi_u32_u24 v19, v23, v19
    v_mul_u32_u24 v20, s25, v12
    v_mul_u32_u24 v21, s25, v13
    v_mul_u32_u24 v22, s25, v14
    v_mul_u32_u24 v23, s25, v15
    v_and_b32 v20, -4, v20
    v_and_b32 v21, -4, v21
    v_and_b32 v22, -4, v22
    v_and_b32 v23, -4, v23
    v_sub_u32 v20, v180, v20
    v_sub_u32 v21, v181, v21
    v_sub_u32 v22, v182, v22
    v_sub_u32 v23, v183, v23
    v_lshl_or_b32 v16, v16, 8, v12
    v_lshl_or_b32 v17, v17, 8, v13
    v_lshl_or_b32 v18, v18, 8, v14
    v_lshl_or_b32 v19, v19, 8, v15
    v_lshlrev_b32 v16, 2, v16
    v_lshlrev_b32 v17, 2, v17
    v_lshlrev_b32 v18, 2, v18
    v_lshlrev_b32 v19, 2, v19
    v_and_b32 v12, 15, v20
    v_and_b32 v13, 15, v21
    v_and_b32 v14, 15, v22
    v_and_b32 v15, 15, v23
    ds_add_u32 v16, v3
    v_lshrrev_b32 v20, 4, v20
    v_lshl_or_b32 v12, v176, 4, v12
    ds_add_u32 v17, v3
    v_lshrrev_b32 v21, 4, v21
    v_lshl_or_b32 v13, v177, 4, v13
    ds_add_u32 v18, v3
    v_lshrrev_b32 v22, 4, v22
    v_lshl_or_b32 v14, v178, 4, v14
    ds_add_u32 v19, v3
    v_lshrrev_b32 v23, 4, v23
    v_lshl_or_b32 v15, v179, 4, v15
    v_lshl_or_b32 v176, v12, 8, v20
    v_lshl_or_b32 v177, v54, 16, v16
    v_lshl_or_b32 v178, v13, 8, v21
    v_and_or_b32 v179, v54, s27, v17
    v_lshl_or_b32 v180, v14, 8, v22
    v_lshl_or_b32 v181, v55, 16, v18
    v_lshl_or_b32 v182, v15, 8, v23
    v_and_or_b32 v183, v55, s27, v19
    s_mov_b32 s50, 188416
    s_mov_b32 s51, 94208
    buffer_load_dwordx4 v[240:243], v1, s[4:7], s50 offen nt
    buffer_load_dwordx4 v[244:247], v1, s[8:11], s50 offen nt
    buffer_load_dwordx2 v[54:55], v2, s[12:15], s51 offen nt
    s_waitcnt vmcnt(21)
    v_or_b32 v12, 3, v188
    v_or_b32 v13, 3, v189
    v_or_b32 v14, 3, v190
    v_or_b32 v15, 3, v191
    v_mul_hi_u32_u24 v12, s24, v12
    v_mul_hi_u32_u24 v13, s24, v13
    v_mul_hi_u32_u24 v14, s24, v14
    v_mul_hi_u32_u24 v15, s24, v15
    v_bfe_u32 v16, v12, 3, 2
    v_bfe_u32 v17, v13, 3, 2
    v_bfe_u32 v18, v14, 3, 2
    v_bfe_u32 v19, v15, 3, 2
    v_mad_i32_i24 v20, v16, s26, v8
    v_mad_i32_i24 v21, v17, s26, v8
    v_mad_i32_i24 v22, v18, s26, v8
    v_mad_i32_i24 v23, v19, s26, v8
    v_mad_u32_u24 v16, v16, s53, v184
    v_mad_u32_u24 v17, v17, s53, v185
    v_mad_u32_u24 v18, v18, s53, v186
    v_mad_u32_u24 v19, v19, s53, v187
    v_mul_hi_u32_u24 v16, v20, v16
    v_mul_hi_u32_u24 v17, v21, v17
    v_mul_hi_u32_u24 v18, v22, v18
    v_mul_hi_u32_u24 v19, v23, v19
    v_mul_u32_u24 v20, s25, v12
    v_mul_u32_u24 v21, s25, v13
    v_mul_u32_u24 v22, s25, v14
    v_mul_u32_u24 v23, s25, v15
    v_and_b32 v20, -4, v20
    v_and_b32 v21, -4, v21
    v_and_b32 v22, -4, v22
    v_and_b32 v23, -4, v23
    v_sub_u32 v20, v188, v20
    v_sub_u32 v21, v189, v21
    v_sub_u32 v22, v190, v22
    v_sub_u32 v23, v191, v23
    v_lshl_or_b32 v16, v16, 8, v12
    v_lshl_or_b32 v17, v17, 8, v13
    v_lshl_or_b32 v18, v18, 8, v14
    v_lshl_or_b32 v19, v19, 8, v15
    v_lshlrev_b32 v16, 2, v16
    v_lshlrev_b32 v17, 2, v17
    v_lshlrev_b32 v18, 2, v18
    v_lshlrev_b32 v19, 2, v19
    v_and_b32 v12, 15, v20
    v_and_b32 v13, 15, v21
    v_and_b32 v14, 15, v22
    v_and_b32 v15, 15, v23
    ds_add_u32 v16, v3
    v_lshrrev_b32 v20, 4, v20
    v_lshl_or_b32 v12, v184, 4, v12
    ds_add_u32 v17, v3
    v_lshrrev_b32 v21, 4, v21
    v_lshl_or_b32 v13, v185, 4, v13
    ds_add_u32 v18, v3
    v_lshrrev_b32 v22, 4, v22
    v_lshl_or_b32 v14, v186, 4, v14
    ds_add_u32 v19, v3
    v_lshrrev_b32 v23, 4, v23
    v_lshl_or_b32 v15, v187, 4, v15
    v_lshl_or_b32 v184, v12, 8, v20
    v_lshl_or_b32 v185, v40, 16, v16
    v_lshl_or_b32 v186, v13, 8, v21
    v_and_or_b32 v187, v40, s27, v17
    v_lshl_or_b32 v188, v14, 8, v22
    v_lshl_or_b32 v189, v41, 16, v18
    v_lshl_or_b32 v190, v15, 8, v23
    v_and_or_b32 v191, v41, s27, v19
    s_mov_b32 s50, 196608
    s_mov_b32 s51, 98304
    buffer_load_dwordx4 v[248:251], v1, s[4:7], s50 offen nt
    buffer_load_dwordx4 v[252:255], v1, s[8:11], s50 offen nt
    buffer_load_dwordx2 v[40:41], v2, s[12:15], s51 offen nt
    s_waitcnt vmcnt(21)
    v_or_b32 v12, 3, v196
    v_or_b32 v13, 3, v197
    v_or_b32 v14, 3, v198
    v_or_b32 v15, 3, v199
    v_mul_hi_u32_u24 v12, s24, v12
    v_mul_hi_u32_u24 v13, s24, v13
    v_mul_hi_u32_u24 v14, s24, v14
    v_mul_hi_u32_u24 v15, s24, v15
    v_bfe_u32 v16, v12, 3, 2
    v_bfe_u32 v17, v13, 3, 2
    v_bfe_u32 v18, v14, 3, 2
    v_bfe_u32 v19, v15, 3, 2
    v_mad_i32_i24 v20, v16, s26, v8
    v_mad_i32_i24 v21, v17, s26, v8
    v_mad_i32_i24 v22, v18, s26, v8
    v_mad_i32_i24 v23, v19, s26, v8
    v_mad_u32_u24 v16, v16, s53, v192
    v_mad_u32_u24 v17, v17, s53, v193
    v_mad_u32_u24 v18, v18, s53, v194
    v_mad_u32_u24 v19, v19, s53, v195
    v_mul_hi_u32_u24 v16, v20, v16
    v_mul_hi_u32_u24 v17, v21, v17
    v_mul_hi_u32_u24 v18, v22, v18
    v_mul_hi_u32_u24 v19, v23, v19
    v_mul_u32_u24 v20, s25, v12
    v_mul_u32_u24 v21, s25, v13
    v_mul_u32_u24 v22, s25, v14
    v_mul_u32_u24 v23, s25, v15
    v_and_b32 v20, -4, v20
    v_and_b32 v21, -4, v21
    v_and_b32 v22, -4, v22
    v_and_b32 v23, -4, v23
    v_sub_u32 v20, v196, v20
    v_sub_u32 v21, v197, v21
    v_sub_u32 v22, v198, v22
    v_sub_u32 v23, v199, v23
    v_lshl_or_b32 v16, v16, 8, v12
    v_lshl_or_b32 v17, v17, 8, v13
    v_lshl_or_b32 v18, v18, 8, v14
    v_lshl_or_b32 v19, v19, 8, v15
    v_lshlrev_b32 v16, 2, v16
    v_lshlrev_b32 v17, 2, v17
    v_lshlrev_b32 v18, 2, v18
    v_lshlrev_b32 v19, 2, v19
    v_and_b32 v12, 15, v20
    v_and_b32 v13, 15, v21
    v_and_b32 v14, 15, v22
    v_and_b32 v15, 15, v23
    ds_add_u32 v16, v3
    v_lshrrev_b32 v20, 4, v20
    v_lshl_or_b32 v12, v192, 4, v12
    ds_add_u32 v17, v3
    v_lshrrev_b32 v21, 4, v21
    v_lshl_or_b32 v13, v193, 4, v13
    ds_add_u32 v18, v3
    v_lshrrev_b32 v22, 4, v22
    v_lshl_or_b32 v14, v194, 4, v14
    ds_add_u32 v19, v3
    v_lshrrev_b32 v23, 4, v23
    v_lshl_or_b32 v15, v195, 4, v15
    v_lshl_or_b32 v192, v12, 8, v20
    v_lshl_or_b32 v193, v42, 16, v16
    v_lshl_or_b32 v194, v13, 8, v21
    v_and_or_b32 v195, v42, s27, v17
    v_lshl_or_b32 v196, v14, 8, v22
    v_lshl_or_b32 v197, v43, 16, v18
    v_lshl_or_b32 v198, v15, 8, v23
    v_and_or_b32 v199, v43, s27, v19
    s_waitcnt vmcnt(18)
    v_or_b32 v12, 3, v204
    v_or_b32 v13, 3, v205
    v_or_b32 v14, 3, v206
    v_or_b32 v15, 3, v207
    v_mul_hi_u32_u24 v12, s24, v12
    v_mul_hi_u32_u24 v13, s24, v13
    v_mul_hi_u32_u24 v14, s24, v14
    v_mul_hi_u32_u24 v15, s24, v15
    v_bfe_u32 v16, v12, 3, 2
    v_bfe_u32 v17, v13, 3, 2
    v_bfe_u32 v18, v14, 3, 2
    v_bfe_u32 v19, v15, 3, 2
    v_mad_i32_i24 v20, v16, s26, v8
    v_mad_i32_i24 v21, v17, s26, v8
    v_mad_i32_i24 v22, v18, s26, v8
    v_mad_i32_i24 v23, v19, s26, v8
    v_mad_u32_u24 v16, v16, s53, v200
    v_mad_u32_u24 v17, v17, s53, v201
    v_mad_u32_u24 v18, v18, s53, v202
    v_mad_u32_u24 v19, v19, s53, v203
    v_mul_hi_u32_u24 v16, v20, v16
    v_mul_hi_u32_u24 v17, v21, v17
    v_mul_hi_u32_u24 v18, v22, v18
    v_mul_hi_u32_u24 v19, v23, v19
    v_mul_u32_u24 v20, s25, v12
    v_mul_u32_u24 v21, s25, v13
    v_mul_u32_u24 v22, s25, v14
    v_mul_u32_u24 v23, s25, v15
    v_and_b32 v20, -4, v20
    v_and_b32 v21, -4, v21
    v_and_b32 v22, -4, v22
    v_and_b32 v23, -4, v23
    v_sub_u32 v20, v204, v20
    v_sub_u32 v21, v205, v21
    v_sub_u32 v22, v206, v22
    v_sub_u32 v23, v207, v23
    v_lshl_or_b32 v16, v16, 8, v12
    v_lshl_or_b32 v17, v17, 8, v13
    v_lshl_or_b32 v18, v18, 8, v14
    v_lshl_or_b32 v19, v19, 8, v15
    v_lshlrev_b32 v16, 2, v16
    v_lshlrev_b32 v17, 2, v17
    v_lshlrev_b32 v18, 2, v18
    v_lshlrev_b32 v19, 2, v19
    v_and_b32 v12, 15, v20
    v_and_b32 v13, 15, v21
    v_and_b32 v14, 15, v22
    v_and_b32 v15, 15, v23
    ds_add_u32 v16, v3
    v_lshrrev_b32 v20, 4, v20
    v_lshl_or_b32 v12, v200, 4, v12
    ds_add_u32 v17, v3
    v_lshrrev_b32 v21, 4, v21
    v_lshl_or_b32 v13, v201, 4, v13
    ds_add_u32 v18, v3
    v_lshrrev_b32 v22, 4, v22
    v_lshl_or_b32 v14, v202, 4, v14
    ds_add_u32 v19, v3
    v_lshrrev_b32 v23, 4, v23
    v_lshl_or_b32 v15, v203, 4, v15
    v_lshl_or_b32 v200, v12, 8, v20
    v_lshl_or_b32 v201, v44, 16, v16
    v_lshl_or_b32 v202, v13, 8, v21
    v_and_or_b32 v203, v44, s27, v17
    v_lshl_or_b32 v204, v14, 8, v22
    v_lshl_or_b32 v205, v45, 16, v18
    v_lshl_or_b32 v206, v15, 8, v23
    v_and_or_b32 v207, v45, s27, v19
    s_waitcnt vmcnt(15)
    v_or_b32 v12, 3, v212
    v_or_b32 v13, 3, v213
    v_or_b32 v14, 3, v214
    v_or_b32 v15, 3, v215
    v_mul_hi_u32_u24 v12, s24, v12
    v_mul_hi_u32_u24 v13, s24, v13
    v_mul_hi_u32_u24 v14, s24, v14
    v_mul_hi_u32_u24 v15, s24, v15
    v_bfe_u32 v16, v12, 3, 2
    v_bfe_u32 v17, v13, 3, 2
    v_bfe_u32 v18, v14, 3, 2
    v_bfe_u32 v19, v15, 3, 2
    v_mad_i32_i24 v20, v16, s26, v8
    v_mad_i32_i24 v21, v17, s26, v8
    v_mad_i32_i24 v22, v18, s26, v8
    v_mad_i32_i24 v23, v19, s26, v8
    v_mad_u32_u24 v16, v16, s53, v208
    v_mad_u32_u24 v17, v17, s53, v209
    v_mad_u32_u24 v18, v18, s53, v210
    v_mad_u32_u24 v19, v19, s53, v211
    v_mul_hi_u32_u24 v16, v20, v16
    v_mul_hi_u32_u24 v17, v21, v17
    v_mul_hi_u32_u24 v18, v22, v18
    v_mul_hi_u32_u24 v19, v23, v19
    v_mul_u32_u24 v20, s25, v12
    v_mul_u32_u24 v21, s25, v13
    v_mul_u32_u24 v22, s25, v14
    v_mul_u32_u24 v23, s25, v15
    v_and_b32 v20, -4, v20
    v_and_b32 v21, -4, v21
    v_and_b32 v22, -4, v22
    v_and_b32 v23, -4, v23
    v_sub_u32 v20, v212, v20
    v_sub_u32 v21, v213, v21
    v_sub_u32 v22, v214, v22
    v_sub_u32 v23, v215, v23
    v_lshl_or_b32 v16, v16, 8, v12
    v_lshl_or_b32 v17, v17, 8, v13
    v_lshl_or_b32 v18, v18, 8, v14
    v_lshl_or_b32 v19, v19, 8, v15
    v_lshlrev_b32 v16, 2, v16
    v_lshlrev_b32 v17, 2, v17
    v_lshlrev_b32 v18, 2, v18
    v_lshlrev_b32 v19, 2, v19
    v_and_b32 v12, 15, v20
    v_and_b32 v13, 15, v21
    v_and_b32 v14, 15, v22
    v_and_b32 v15, 15, v23
    ds_add_u32 v16, v3
    v_lshrrev_b32 v20, 4, v20
    v_lshl_or_b32 v12, v208, 4, v12
    ds_add_u32 v17, v3
    v_lshrrev_b32 v21, 4, v21
    v_lshl_or_b32 v13, v209, 4, v13
    ds_add_u32 v18, v3
    v_lshrrev_b32 v22, 4, v22
    v_lshl_or_b32 v14, v210, 4, v14
    ds_add_u32 v19, v3
    v_lshrrev_b32 v23, 4, v23
    v_lshl_or_b32 v15, v211, 4, v15
    v_lshl_or_b32 v208, v12, 8, v20
    v_lshl_or_b32 v209, v46, 16, v16
    v_lshl_or_b32 v210, v13, 8, v21
    v_and_or_b32 v211, v46, s27, v17
    v_lshl_or_b32 v212, v14, 8, v22
    v_lshl_or_b32 v213, v47, 16, v18
    v_lshl_or_b32 v214, v15, 8, v23
    v_and_or_b32 v215, v47, s27, v19
    s_waitcnt vmcnt(12)
    v_or_b32 v12, 3, v220
    v_or_b32 v13, 3, v221
    v_or_b32 v14, 3, v222
    v_or_b32 v15, 3, v223
    v_mul_hi_u32_u24 v12, s24, v12
    v_mul_hi_u32_u24 v13, s24, v13
    v_mul_hi_u32_u24 v14, s24, v14
    v_mul_hi_u32_u24 v15, s24, v15
    v_bfe_u32 v16, v12, 3, 2
    v_bfe_u32 v17, v13, 3, 2
    v_bfe_u32 v18, v14, 3, 2
    v_bfe_u32 v19, v15, 3, 2
    v_mad_i32_i24 v20, v16, s26, v8
    v_mad_i32_i24 v21, v17, s26, v8
    v_mad_i32_i24 v22, v18, s26, v8
    v_mad_i32_i24 v23, v19, s26, v8
    v_mad_u32_u24 v16, v16, s53, v216
    v_mad_u32_u24 v17, v17, s53, v217
    v_mad_u32_u24 v18, v18, s53, v218
    v_mad_u32_u24 v19, v19, s53, v219
    v_mul_hi_u32_u24 v16, v20, v16
    v_mul_hi_u32_u24 v17, v21, v17
    v_mul_hi_u32_u24 v18, v22, v18
    v_mul_hi_u32_u24 v19, v23, v19
    v_mul_u32_u24 v20, s25, v12
    v_mul_u32_u24 v21, s25, v13
    v_mul_u32_u24 v22, s25, v14
    v_mul_u32_u24 v23, s25, v15
    v_and_b32 v20, -4, v20
    v_and_b32 v21, -4, v21
    v_and_b32 v22, -4, v22
    v_and_b32 v23, -4, v23
    v_sub_u32 v20, v220, v20
    v_sub_u32 v21, v221, v21
    v_sub_u32 v22, v222, v22
    v_sub_u32 v23, v223, v23
    v_lshl_or_b32 v16, v16, 8, v12
    v_lshl_or_b32 v17, v17, 8, v13
    v_lshl_or_b32 v18, v18, 8, v14
    v_lshl_or_b32 v19, v19, 8, v15
    v_lshlrev_b32 v16, 2, v16
    v_lshlrev_b32 v17, 2, v17
    v_lshlrev_b32 v18, 2, v18
    v_lshlrev_b32 v19, 2, v19
    v_and_b32 v12, 15, v20
    v_and_b32 v13, 15, v21
    v_and_b32 v14, 15, v22
    v_and_b32 v15, 15, v23
    ds_add_u32 v16, v3
    v_lshrrev_b32 v20, 4, v20
    v_lshl_or_b32 v12, v216, 4, v12
    ds_add_u32 v17, v3
    v_lshrrev_b32 v21, 4, v21
    v_lshl_or_b32 v13, v217, 4, v13
    ds_add_u32 v18, v3
    v_lshrrev_b32 v22, 4, v22
    v_lshl_or_b32 v14, v218, 4, v14
    ds_add_u32 v19, v3
    v_lshrrev_b32 v23, 4, v23
    v_lshl_or_b32 v15, v219, 4, v15
    v_lshl_or_b32 v216, v12, 8, v20
    v_lshl_or_b32 v217, v48, 16, v16
    v_lshl_or_b32 v218, v13, 8, v21
    v_and_or_b32 v219, v48, s27, v17
    v_lshl_or_b32 v220, v14, 8, v22
    v_lshl_or_b32 v221, v49, 16, v18
    v_lshl_or_b32 v222, v15, 8, v23
    v_and_or_b32 v223, v49, s27, v19
    s_waitcnt vmcnt(9)
    v_or_b32 v12, 3, v228
    v_or_b32 v13, 3, v229
    v_or_b32 v14, 3, v230
    v_or_b32 v15, 3, v231
    v_mul_hi_u32_u24 v12, s24, v12
    v_mul_hi_u32_u24 v13, s24, v13
    v_mul_hi_u32_u24 v14, s24, v14
    v_mul_hi_u32_u24 v15, s24, v15
    v_bfe_u32 v16, v12, 3, 2
    v_bfe_u32 v17, v13, 3, 2
    v_bfe_u32 v18, v14, 3, 2
    v_bfe_u32 v19, v15, 3, 2
    v_mad_i32_i24 v20, v16, s26, v8
    v_mad_i32_i24 v21, v17, s26, v8
    v_mad_i32_i24 v22, v18, s26, v8
    v_mad_i32_i24 v23, v19, s26, v8
    v_mad_u32_u24 v16, v16, s53, v224
    v_mad_u32_u24 v17, v17, s53, v225
    v_mad_u32_u24 v18, v18, s53, v226
    v_mad_u32_u24 v19, v19, s53, v227
    v_mul_hi_u32_u24 v16, v20, v16
    v_mul_hi_u32_u24 v17, v21, v17
    v_mul_hi_u32_u24 v18, v22, v18
    v_mul_hi_u32_u24 v19, v23, v19
    v_mul_u32_u24 v20, s25, v12
    v_mul_u32_u24 v21, s25, v13
    v_mul_u32_u24 v22, s25, v14
    v_mul_u32_u24 v23, s25, v15
    v_and_b32 v20, -4, v20
    v_and_b32 v21, -4, v21
    v_and_b32 v22, -4, v22
    v_and_b32 v23, -4, v23
    v_sub_u32 v20, v228, v20
    v_sub_u32 v21, v229, v21
    v_sub_u32 v22, v230, v22
    v_sub_u32 v23, v231, v23
    v_lshl_or_b32 v16, v16, 8, v12
    v_lshl_or_b32 v17, v17, 8, v13
    v_lshl_or_b32 v18, v18, 8, v14
    v_lshl_or_b32 v19, v19, 8, v15
    v_lshlrev_b32 v16, 2, v16
    v_lshlrev_b32 v17, 2, v17
    v_lshlrev_b32 v18, 2, v18
    v_lshlrev_b32 v19, 2, v19
    v_and_b32 v12, 15, v20
    v_and_b32 v13, 15, v21
    v_and_b32 v14, 15, v22
    v_and_b32 v15, 15, v23
    ds_add_u32 v16, v3
    v_lshrrev_b32 v20, 4, v20
    v_lshl_or_b32 v12, v224, 4, v12
    ds_add_u32 v17, v3
    v_lshrrev_b32 v21, 4, v21
    v_lshl_or_b32 v13, v225, 4, v13
    ds_add_u32 v18, v3
    v_lshrrev_b32 v22, 4, v22
    v_lshl_or_b32 v14, v226, 4, v14
    ds_add_u32 v19, v3
    v_lshrrev_b32 v23, 4, v23
    v_lshl_or_b32 v15, v227, 4, v15
    v_lshl_or_b32 v224, v12, 8, v20
    v_lshl_or_b32 v225, v50, 16, v16
    v_lshl_or_b32 v226, v13, 8, v21
    v_and_or_b32 v227, v50, s27, v17
    v_lshl_or_b32 v228, v14, 8, v22
    v_lshl_or_b32 v229, v51, 16, v18
    v_lshl_or_b32 v230, v15, 8, v23
    v_and_or_b32 v231, v51, s27, v19
    s_waitcnt vmcnt(6)
    v_or_b32 v12, 3, v236
    v_or_b32 v13, 3, v237
    v_or_b32 v14, 3, v238
    v_or_b32 v15, 3, v239
    v_mul_hi_u32_u24 v12, s24, v12
    v_mul_hi_u32_u24 v13, s24, v13
    v_mul_hi_u32_u24 v14, s24, v14
    v_mul_hi_u32_u24 v15, s24, v15
    v_bfe_u32 v16, v12, 3, 2
    v_bfe_u32 v17, v13, 3, 2
    v_bfe_u32 v18, v14, 3, 2
    v_bfe_u32 v19, v15, 3, 2
    v_mad_i32_i24 v20, v16, s26, v8
    v_mad_i32_i24 v21, v17, s26, v8
    v_mad_i32_i24 v22, v18, s26, v8
    v_mad_i32_i24 v23, v19, s26, v8
    v_mad_u32_u24 v16, v16, s53, v232
    v_mad_u32_u24 v17, v17, s53, v233
    v_mad_u32_u24 v18, v18, s53, v234
    v_mad_u32_u24 v19, v19, s53, v235
    v_mul_hi_u32_u24 v16, v20, v16
    v_mul_hi_u32_u24 v17, v21, v17
    v_mul_hi_u32_u24 v18, v22, v18
    v_mul_hi_u32_u24 v19, v23, v19
    v_mul_u32_u24 v20, s25, v12
    v_mul_u32_u24 v21, s25, v13
    v_mul_u32_u24 v22, s25, v14
    v_mul_u32_u24 v23, s25, v15
    v_and_b32 v20, -4, v20
    v_and_b32 v21, -4, v21
    v_and_b32 v22, -4, v22
    v_and_b32 v23, -4, v23
    v_sub_u32 v20, v236, v20
    v_sub_u32 v21, v237, v21
    v_sub_u32 v22, v238, v22
    v_sub_u32 v23, v239, v23
    v_lshl_or_b32 v16, v16, 8, v12
    v_lshl_or_b32 v17, v17, 8, v13
    v_lshl_or_b32 v18, v18, 8, v14
    v_lshl_or_b32 v19, v19, 8, v15
    v_lshlrev_b32 v16, 2, v16
    v_lshlrev_b32 v17, 2, v17
    v_lshlrev_b32 v18, 2, v18
    v_lshlrev_b32 v19, 2, v19
    v_and_b32 v12, 15, v20
    v_and_b32 v13, 15, v21
    v_and_b32 v14, 15, v22
    v_and_b32 v15, 15, v23
    ds_add_u32 v16, v3
    v_lshrrev_b32 v20, 4, v20
    v_lshl_or_b32 v12, v232, 4, v12
    ds_add_u32 v17, v3
    v_lshrrev_b32 v21, 4, v21
    v_lshl_or_b32 v13, v233, 4, v13
    ds_add_u32 v18, v3
    v_lshrrev_b32 v22, 4, v22
    v_lshl_or_b32 v14, v234, 4, v14
    ds_add_u32 v19, v3
    v_lshrrev_b32 v23, 4, v23
    v_lshl_or_b32 v15, v235, 4, v15
    v_lshl_or_b32 v232, v12, 8, v20
    v_lshl_or_b32 v233, v52, 16, v16
    v_lshl_or_b32 v234, v13, 8, v21
    v_and_or_b32 v235, v52, s27, v17
    v_lshl_or_b32 v236, v14, 8, v22
    v_lshl_or_b32 v237, v53, 16, v18
    v_lshl_or_b32 v238, v15, 8, v23
    v_and_or_b32 v239, v53, s27, v19
    s_waitcnt vmcnt(3)
    v_or_b32 v12, 3, v244
    v_or_b32 v13, 3, v245
    v_or_b32 v14, 3, v246
    v_or_b32 v15, 3, v247
    v_mul_hi_u32_u24 v12, s24, v12
    v_mul_hi_u32_u24 v13, s24, v13
    v_mul_hi_u32_u24 v14, s24, v14
    v_mul_hi_u32_u24 v15, s24, v15
    v_bfe_u32 v16, v12, 3, 2
    v_bfe_u32 v17, v13, 3, 2
    v_bfe_u32 v18, v14, 3, 2
    v_bfe_u32 v19, v15, 3, 2
    v_mad_i32_i24 v20, v16, s26, v8
    v_mad_i32_i24 v21, v17, s26, v8
    v_mad_i32_i24 v22, v18, s26, v8
    v_mad_i32_i24 v23, v19, s26, v8
    v_mad_u32_u24 v16, v16, s53, v240
    v_mad_u32_u24 v17, v17, s53, v241
    v_mad_u32_u24 v18, v18, s53, v242
    v_mad_u32_u24 v19, v19, s53, v243
    v_mul_hi_u32_u24 v16, v20, v16
    v_mul_hi_u32_u24 v17, v21, v17
    v_mul_hi_u32_u24 v18, v22, v18
    v_mul_hi_u32_u24 v19, v23, v19
    v_mul_u32_u24 v20, s25, v12
    v_mul_u32_u24 v21, s25, v13
    v_mul_u32_u24 v22, s25, v14
    v_mul_u32_u24 v23, s25, v15
    v_and_b32 v20, -4, v20
    v_and_b32 v21, -4, v21
    v_and_b32 v22, -4, v22
    v_and_b32 v23, -4, v23
    v_sub_u32 v20, v244, v20
    v_sub_u32 v21, v245, v21
    v_sub_u32 v22, v246, v22
    v_sub_u32 v23, v247, v23
    v_lshl_or_b32 v16, v16, 8, v12
    v_lshl_or_b32 v17, v17, 8, v13
    v_lshl_or_b32 v18, v18, 8, v14
    v_lshl_or_b32 v19, v19, 8, v15
    v_lshlrev_b32 v16, 2, v16
    v_lshlrev_b32 v17, 2, v17
    v_lshlrev_b32 v18, 2, v18
    v_lshlrev_b32 v19, 2, v19
    v_and_b32 v12, 15, v20
    v_and_b32 v13, 15, v21
    v_and_b32 v14, 15, v22
    v_and_b32 v15, 15, v23
    ds_add_u32 v16, v3
    v_lshrrev_b32 v20, 4, v20
    v_lshl_or_b32 v12, v240, 4, v12
    ds_add_u32 v17, v3
    v_lshrrev_b32 v21, 4, v21
    v_lshl_or_b32 v13, v241, 4, v13
    ds_add_u32 v18, v3
    v_lshrrev_b32 v22, 4, v22
    v_lshl_or_b32 v14, v242, 4, v14
    ds_add_u32 v19, v3
    v_lshrrev_b32 v23, 4, v23
    v_lshl_or_b32 v15, v243, 4, v15
    v_lshl_or_b32 v240, v12, 8, v20
    v_lshl_or_b32 v241, v54, 16, v16
    v_lshl_or_b32 v242, v13, 8, v21
    v_and_or_b32 v243, v54, s27, v17
    v_lshl_or_b32 v244, v14, 8, v22
    v_lshl_or_b32 v245, v55, 16, v18
    v_lshl_or_b32 v246, v15, 8, v23
    v_and_or_b32 v247, v55, s27, v19
    s_waitcnt vmcnt(0)
    s_mov_b64 exec, s[30:31]
    v_or_b32 v12, 3, v252
    v_or_b32 v13, 3, v253
    v_or_b32 v14, 3, v254
    v_or_b32 v15, 3, v255
    v_mul_hi_u32_u24 v12, s24, v12
    v_mul_hi_u32_u24 v13, s24, v13
    v_mul_hi_u32_u24 v14, s24, v14
    v_mul_hi_u32_u24 v15, s24, v15
    v_bfe_u32 v16, v12, 3, 2
    v_bfe_u32 v17, v13, 3, 2
    v_bfe_u32 v18, v14, 3, 2
    v_bfe_u32 v19, v15, 3, 2
    v_mad_i32_i24 v20, v16, s26, v8
    v_mad_i32_i24 v21, v17, s26, v8
    v_mad_i32_i24 v22, v18, s26, v8
    v_mad_i32_i24 v23, v19, s26, v8
    v_mad_u32_u24 v16, v16, s53, v248
    v_mad_u32_u24 v17, v17, s53, v249
    v_mad_u32_u24 v18, v18, s53, v250
    v_mad_u32_u24 v19, v19, s53, v251
    v_mul_hi_u32_u24 v16, v20, v16
    v_mul_hi_u32_u24 v17, v21, v17
    v_mul_hi_u32_u24 v18, v22, v18
    v_mul_hi_u32_u24 v19, v23, v19
    v_mul_u32_u24 v20, s25, v12
    v_mul_u32_u24 v21, s25, v13
    v_mul_u32_u24 v22, s25, v14
    v_mul_u32_u24 v23, s25, v15
    v_and_b32 v20, -4, v20
    v_and_b32 v21, -4, v21
    v_and_b32 v22, -4, v22
    v_and_b32 v23, -4, v23
    v_sub_u32 v20, v252, v20
    v_sub_u32 v21, v253, v21
    v_sub_u32 v22, v254, v22
    v_sub_u32 v23, v255, v23
    v_lshl_or_b32 v16, v16, 8, v12
    v_lshl_or_b32 v17, v17, 8, v13
    v_lshl_or_b32 v18, v18, 8, v14
    v_lshl_or_b32 v19, v19, 8, v15
    v_lshlrev_b32 v16, 2, v16
    v_lshlrev_b32 v17, 2, v17
    v_lshlrev_b32 v18, 2, v18
    v_lshlrev_b32 v19, 2, v19
    v_and_b32 v12, 15, v20
    v_and_b32 v13, 15, v21
    v_and_b32 v14, 15, v22
    v_and_b32 v15, 15, v23
    ds_add_u32 v16, v3
    v_lshrrev_b32 v20, 4, v20
    v_lshl_or_b32 v12, v248, 4, v12
    ds_add_u32 v17, v3
    v_lshrrev_b32 v21, 4, v21
    v_lshl_or_b32 v13, v249, 4, v13
    ds_add_u32 v18, v3
    v_lshrrev_b32 v22, 4, v22
    v_lshl_or_b32 v14, v250, 4, v14
    ds_add_u32 v19, v3
    v_lshrrev_b32 v23, 4, v23
    v_lshl_or_b32 v15, v251, 4, v15
    v_lshl_or_b32 v248, v12, 8, v20
    v_lshl_or_b32 v249, v40, 16, v16
    v_lshl_or_b32 v250, v13, 8, v21
    v_and_or_b32 v251, v40, s27, v17
    v_lshl_or_b32 v252, v14, 8, v22
    v_lshl_or_b32 v253, v41, 16, v18
    v_lshl_or_b32 v254, v15, 8, v23
    v_and_or_b32 v255, v41, s27, v19
    s_mov_b64 exec, -1
    s_waitcnt lgkmcnt(0)
    s_barrier
    v_mul_u32_u24 v11, 24, v0
    ds_read_b64 v[12:13], v11 offset:0
    ds_read_b64 v[14:15], v11 offset:8
    ds_read_b64 v[16:17], v11 offset:16
    s_waitcnt lgkmcnt(0)
    v_and_b32 v40, 1, v12
    v_and_b32 v41, 1, v13
    v_and_b32 v42, 1, v14
    v_and_b32 v43, 1, v15
    v_and_b32 v44, 1, v16
    v_and_b32 v45, 1, v17
    v_add_u32 v12, v12, v40
    v_add_u32 v13, v13, v41
    v_add_u32 v14, v14, v42
    v_add_u32 v15, v15, v43
    v_add_u32 v16, v16, v44
    v_add_u32 v17, v17, v45
    v_add_u32 v13, v13, v12
    v_add_u32 v14, v14, v13
    v_add_u32 v15, v15, v14
    v_add_u32 v16, v16, v15
    v_add_u32 v17, v17, v16
    v_mov_b32 v46, v17
    s_nop 1
    v_add_u32_dpp v46, v46, v46 row_shr:1 row_mask:0xf bank_mask:0xf
    s_nop 1
    v_add_u32_dpp v46, v46, v46 row_shr:2 row_mask:0xf bank_mask:0xf
    s_nop 1
    v_add_u32_dpp v46, v46, v46 row_shr:4 row_mask:0xf bank_mask:0xf
    s_nop 1
    v_add_u32_dpp v46, v46, v46 row_shr:8 row_mask:0xf bank_mask:0xf
    s_nop 1
    v_add_u32_dpp v46, v46, v46 row_bcast:15 row_mask:0xa bank_mask:0xf
    s_nop 1
    v_add_u32_dpp v46, v46, v46 row_bcast:31 row_mask:0xc bank_mask:0xf
    s_nop 0
    v_readlane_b32 s35, v46, 63
    s_lshl_b32 s50, s3, 2
    s_add_u32 s50, s50, 12352
    v_mov_b32 v47, s50
    v_mov_b32 v48, s35
    s_mov_b64 exec, 1
    ds_write_b32 v47, v48
    s_mov_b64 exec, -1
    v_sub_u32 v46, v46, v17
    v_mov_b32 v47, 12352
    s_waitcnt lgkmcnt(0)
    s_barrier
    ds_read_b128 v[48:51], v47
    ds_read_b128 v[52:55], v47 offset:16
    s_mov_b32 s35, 0
    s_mov_b32 s34, 0
    s_waitcnt lgkmcnt(0)
    v_readfirstlane_b32 s50, v48
    s_add_u32 s34, s34, s50
    s_cmp_eq_u32 s3, 1
    s_cselect_b32 s35, s34, s35
    v_readfirstlane_b32 s50, v49
    s_add_u32 s34, s34, s50
    s_cmp_eq_u32 s3, 2
    s_cselect_b32 s35, s34, s35
    v_readfirstlane_b32 s50, v50
    s_add_u32 s34, s34, s50
    s_cmp_eq_u32 s3, 3
    s_cselect_b32 s35, s34, s35
    v_readfirstlane_b32 s50, v51
    s_add_u32 s34, s34, s50
    s_cmp_eq_u32 s3, 4
    s_cselect_b32 s35, s34, s35
    v_readfirstlane_b32 s50, v52
    s_add_u32 s34, s34, s50
    s_cmp_eq_u32 s3, 5
    s_cselect_b32 s35, s34, s35
    v_readfirstlane_b32 s50, v53
    s_add_u32 s34, s34, s50
    s_cmp_eq_u32 s3, 6
    s_cselect_b32 s35, s34, s35
    v_readfirstlane_b32 s50, v54
    s_add_u32 s34, s34, s50
    s_cmp_eq_u32 s3, 7
    s_cselect_b32 s35, s34, s35
    v_readfirstlane_b32 s50, v55
    s_add_u32 s34, s34, s50
    s_cmp_eq_u32 s3, 8
    s_cselect_b32 s35, s34, s35
    v_add_u32 v28, s35, v46
    v_add_u32 v29, v28, v12
    v_add_u32 v30, v28, v13
    v_add_u32 v31, v28, v14
    v_add_u32 v32, v28, v15
    v_add_u32 v33, v28, v16
    v_add_u32 v34, v28, v17
    ds_write_b64 v11, v[28:29] offset:0
    ds_write_b64 v11, v[30:31] offset:8
    ds_write_b64 v11, v[32:33] offset:16
    s_mul_i32 s34, s34, 6
    s_waitcnt lgkmcnt(0)
    s_barrier
    s_mov_b32 s32, 12416
    v_and_b32 v12, s28, v57
    v_and_b32 v13, s28, v59
    v_and_b32 v14, s28, v61
    v_and_b32 v15, s28, v63
    ds_add_rtn_u32 v20, v12, v3
    ds_add_rtn_u32 v21, v13, v3
    ds_add_rtn_u32 v22, v14, v3
    ds_add_rtn_u32 v23, v15, v3
    v_and_b32 v16, s28, v65
    v_and_b32 v17, s28, v67
    v_and_b32 v18, s28, v69
    v_and_b32 v19, s28, v71
    ds_add_rtn_u32 v24, v16, v3
    ds_add_rtn_u32 v25, v17, v3
    ds_add_rtn_u32 v26, v18, v3
    ds_add_rtn_u32 v27, v19, v3
    s_waitcnt lgkmcnt(4)
    v_bfi_b32 v57, s28, v20, v57
    v_bfi_b32 v59, s28, v21, v59
    v_bfi_b32 v61, s28, v22, v61
    v_bfi_b32 v63, s28, v23, v63
    v_mad_u32_u16 v28, v57, 8, s32
    v_mad_u32_u16 v29, v59, 8, s32
    v_mad_u32_u16 v30, v61, 8, s32
    v_mad_u32_u16 v31, v63, 8, s32
    ds_write_b64 v28, v[56:57]
    ds_write_b64 v29, v[58:59]
    ds_write_b64 v30, v[60:61]
    ds_write_b64 v31, v[62:63]
    v_and_b32 v12, s28, v73
    v_and_b32 v13, s28, v75
    v_and_b32 v14, s28, v77
    v_and_b32 v15, s28, v79
    ds_add_rtn_u32 v20, v12, v3
    ds_add_rtn_u32 v21, v13, v3
    ds_add_rtn_u32 v22, v14, v3
    ds_add_rtn_u32 v23, v15, v3
    s_waitcnt lgkmcnt(8)
    v_bfi_b32 v65, s28, v24, v65
    v_bfi_b32 v67, s28, v25, v67
    v_bfi_b32 v69, s28, v26, v69
    v_bfi_b32 v71, s28, v27, v71
    v_mad_u32_u16 v28, v65, 8, s32
    v_mad_u32_u16 v29, v67, 8, s32
    v_mad_u32_u16 v30, v69, 8, s32
    v_mad_u32_u16 v31, v71, 8, s32
    ds_write_b64 v28, v[64:65]
    ds_write_b64 v29, v[66:67]
    ds_write_b64 v30, v[68:69]
    ds_write_b64 v31, v[70:71]
    v_and_b32 v16, s28, v81
    v_and_b32 v17, s28, v83
    v_and_b32 v18, s28, v85
    v_and_b32 v19, s28, v87
    ds_add_rtn_u32 v24, v16, v3
    ds_add_rtn_u32 v25, v17, v3
    ds_add_rtn_u32 v26, v18, v3
    ds_add_rtn_u32 v27, v19, v3
    s_waitcnt lgkmcnt(8)
    v_bfi_b32 v73, s28, v20, v73
    v_bfi_b32 v75, s28, v21, v75
    v_bfi_b32 v77, s28, v22, v77
    v_bfi_b32 v79, s28, v23, v79
    v_mad_u32_u16 v28, v73, 8, s32
    v_mad_u32_u16 v29, v75, 8, s32
    v_mad_u32_u16 v30, v77, 8, s32
    v_mad_u32_u16 v31, v79, 8, s32
    ds_write_b64 v28, v[72:73]
    ds_write_b64 v29, v[74:75]
    ds_write_b64 v30, v[76:77]
    ds_write_b64 v31, v[78:79]
    v_and_b32 v12, s28, v89
    v_and_b32 v13, s28, v91
    v_and_b32 v14, s28, v93
    v_and_b32 v15, s28, v95
    ds_add_rtn_u32 v20, v12, v3
    ds_add_rtn_u32 v21, v13, v3
    ds_add_rtn_u32 v22, v14, v3
    ds_add_rtn_u32 v23, v15, v3
    s_waitcnt lgkmcnt(8)
    v_bfi_b32 v81, s28, v24, v81
    v_bfi_b32 v83, s28, v25, v83
    v_bfi_b32 v85, s28, v26, v85
    v_bfi_b32 v87, s28, v27, v87
    v_mad_u32_u16 v28, v81, 8, s32
    v_mad_u32_u16 v29, v83, 8, s32
    v_mad_u32_u16 v30, v85, 8, s32
    v_mad_u32_u16 v31, v87, 8, s32
    ds_write_b64 v28, v[80:81]
    ds_write_b64 v29, v[82:83]
    ds_write_b64 v30, v[84:85]
    ds_write_b64 v31, v[86:87]
    v_lshlrev_b32 v9, 7, v0
    s_mul_i32 s50, s2, 100000
    s_and_b32 s50, s50, 0xffffff80
    s_add_u32 s51, s50, 65536
    s_mul_i32 s52, s2, 6250
    s_and_b32 s52, s52, 0xffffff80
    s_mov_b32 m0, 160000
    s_nop 0
    buffer_load_dword v9, s[64:67], s50 offen lds
    v_cmp_gt_u32 vcc, 271, v0
    s_mov_b64 exec, vcc
    buffer_load_dword v9, s[64:67], s51 offen lds
    s_mov_b64 exec, -1
    v_cmp_gt_u32 vcc, 50, v0
    s_mov_b64 exec, vcc
    buffer_load_dword v9, s[68:71], s52 offen lds
    s_mov_b64 exec, -1
    v_and_b32 v16, s28, v97
    v_and_b32 v17, s28, v99
    v_and_b32 v18, s28, v101
    v_and_b32 v19, s28, v103
    ds_add_rtn_u32 v24, v16, v3
    ds_add_rtn_u32 v25, v17, v3
    ds_add_rtn_u32 v26, v18, v3
    ds_add_rtn_u32 v27, v19, v3
    s_waitcnt lgkmcnt(8)
    v_bfi_b32 v89, s28, v20, v89
    v_bfi_b32 v91, s28, v21, v91
    v_bfi_b32 v93, s28, v22, v93
    v_bfi_b32 v95, s28, v23, v95
    v_mad_u32_u16 v28, v89, 8, s32
    v_mad_u32_u16 v29, v91, 8, s32
    v_mad_u32_u16 v30, v93, 8, s32
    v_mad_u32_u16 v31, v95, 8, s32
    ds_write_b64 v28, v[88:89]
    ds_write_b64 v29, v[90:91]
    ds_write_b64 v30, v[92:93]
    ds_write_b64 v31, v[94:95]
    v_and_b32 v12, s28, v105
    v_and_b32 v13, s28, v107
    v_and_b32 v14, s28, v109
    v_and_b32 v15, s28, v111
    ds_add_rtn_u32 v20, v12, v3
    ds_add_rtn_u32 v21, v13, v3
    ds_add_rtn_u32 v22, v14, v3
    ds_add_rtn_u32 v23, v15, v3
    s_waitcnt lgkmcnt(8)
    v_bfi_b32 v97, s28, v24, v97
    v_bfi_b32 v99, s28, v25, v99
    v_bfi_b32 v101, s28, v26, v101
    v_bfi_b32 v103, s28, v27, v103
    v_mad_u32_u16 v28, v97, 8, s32
    v_mad_u32_u16 v29, v99, 8, s32
    v_mad_u32_u16 v30, v101, 8, s32
    v_mad_u32_u16 v31, v103, 8, s32
    ds_write_b64 v28, v[96:97]
    ds_write_b64 v29, v[98:99]
    ds_write_b64 v30, v[100:101]
    ds_write_b64 v31, v[102:103]
    v_and_b32 v16, s28, v113
    v_and_b32 v17, s28, v115
    v_and_b32 v18, s28, v117
    v_and_b32 v19, s28, v119
    ds_add_rtn_u32 v24, v16, v3
    ds_add_rtn_u32 v25, v17, v3
    ds_add_rtn_u32 v26, v18, v3
    ds_add_rtn_u32 v27, v19, v3
    s_waitcnt lgkmcnt(8)
    v_bfi_b32 v105, s28, v20, v105
    v_bfi_b32 v107, s28, v21, v107
    v_bfi_b32 v109, s28, v22, v109
    v_bfi_b32 v111, s28, v23, v111
    v_mad_u32_u16 v28, v105, 8, s32
    v_mad_u32_u16 v29, v107, 8, s32
    v_mad_u32_u16 v30, v109, 8, s32
    v_mad_u32_u16 v31, v111, 8, s32
    ds_write_b64 v28, v[104:105]
    ds_write_b64 v29, v[106:107]
    ds_write_b64 v30, v[108:109]
    ds_write_b64 v31, v[110:111]
    v_and_b32 v12, s28, v121
    v_and_b32 v13, s28, v123
    v_and_b32 v14, s28, v125
    v_and_b32 v15, s28, v127
    ds_add_rtn_u32 v20, v12, v3
    ds_add_rtn_u32 v21, v13, v3
    ds_add_rtn_u32 v22, v14, v3
    ds_add_rtn_u32 v23, v15, v3
    s_waitcnt lgkmcnt(8)
    v_bfi_b32 v113, s28, v24, v113
    v_bfi_b32 v115, s28, v25, v115
    v_bfi_b32 v117, s28, v26, v117
    v_bfi_b32 v119, s28, v27, v119
    v_mad_u32_u16 v28, v113, 8, s32
    v_mad_u32_u16 v29, v115, 8, s32
    v_mad_u32_u16 v30, v117, 8, s32
    v_mad_u32_u16 v31, v119, 8, s32
    ds_write_b64 v28, v[112:113]
    ds_write_b64 v29, v[114:115]
    ds_write_b64 v30, v[116:117]
    ds_write_b64 v31, v[118:119]
    v_and_b32 v16, s28, v129
    v_and_b32 v17, s28, v131
    v_and_b32 v18, s28, v133
    v_and_b32 v19, s28, v135
    ds_add_rtn_u32 v24, v16, v3
    ds_add_rtn_u32 v25, v17, v3
    ds_add_rtn_u32 v26, v18, v3
    ds_add_rtn_u32 v27, v19, v3
    s_waitcnt lgkmcnt(8)
    v_bfi_b32 v121, s28, v20, v121
    v_bfi_b32 v123, s28, v21, v123
    v_bfi_b32 v125, s28, v22, v125
    v_bfi_b32 v127, s28, v23, v127
    v_mad_u32_u16 v28, v121, 8, s32
    v_mad_u32_u16 v29, v123, 8, s32
    v_mad_u32_u16 v30, v125, 8, s32
    v_mad_u32_u16 v31, v127, 8, s32
    ds_write_b64 v28, v[120:121]
    ds_write_b64 v29, v[122:123]
    ds_write_b64 v30, v[124:125]
    ds_write_b64 v31, v[126:127]
    v_and_b32 v12, s28, v137
    v_and_b32 v13, s28, v139
    v_and_b32 v14, s28, v141
    v_and_b32 v15, s28, v143
    ds_add_rtn_u32 v20, v12, v3
    ds_add_rtn_u32 v21, v13, v3
    ds_add_rtn_u32 v22, v14, v3
    ds_add_rtn_u32 v23, v15, v3
    s_waitcnt lgkmcnt(8)
    v_bfi_b32 v129, s28, v24, v129
    v_bfi_b32 v131, s28, v25, v131
    v_bfi_b32 v133, s28, v26, v133
    v_bfi_b32 v135, s28, v27, v135
    v_mad_u32_u16 v28, v129, 8, s32
    v_mad_u32_u16 v29, v131, 8, s32
    v_mad_u32_u16 v30, v133, 8, s32
    v_mad_u32_u16 v31, v135, 8, s32
    ds_write_b64 v28, v[128:129]
    ds_write_b64 v29, v[130:131]
    ds_write_b64 v30, v[132:133]
    ds_write_b64 v31, v[134:135]
    v_and_b32 v16, s28, v145
    v_and_b32 v17, s28, v147
    v_and_b32 v18, s28, v149
    v_and_b32 v19, s28, v151
    ds_add_rtn_u32 v24, v16, v3
    ds_add_rtn_u32 v25, v17, v3
    ds_add_rtn_u32 v26, v18, v3
    ds_add_rtn_u32 v27, v19, v3
    s_waitcnt lgkmcnt(8)
    v_bfi_b32 v137, s28, v20, v137
    v_bfi_b32 v139, s28, v21, v139
    v_bfi_b32 v141, s28, v22, v141
    v_bfi_b32 v143, s28, v23, v143
    v_mad_u32_u16 v28, v137, 8, s32
    v_mad_u32_u16 v29, v139, 8, s32
    v_mad_u32_u16 v30, v141, 8, s32
    v_mad_u32_u16 v31, v143, 8, s32
    ds_write_b64 v28, v[136:137]
    ds_write_b64 v29, v[138:139]
    ds_write_b64 v30, v[140:141]
    ds_write_b64 v31, v[142:143]
    v_and_b32 v12, s28, v153
    v_and_b32 v13, s28, v155
    v_and_b32 v14, s28, v157
    v_and_b32 v15, s28, v159
    ds_add_rtn_u32 v20, v12, v3
    ds_add_rtn_u32 v21, v13, v3
    ds_add_rtn_u32 v22, v14, v3
    ds_add_rtn_u32 v23, v15, v3
    s_waitcnt lgkmcnt(8)
    v_bfi_b32 v145, s28, v24, v145
    v_bfi_b32 v147, s28, v25, v147
    v_bfi_b32 v149, s28, v26, v149
    v_bfi_b32 v151, s28, v27, v151
    v_mad_u32_u16 v28, v145, 8, s32
    v_mad_u32_u16 v29, v147, 8, s32
    v_mad_u32_u16 v30, v149, 8, s32
    v_mad_u32_u16 v31, v151, 8, s32
    ds_write_b64 v28, v[144:145]
    ds_write_b64 v29, v[146:147]
    ds_write_b64 v30, v[148:149]
    ds_write_b64 v31, v[150:151]
    v_and_b32 v16, s28, v161
    v_and_b32 v17, s28, v163
    v_and_b32 v18, s28, v165
    v_and_b32 v19, s28, v167
    ds_add_rtn_u32 v24, v16, v3
    ds_add_rtn_u32 v25, v17, v3
    ds_add_rtn_u32 v26, v18, v3
    ds_add_rtn_u32 v27, v19, v3
    s_waitcnt lgkmcnt(8)
    v_bfi_b32 v153, s28, v20, v153
    v_bfi_b32 v155, s28, v21, v155
    v_bfi_b32 v157, s28, v22, v157
    v_bfi_b32 v159, s28, v23, v159
    v_mad_u32_u16 v28, v153, 8, s32
    v_mad_u32_u16 v29, v155, 8, s32
    v_mad_u32_u16 v30, v157, 8, s32
    v_mad_u32_u16 v31, v159, 8, s32
    ds_write_b64 v28, v[152:153]
    ds_write_b64 v29, v[154:155]
    ds_write_b64 v30, v[156:157]
    ds_write_b64 v31, v[158:159]
    v_and_b32 v12, s28, v169
    v_and_b32 v13, s28, v171
    v_and_b32 v14, s28, v173
    v_and_b32 v15, s28, v175
    ds_add_rtn_u32 v20, v12, v3
    ds_add_rtn_u32 v21, v13, v3
    ds_add_rtn_u32 v22, v14, v3
    ds_add_rtn_u32 v23, v15, v3
    s_waitcnt lgkmcnt(8)
    v_bfi_b32 v161, s28, v24, v161
    v_bfi_b32 v163, s28, v25, v163
    v_bfi_b32 v165, s28, v26, v165
    v_bfi_b32 v167, s28, v27, v167
    v_mad_u32_u16 v28, v161, 8, s32
    v_mad_u32_u16 v29, v163, 8, s32
    v_mad_u32_u16 v30, v165, 8, s32
    v_mad_u32_u16 v31, v167, 8, s32
    ds_write_b64 v28, v[160:161]
    ds_write_b64 v29, v[162:163]
    ds_write_b64 v30, v[164:165]
    ds_write_b64 v31, v[166:167]
    v_and_b32 v16, s28, v177
    v_and_b32 v17, s28, v179
    v_and_b32 v18, s28, v181
    v_and_b32 v19, s28, v183
    ds_add_rtn_u32 v24, v16, v3
    ds_add_rtn_u32 v25, v17, v3
    ds_add_rtn_u32 v26, v18, v3
    ds_add_rtn_u32 v27, v19, v3
    s_waitcnt lgkmcnt(8)
    v_bfi_b32 v169, s28, v20, v169
    v_bfi_b32 v171, s28, v21, v171
    v_bfi_b32 v173, s28, v22, v173
    v_bfi_b32 v175, s28, v23, v175
    v_mad_u32_u16 v28, v169, 8, s32
    v_mad_u32_u16 v29, v171, 8, s32
    v_mad_u32_u16 v30, v173, 8, s32
    v_mad_u32_u16 v31, v175, 8, s32
    ds_write_b64 v28, v[168:169]
    ds_write_b64 v29, v[170:171]
    ds_write_b64 v30, v[172:173]
    ds_write_b64 v31, v[174:175]
    v_and_b32 v12, s28, v185
    v_and_b32 v13, s28, v187
    v_and_b32 v14, s28, v189
    v_and_b32 v15, s28, v191
    ds_add_rtn_u32 v20, v12, v3
    ds_add_rtn_u32 v21, v13, v3
    ds_add_rtn_u32 v22, v14, v3
    ds_add_rtn_u32 v23, v15, v3
    s_waitcnt lgkmcnt(8)
    v_bfi_b32 v177, s28, v24, v177
    v_bfi_b32 v179, s28, v25, v179
    v_bfi_b32 v181, s28, v26, v181
    v_bfi_b32 v183, s28, v27, v183
    v_mad_u32_u16 v28, v177, 8, s32
    v_mad_u32_u16 v29, v179, 8, s32
    v_mad_u32_u16 v30, v181, 8, s32
    v_mad_u32_u16 v31, v183, 8, s32
    ds_write_b64 v28, v[176:177]
    ds_write_b64 v29, v[178:179]
    ds_write_b64 v30, v[180:181]
    ds_write_b64 v31, v[182:183]
    v_and_b32 v16, s28, v193
    v_and_b32 v17, s28, v195
    v_and_b32 v18, s28, v197
    v_and_b32 v19, s28, v199
    ds_add_rtn_u32 v24, v16, v3
    ds_add_rtn_u32 v25, v17, v3
    ds_add_rtn_u32 v26, v18, v3
    ds_add_rtn_u32 v27, v19, v3
    s_waitcnt lgkmcnt(8)
    v_bfi_b32 v185, s28, v20, v185
    v_bfi_b32 v187, s28, v21, v187
    v_bfi_b32 v189, s28, v22, v189
    v_bfi_b32 v191, s28, v23, v191
    v_mad_u32_u16 v28, v185, 8, s32
    v_mad_u32_u16 v29, v187, 8, s32
    v_mad_u32_u16 v30, v189, 8, s32
    v_mad_u32_u16 v31, v191, 8, s32
    ds_write_b64 v28, v[184:185]
    ds_write_b64 v29, v[186:187]
    ds_write_b64 v30, v[188:189]
    ds_write_b64 v31, v[190:191]
    v_and_b32 v12, s28, v201
    v_and_b32 v13, s28, v203
    v_and_b32 v14, s28, v205
    v_and_b32 v15, s28, v207
    ds_add_rtn_u32 v20, v12, v3
    ds_add_rtn_u32 v21, v13, v3
    ds_add_rtn_u32 v22, v14, v3
    ds_add_rtn_u32 v23, v15, v3
    s_waitcnt lgkmcnt(8)
    v_bfi_b32 v193, s28, v24, v193
    v_bfi_b32 v195, s28, v25, v195
    v_bfi_b32 v197, s28, v26, v197
    v_bfi_b32 v199, s28, v27, v199
    v_mad_u32_u16 v28, v193, 8, s32
    v_mad_u32_u16 v29, v195, 8, s32
    v_mad_u32_u16 v30, v197, 8, s32
    v_mad_u32_u16 v31, v199, 8, s32
    ds_write_b64 v28, v[192:193]
    ds_write_b64 v29, v[194:195]
    ds_write_b64 v30, v[196:197]
    ds_write_b64 v31, v[198:199]
    v_and_b32 v16, s28, v209
    v_and_b32 v17, s28, v211
    v_and_b32 v18, s28, v213
    v_and_b32 v19, s28, v215
    ds_add_rtn_u32 v24, v16, v3
    ds_add_rtn_u32 v25, v17, v3
    ds_add_rtn_u32 v26, v18, v3
    ds_add_rtn_u32 v27, v19, v3
    s_waitcnt lgkmcnt(8)
    v_bfi_b32 v201, s28, v20, v201
    v_bfi_b32 v203, s28, v21, v203
    v_bfi_b32 v205, s28, v22, v205
    v_bfi_b32 v207, s28, v23, v207
    v_mad_u32_u16 v28, v201, 8, s32
    v_mad_u32_u16 v29, v203, 8, s32
    v_mad_u32_u16 v30, v205, 8, s32
    v_mad_u32_u16 v31, v207, 8, s32
    ds_write_b64 v28, v[200:201]
    ds_write_b64 v29, v[202:203]
    ds_write_b64 v30, v[204:205]
    ds_write_b64 v31, v[206:207]
    v_and_b32 v12, s28, v217
    v_and_b32 v13, s28, v219
    v_and_b32 v14, s28, v221
    v_and_b32 v15, s28, v223
    ds_add_rtn_u32 v20, v12, v3
    ds_add_rtn_u32 v21, v13, v3
    ds_add_rtn_u32 v22, v14, v3
    ds_add_rtn_u32 v23, v15, v3
    s_waitcnt lgkmcnt(8)
    v_bfi_b32 v209, s28, v24, v209
    v_bfi_b32 v211, s28, v25, v211
    v_bfi_b32 v213, s28, v26, v213
    v_bfi_b32 v215, s28, v27, v215
    v_mad_u32_u16 v28, v209, 8, s32
    v_mad_u32_u16 v29, v211, 8, s32
    v_mad_u32_u16 v30, v213, 8, s32
    v_mad_u32_u16 v31, v215, 8, s32
    ds_write_b64 v28, v[208:209]
    ds_write_b64 v29, v[210:211]
    ds_write_b64 v30, v[212:213]
    ds_write_b64 v31, v[214:215]
    v_and_b32 v16, s28, v225
    v_and_b32 v17, s28, v227
    v_and_b32 v18, s28, v229
    v_and_b32 v19, s28, v231
    ds_add_rtn_u32 v24, v16, v3
    ds_add_rtn_u32 v25, v17, v3
    ds_add_rtn_u32 v26, v18, v3
    ds_add_rtn_u32 v27, v19, v3
    s_waitcnt lgkmcnt(8)
    v_bfi_b32 v217, s28, v20, v217
    v_bfi_b32 v219, s28, v21, v219
    v_bfi_b32 v221, s28, v22, v221
    v_bfi_b32 v223, s28, v23, v223
    v_mad_u32_u16 v28, v217, 8, s32
    v_mad_u32_u16 v29, v219, 8, s32
    v_mad_u32_u16 v30, v221, 8, s32
    v_mad_u32_u16 v31, v223, 8, s32
    ds_write_b64 v28, v[216:217]
    ds_write_b64 v29, v[218:219]
    ds_write_b64 v30, v[220:221]
    ds_write_b64 v31, v[222:223]
    v_and_b32 v12, s28, v233
    v_and_b32 v13, s28, v235
    v_and_b32 v14, s28, v237
    v_and_b32 v15, s28, v239
    ds_add_rtn_u32 v20, v12, v3
    ds_add_rtn_u32 v21, v13, v3
    ds_add_rtn_u32 v22, v14, v3
    ds_add_rtn_u32 v23, v15, v3
    s_waitcnt lgkmcnt(8)
    v_bfi_b32 v225, s28, v24, v225
    v_bfi_b32 v227, s28, v25, v227
    v_bfi_b32 v229, s28, v26, v229
    v_bfi_b32 v231, s28, v27, v231
    v_mad_u32_u16 v28, v225, 8, s32
    v_mad_u32_u16 v29, v227, 8, s32
    v_mad_u32_u16 v30, v229, 8, s32
    v_mad_u32_u16 v31, v231, 8, s32
    ds_write_b64 v28, v[224:225]
    ds_write_b64 v29, v[226:227]
    ds_write_b64 v30, v[228:229]
    ds_write_b64 v31, v[230:231]
    v_and_b32 v16, s28, v241
    v_and_b32 v17, s28, v243
    v_and_b32 v18, s28, v245
    v_and_b32 v19, s28, v247
    ds_add_rtn_u32 v24, v16, v3
    ds_add_rtn_u32 v25, v17, v3
    ds_add_rtn_u32 v26, v18, v3
    ds_add_rtn_u32 v27, v19, v3
    s_waitcnt lgkmcnt(8)
    v_bfi_b32 v233, s28, v20, v233
    v_bfi_b32 v235, s28, v21, v235
    v_bfi_b32 v237, s28, v22, v237
    v_bfi_b32 v239, s28, v23, v239
    v_mad_u32_u16 v28, v233, 8, s32
    v_mad_u32_u16 v29, v235, 8, s32
    v_mad_u32_u16 v30, v237, 8, s32
    v_mad_u32_u16 v31, v239, 8, s32
    ds_write_b64 v28, v[232:233]
    ds_write_b64 v29, v[234:235]
    ds_write_b64 v30, v[236:237]
    ds_write_b64 v31, v[238:239]
    v_mov_b32 v20, -1
    v_mov_b32 v21, -1
    v_mov_b32 v22, -1
    v_mov_b32 v23, -1
    s_mov_b64 exec, s[30:31]
    v_and_b32 v12, s28, v249
    v_and_b32 v13, s28, v251
    v_and_b32 v14, s28, v253
    v_and_b32 v15, s28, v255
    ds_add_rtn_u32 v20, v12, v3
    ds_add_rtn_u32 v21, v13, v3
    ds_add_rtn_u32 v22, v14, v3
    ds_add_rtn_u32 v23, v15, v3
    s_mov_b64 exec, -1
    s_waitcnt lgkmcnt(8)
    v_bfi_b32 v241, s28, v24, v241
    v_bfi_b32 v243, s28, v25, v243
    v_bfi_b32 v245, s28, v26, v245
    v_bfi_b32 v247, s28, v27, v247
    v_mad_u32_u16 v28, v241, 8, s32
    v_mad_u32_u16 v29, v243, 8, s32
    v_mad_u32_u16 v30, v245, 8, s32
    v_mad_u32_u16 v31, v247, 8, s32
    ds_write_b64 v28, v[240:241]
    ds_write_b64 v29, v[242:243]
    ds_write_b64 v30, v[244:245]
    ds_write_b64 v31, v[246:247]
    s_waitcnt lgkmcnt(4)
    v_bfi_b32 v249, s28, v20, v249
    v_bfi_b32 v251, s28, v21, v251
    v_bfi_b32 v253, s28, v22, v253
    v_bfi_b32 v255, s28, v23, v255
    v_mad_u32_u16 v28, v249, 8, s32
    v_mad_u32_u16 v29, v251, 8, s32
    v_mad_u32_u16 v30, v253, 8, s32
    v_mad_u32_u16 v31, v255, 8, s32
    ds_write_b64 v28, v[248:249]
    ds_write_b64 v29, v[250:251]
    ds_write_b64 v30, v[252:253]
    ds_write_b64 v31, v[254:255]
    v_add_u32 v5, 12416, v1
    v_add_u32 v6, 77952, v1
    v_add_u32 v7, 143488, v1
    v_mul_u32_u24 v4, 12, v0
    s_waitcnt lgkmcnt(0)
    s_barrier
    v_lshrrev_b32 v28, 1, v0
    v_and_b32 v29, 1, v0
    v_mul_u32_u24 v30, 6144, v29
    v_lshl_add_u32 v30, v28, 2, v30
    v_mul_u32_u24 v28, 24, v0
    v_max_u32 v31, 4, v30
    v_subrev_u32 v31, 4, v31
    s_mul_i32 s51, s2, 12288
    ds_read_b32 v8, v30 offset:0
    ds_read_b32 v14, v31 offset:0
    ds_read_b32 v9, v30 offset:1024
    ds_read_b32 v15, v30 offset:1020
    ds_read_b32 v10, v30 offset:2048
    ds_read_b32 v16, v30 offset:2044
    ds_read_b32 v11, v30 offset:3072
    ds_read_b32 v17, v30 offset:3068
    ds_read_b32 v12, v30 offset:4096
    ds_read_b32 v18, v30 offset:4092
    ds_read_b32 v13, v30 offset:5120
    ds_read_b32 v19, v30 offset:5116
    v_cmp_ne_u32 vcc, 0, v0
    s_waitcnt lgkmcnt(0)
    s_nop 0
    v_cndmask_b32 v14, 0, v14, vcc
    v_add_u32 v14, 1, v14
    v_add_u32 v15, 1, v15
    v_add_u32 v16, 1, v16
    v_add_u32 v17, 1, v17
    v_add_u32 v18, 1, v18
    v_add_u32 v19, 1, v19
    v_and_b32 v14, -2, v14
    v_and_b32 v15, -2, v15
    v_and_b32 v16, -2, v16
    v_and_b32 v17, -2, v17
    v_and_b32 v18, -2, v18
    v_and_b32 v19, -2, v19
    v_sub_u32 v8, v8, v14
    v_sub_u32 v9, v9, v15
    v_sub_u32 v10, v10, v16
    v_sub_u32 v11, v11, v17
    v_sub_u32 v12, v12, v18
    v_sub_u32 v13, v13, v19
    v_lshl_or_b32 v20, v8, 16, v14
    v_lshl_or_b32 v21, v9, 16, v15
    v_lshl_or_b32 v22, v10, 16, v16
    v_lshl_or_b32 v23, v11, 16, v17
    v_lshl_or_b32 v24, v12, 16, v18
    v_lshl_or_b32 v25, v13, 16, v19
    buffer_store_dwordx4 v[20:23], v28, s[20:23], s51 offen
    buffer_store_dwordx2 v[24:25], v28, s[20:23], s51 offen offset:16
    s_min_u32 s18, s34, 106368
    ds_read_b128 v[52:55], v5 offset:0
    ds_read_b128 v[48:51], v5 offset:8192
    ds_read_b128 v[44:47], v5 offset:16384
    ds_read_b128 v[40:43], v5 offset:24576
    s_waitcnt lgkmcnt(3)
    v_perm_b32 v53, v55, v53, s33
    s_mov_b32 s50, 0
    buffer_store_dwordx3 v[52:54], v4, s[16:19], s50 offen sc1
    ds_read_b128 v[36:39], v5 offset:32768
    s_waitcnt lgkmcnt(3)
    v_perm_b32 v49, v51, v49, s33
    s_mov_b32 s50, 6144
    buffer_store_dwordx3 v[48:50], v4, s[16:19], s50 offen sc1
    ds_read_b128 v[32:35], v5 offset:40960
    s_waitcnt lgkmcnt(3)
    v_perm_b32 v45, v47, v45, s33
    s_mov_b32 s50, 12288
    buffer_store_dwordx3 v[44:46], v4, s[16:19], s50 offen sc1
    ds_read_b128 v[52:55], v5 offset:49152
    s_waitcnt lgkmcnt(3)
    v_perm_b32 v41, v43, v41, s33
    s_mov_b32 s50, 18432
    buffer_store_dwordx3 v[40:42], v4, s[16:19], s50 offen sc1
    ds_read_b128 v[48:51], v5 offset:57344
    s_waitcnt lgkmcnt(3)
    v_perm_b32 v37, v39, v37, s33
    s_mov_b32 s50, 24576
    buffer_store_dwordx3 v[36:38], v4, s[16:19], s50 offen sc1
    ds_read_b128 v[8:11], v6 offset:0
    s_waitcnt lgkmcnt(3)
    v_perm_b32 v33, v35, v33, s33
    s_mov_b32 s50, 30720
    buffer_store_dwordx3 v[32:34], v4, s[16:19], s50 offen sc1
    ds_read_b128 v[12:15], v6 offset:8192
    s_waitcnt lgkmcnt(3)
    v_perm_b32 v53, v55, v53, s33
    s_mov_b32 s50, 36864
    buffer_store_dwordx3 v[52:54], v4, s[16:19], s50 offen sc1
    ds_read_b128 v[16:19], v6 offset:16384
    s_waitcnt lgkmcnt(3)
    v_perm_b32 v49, v51, v49, s33
    s_mov_b32 s50, 43008
    buffer_store_dwordx3 v[48:50], v4, s[16:19], s50 offen sc1
    ds_read_b128 v[20:23], v6 offset:24576
    s_waitcnt lgkmcnt(3)
    v_perm_b32 v9, v11, v9, s33
    ds_read_b128 v[24:27], v6 offset:32768
    s_waitcnt lgkmcnt(3)
    v_perm_b32 v13, v15, v13, s33
    ds_read_b128 v[32:35], v6 offset:40960
    s_waitcnt lgkmcnt(3)
    v_perm_b32 v17, v19, v17, s33
    ds_read_b128 v[36:39], v6 offset:49152
    s_waitcnt lgkmcnt(3)
    v_perm_b32 v21, v23, v21, s33
    ds_read_b128 v[40:43], v6 offset:57344
    s_waitcnt lgkmcnt(3)
    v_perm_b32 v25, v27, v25, s33
    ds_read_b128 v[44:47], v7 offset:0
    s_waitcnt lgkmcnt(3)
    v_perm_b32 v33, v35, v33, s33
    ds_read_b128 v[48:51], v7 offset:8192
    s_waitcnt lgkmcnt(3)
    v_perm_b32 v37, v39, v37, s33
    s_waitcnt lgkmcnt(2)
    v_perm_b32 v41, v43, v41, s33
    s_waitcnt lgkmcnt(1)
    v_perm_b32 v45, v47, v45, s33
    s_waitcnt lgkmcnt(0)
    v_perm_b32 v49, v51, v49, s33
    s_barrier
    s_mov_b32 s32, 4294837888
    v_mad_u32_u16 v28, v57, 8, s32
    v_mad_u32_u16 v29, v59, 8, s32
    v_mad_u32_u16 v30, v61, 8, s32
    v_mad_u32_u16 v31, v63, 8, s32
    ds_write_b64 v28, v[56:57]
    ds_write_b64 v29, v[58:59]
    ds_write_b64 v30, v[60:61]
    ds_write_b64 v31, v[62:63]
    s_mov_b32 s50, 49152
    buffer_store_dwordx3 v[8:10], v4, s[16:19], s50 offen sc1
    v_mad_u32_u16 v28, v65, 8, s32
    v_mad_u32_u16 v29, v67, 8, s32
    v_mad_u32_u16 v30, v69, 8, s32
    v_mad_u32_u16 v31, v71, 8, s32
    ds_write_b64 v28, v[64:65]
    ds_write_b64 v29, v[66:67]
    ds_write_b64 v30, v[68:69]
    ds_write_b64 v31, v[70:71]
    v_mad_u32_u16 v28, v73, 8, s32
    v_mad_u32_u16 v29, v75, 8, s32
    v_mad_u32_u16 v30, v77, 8, s32
    v_mad_u32_u16 v31, v79, 8, s32
    ds_write_b64 v28, v[72:73]
    ds_write_b64 v29, v[74:75]
    ds_write_b64 v30, v[76:77]
    ds_write_b64 v31, v[78:79]
    s_mov_b32 s50, 55296
    buffer_store_dwordx3 v[12:14], v4, s[16:19], s50 offen sc1
    v_mad_u32_u16 v28, v81, 8, s32
    v_mad_u32_u16 v29, v83, 8, s32
    v_mad_u32_u16 v30, v85, 8, s32
    v_mad_u32_u16 v31, v87, 8, s32
    ds_write_b64 v28, v[80:81]
    ds_write_b64 v29, v[82:83]
    ds_write_b64 v30, v[84:85]
    ds_write_b64 v31, v[86:87]
    v_mad_u32_u16 v28, v89, 8, s32
    v_mad_u32_u16 v29, v91, 8, s32
    v_mad_u32_u16 v30, v93, 8, s32
    v_mad_u32_u16 v31, v95, 8, s32
    ds_write_b64 v28, v[88:89]
    ds_write_b64 v29, v[90:91]
    ds_write_b64 v30, v[92:93]
    ds_write_b64 v31, v[94:95]
    s_mov_b32 s50, 61440
    buffer_store_dwordx3 v[16:18], v4, s[16:19], s50 offen sc1
    v_mad_u32_u16 v28, v97, 8, s32
    v_mad_u32_u16 v29, v99, 8, s32
    v_mad_u32_u16 v30, v101, 8, s32
    v_mad_u32_u16 v31, v103, 8, s32
    ds_write_b64 v28, v[96:97]
    ds_write_b64 v29, v[98:99]
    ds_write_b64 v30, v[100:101]
    ds_write_b64 v31, v[102:103]
    v_mad_u32_u16 v28, v105, 8, s32
    v_mad_u32_u16 v29, v107, 8, s32
    v_mad_u32_u16 v30, v109, 8, s32
    v_mad_u32_u16 v31, v111, 8, s32
    ds_write_b64 v28, v[104:105]
    ds_write_b64 v29, v[106:107]
    ds_write_b64 v30, v[108:109]
    ds_write_b64 v31, v[110:111]
    s_mov_b32 s50, 67584
    buffer_store_dwordx3 v[20:22], v4, s[16:19], s50 offen sc1
    v_mad_u32_u16 v28, v113, 8, s32
    v_mad_u32_u16 v29, v115, 8, s32
    v_mad_u32_u16 v30, v117, 8, s32
    v_mad_u32_u16 v31, v119, 8, s32
    ds_write_b64 v28, v[112:113]
    ds_write_b64 v29, v[114:115]
    ds_write_b64 v30, v[116:117]
    ds_write_b64 v31, v[118:119]
    v_mad_u32_u16 v28, v121, 8, s32
    v_mad_u32_u16 v29, v123, 8, s32
    v_mad_u32_u16 v30, v125, 8, s32
    v_mad_u32_u16 v31, v127, 8, s32
    ds_write_b64 v28, v[120:121]
    ds_write_b64 v29, v[122:123]
    ds_write_b64 v30, v[124:125]
    ds_write_b64 v31, v[126:127]
    s_mov_b32 s50, 73728
    buffer_store_dwordx3 v[24:26], v4, s[16:19], s50 offen sc1
    v_mad_u32_u16 v28, v129, 8, s32
    v_mad_u32_u16 v29, v131, 8, s32
    v_mad_u32_u16 v30, v133, 8, s32
    v_mad_u32_u16 v31, v135, 8, s32
    ds_write_b64 v28, v[128:129]
    ds_write_b64 v29, v[130:131]
    ds_write_b64 v30, v[132:133]
    ds_write_b64 v31, v[134:135]
    v_mad_u32_u16 v28, v137, 8, s32
    v_mad_u32_u16 v29, v139, 8, s32
    v_mad_u32_u16 v30, v141, 8, s32
    v_mad_u32_u16 v31, v143, 8, s32
    ds_write_b64 v28, v[136:137]
    ds_write_b64 v29, v[138:139]
    ds_write_b64 v30, v[140:141]
    ds_write_b64 v31, v[142:143]
    s_mov_b32 s50, 79872
    buffer_store_dwordx3 v[32:34], v4, s[16:19], s50 offen sc1
    v_mad_u32_u16 v28, v145, 8, s32
    v_mad_u32_u16 v29, v147, 8, s32
    v_mad_u32_u16 v30, v149, 8, s32
    v_mad_u32_u16 v31, v151, 8, s32
    ds_write_b64 v28, v[144:145]
    ds_write_b64 v29, v[146:147]
    ds_write_b64 v30, v[148:149]
    ds_write_b64 v31, v[150:151]
    v_mad_u32_u16 v28, v153, 8, s32
    v_mad_u32_u16 v29, v155, 8, s32
    v_mad_u32_u16 v30, v157, 8, s32
    v_mad_u32_u16 v31, v159, 8, s32
    ds_write_b64 v28, v[152:153]
    ds_write_b64 v29, v[154:155]
    ds_write_b64 v30, v[156:157]
    ds_write_b64 v31, v[158:159]
    s_mov_b32 s50, 86016
    buffer_store_dwordx3 v[36:38], v4, s[16:19], s50 offen sc1
    v_mad_u32_u16 v28, v161, 8, s32
    v_mad_u32_u16 v29, v163, 8, s32
    v_mad_u32_u16 v30, v165, 8, s32
    v_mad_u32_u16 v31, v167, 8, s32
    ds_write_b64 v28, v[160:161]
    ds_write_b64 v29, v[162:163]
    ds_write_b64 v30, v[164:165]
    ds_write_b64 v31, v[166:167]
    v_mad_u32_u16 v28, v169, 8, s32
    v_mad_u32_u16 v29, v171, 8, s32
    v_mad_u32_u16 v30, v173, 8, s32
    v_mad_u32_u16 v31, v175, 8, s32
    ds_write_b64 v28, v[168:169]
    ds_write_b64 v29, v[170:171]
    ds_write_b64 v30, v[172:173]
    ds_write_b64 v31, v[174:175]
    s_mov_b32 s50, 92160
    buffer_store_dwordx3 v[40:42], v4, s[16:19], s50 offen sc1
    v_mad_u32_u16 v28, v177, 8, s32
    v_mad_u32_u16 v29, v179, 8, s32
    v_mad_u32_u16 v30, v181, 8, s32
    v_mad_u32_u16 v31, v183, 8, s32
    ds_write_b64 v28, v[176:177]
    ds_write_b64 v29, v[178:179]
    ds_write_b64 v30, v[180:181]
    ds_write_b64 v31, v[182:183]
    v_mad_u32_u16 v28, v185, 8, s32
    v_mad_u32_u16 v29, v187, 8, s32
    v_mad_u32_u16 v30, v189, 8, s32
    v_mad_u32_u16 v31, v191, 8, s32
    ds_write_b64 v28, v[184:185]
    ds_write_b64 v29, v[186:187]
    ds_write_b64 v30, v[188:189]
    ds_write_b64 v31, v[190:191]
    s_mov_b32 s50, 98304
    buffer_store_dwordx3 v[44:46], v4, s[16:19], s50 offen sc1
    v_mad_u32_u16 v28, v193, 8, s32
    v_mad_u32_u16 v29, v195, 8, s32
    v_mad_u32_u16 v30, v197, 8, s32
    v_mad_u32_u16 v31, v199, 8, s32
    ds_write_b64 v28, v[192:193]
    ds_write_b64 v29, v[194:195]
    ds_write_b64 v30, v[196:197]
    ds_write_b64 v31, v[198:199]
    v_mad_u32_u16 v28, v201, 8, s32
    v_mad_u32_u16 v29, v203, 8, s32
    v_mad_u32_u16 v30, v205, 8, s32
    v_mad_u32_u16 v31, v207, 8, s32
    ds_write_b64 v28, v[200:201]
    ds_write_b64 v29, v[202:203]
    ds_write_b64 v30, v[204:205]
    ds_write_b64 v31, v[206:207]
    s_mov_b32 s50, 104448
    buffer_store_dwordx3 v[48:50], v4, s[16:19], s50 offen sc1
    v_mad_u32_u16 v28, v209, 8, s32
    v_mad_u32_u16 v29, v211, 8, s32
    v_mad_u32_u16 v30, v213, 8, s32
    v_mad_u32_u16 v31, v215, 8, s32
    ds_write_b64 v28, v[208:209]
    ds_write_b64 v29, v[210:211]
    ds_write_b64 v30, v[212:213]
    ds_write_b64 v31, v[214:215]
    v_mad_u32_u16 v28, v217, 8, s32
    v_mad_u32_u16 v29, v219, 8, s32
    v_mad_u32_u16 v30, v221, 8, s32
    v_mad_u32_u16 v31, v223, 8, s32
    ds_write_b64 v28, v[216:217]
    ds_write_b64 v29, v[218:219]
    ds_write_b64 v30, v[220:221]
    ds_write_b64 v31, v[222:223]
    v_mad_u32_u16 v28, v225, 8, s32
    v_mad_u32_u16 v29, v227, 8, s32
    v_mad_u32_u16 v30, v229, 8, s32
    v_mad_u32_u16 v31, v231, 8, s32
    ds_write_b64 v28, v[224:225]
    ds_write_b64 v29, v[226:227]
    ds_write_b64 v30, v[228:229]
    ds_write_b64 v31, v[230:231]
    v_mad_u32_u16 v28, v233, 8, s32
    v_mad_u32_u16 v29, v235, 8, s32
    v_mad_u32_u16 v30, v237, 8, s32
    v_mad_u32_u16 v31, v239, 8, s32
    ds_write_b64 v28, v[232:233]
    ds_write_b64 v29, v[234:235]
    ds_write_b64 v30, v[236:237]
    ds_write_b64 v31, v[238:239]
    v_mad_u32_u16 v28, v241, 8, s32
    v_mad_u32_u16 v29, v243, 8, s32
    v_mad_u32_u16 v30, v245, 8, s32
    v_mad_u32_u16 v31, v247, 8, s32
    ds_write_b64 v28, v[240:241]
    ds_write_b64 v29, v[242:243]
    ds_write_b64 v30, v[244:245]
    ds_write_b64 v31, v[246:247]
    v_mad_u32_u16 v28, v249, 8, s32
    v_mad_u32_u16 v29, v251, 8, s32
    v_mad_u32_u16 v30, v253, 8, s32
    v_mad_u32_u16 v31, v255, 8, s32
    ds_write_b64 v28, v[248:249]
    ds_write_b64 v29, v[250:251]
    ds_write_b64 v30, v[252:253]
    ds_write_b64 v31, v[254:255]
    s_waitcnt lgkmcnt(0)
    s_barrier
    s_min_u32 s18, s34, 212736
    ds_read_b128 v[52:55], v5 offset:0
    ds_read_b128 v[48:51], v5 offset:8192
    ds_read_b128 v[44:47], v5 offset:16384
    ds_read_b128 v[40:43], v5 offset:24576
    s_waitcnt lgkmcnt(3)
    v_perm_b32 v53, v55, v53, s33
    s_mov_b32 s50, 106368
    buffer_store_dwordx3 v[52:54], v4, s[16:19], s50 offen sc1
    ds_read_b128 v[36:39], v5 offset:32768
    s_waitcnt lgkmcnt(3)
    v_perm_b32 v49, v51, v49, s33
    s_mov_b32 s50, 112512
    buffer_store_dwordx3 v[48:50], v4, s[16:19], s50 offen sc1
    ds_read_b128 v[32:35], v5 offset:40960
    s_waitcnt lgkmcnt(3)
    v_perm_b32 v45, v47, v45, s33
    s_mov_b32 s50, 118656
    buffer_store_dwordx3 v[44:46], v4, s[16:19], s50 offen sc1
    ds_read_b128 v[52:55], v5 offset:49152
    s_waitcnt lgkmcnt(3)
    v_perm_b32 v41, v43, v41, s33
    s_mov_b32 s50, 124800
    buffer_store_dwordx3 v[40:42], v4, s[16:19], s50 offen sc1
    ds_read_b128 v[48:51], v5 offset:57344
    s_waitcnt lgkmcnt(3)
    v_perm_b32 v37, v39, v37, s33
    s_mov_b32 s50, 130944
    buffer_store_dwordx3 v[36:38], v4, s[16:19], s50 offen sc1
    ds_read_b128 v[8:11], v6 offset:0
    s_waitcnt lgkmcnt(3)
    v_perm_b32 v33, v35, v33, s33
    s_mov_b32 s50, 137088
    buffer_store_dwordx3 v[32:34], v4, s[16:19], s50 offen sc1
    ds_read_b128 v[12:15], v6 offset:8192
    s_waitcnt lgkmcnt(3)
    v_perm_b32 v53, v55, v53, s33
    s_mov_b32 s50, 143232
    buffer_store_dwordx3 v[52:54], v4, s[16:19], s50 offen sc1
    ds_read_b128 v[16:19], v6 offset:16384
    s_waitcnt lgkmcnt(3)
    v_perm_b32 v49, v51, v49, s33
    s_mov_b32 s50, 149376
    buffer_store_dwordx3 v[48:50], v4, s[16:19], s50 offen sc1
    ds_read_b128 v[20:23], v6 offset:24576
    s_waitcnt lgkmcnt(3)
    v_perm_b32 v9, v11, v9, s33
    ds_read_b128 v[24:27], v6 offset:32768
    s_waitcnt lgkmcnt(3)
    v_perm_b32 v13, v15, v13, s33
    ds_read_b128 v[32:35], v6 offset:40960
    s_waitcnt lgkmcnt(3)
    v_perm_b32 v17, v19, v17, s33
    ds_read_b128 v[36:39], v6 offset:49152
    s_waitcnt lgkmcnt(3)
    v_perm_b32 v21, v23, v21, s33
    ds_read_b128 v[40:43], v6 offset:57344
    s_waitcnt lgkmcnt(3)
    v_perm_b32 v25, v27, v25, s33
    ds_read_b128 v[44:47], v7 offset:0
    s_waitcnt lgkmcnt(3)
    v_perm_b32 v33, v35, v33, s33
    ds_read_b128 v[48:51], v7 offset:8192
    s_waitcnt lgkmcnt(3)
    v_perm_b32 v37, v39, v37, s33
    s_waitcnt lgkmcnt(2)
    v_perm_b32 v41, v43, v41, s33
    s_waitcnt lgkmcnt(1)
    v_perm_b32 v45, v47, v45, s33
    s_waitcnt lgkmcnt(0)
    v_perm_b32 v49, v51, v49, s33
    s_barrier
    s_mov_b32 s32, 4294696064
    v_mad_u32_u16 v28, v57, 8, s32
    v_mad_u32_u16 v29, v59, 8, s32
    v_mad_u32_u16 v30, v61, 8, s32
    v_mad_u32_u16 v31, v63, 8, s32
    ds_write_b64 v28, v[56:57]
    ds_write_b64 v29, v[58:59]
    ds_write_b64 v30, v[60:61]
    ds_write_b64 v31, v[62:63]
    s_mov_b32 s50, 155520
    buffer_store_dwordx3 v[8:10], v4, s[16:19], s50 offen sc1
    v_mad_u32_u16 v28, v65, 8, s32
    v_mad_u32_u16 v29, v67, 8, s32
    v_mad_u32_u16 v30, v69, 8, s32
    v_mad_u32_u16 v31, v71, 8, s32
    ds_write_b64 v28, v[64:65]
    ds_write_b64 v29, v[66:67]
    ds_write_b64 v30, v[68:69]
    ds_write_b64 v31, v[70:71]
    v_mad_u32_u16 v28, v73, 8, s32
    v_mad_u32_u16 v29, v75, 8, s32
    v_mad_u32_u16 v30, v77, 8, s32
    v_mad_u32_u16 v31, v79, 8, s32
    ds_write_b64 v28, v[72:73]
    ds_write_b64 v29, v[74:75]
    ds_write_b64 v30, v[76:77]
    ds_write_b64 v31, v[78:79]
    s_mov_b32 s50, 161664
    buffer_store_dwordx3 v[12:14], v4, s[16:19], s50 offen sc1
    v_mad_u32_u16 v28, v81, 8, s32
    v_mad_u32_u16 v29, v83, 8, s32
    v_mad_u32_u16 v30, v85, 8, s32
    v_mad_u32_u16 v31, v87, 8, s32
    ds_write_b64 v28, v[80:81]
    ds_write_b64 v29, v[82:83]
    ds_write_b64 v30, v[84:85]
    ds_write_b64 v31, v[86:87]
    v_mad_u32_u16 v28, v89, 8, s32
    v_mad_u32_u16 v29, v91, 8, s32
    v_mad_u32_u16 v30, v93, 8, s32
    v_mad_u32_u16 v31, v95, 8, s32
    ds_write_b64 v28, v[88:89]
    ds_write_b64 v29, v[90:91]
    ds_write_b64 v30, v[92:93]
    ds_write_b64 v31, v[94:95]
    s_mov_b32 s50, 167808
    buffer_store_dwordx3 v[16:18], v4, s[16:19], s50 offen sc1
    v_mad_u32_u16 v28, v97, 8, s32
    v_mad_u32_u16 v29, v99, 8, s32
    v_mad_u32_u16 v30, v101, 8, s32
    v_mad_u32_u16 v31, v103, 8, s32
    ds_write_b64 v28, v[96:97]
    ds_write_b64 v29, v[98:99]
    ds_write_b64 v30, v[100:101]
    ds_write_b64 v31, v[102:103]
    v_mad_u32_u16 v28, v105, 8, s32
    v_mad_u32_u16 v29, v107, 8, s32
    v_mad_u32_u16 v30, v109, 8, s32
    v_mad_u32_u16 v31, v111, 8, s32
    ds_write_b64 v28, v[104:105]
    ds_write_b64 v29, v[106:107]
    ds_write_b64 v30, v[108:109]
    ds_write_b64 v31, v[110:111]
    s_mov_b32 s50, 173952
    buffer_store_dwordx3 v[20:22], v4, s[16:19], s50 offen sc1
    v_mad_u32_u16 v28, v113, 8, s32
    v_mad_u32_u16 v29, v115, 8, s32
    v_mad_u32_u16 v30, v117, 8, s32
    v_mad_u32_u16 v31, v119, 8, s32
    ds_write_b64 v28, v[112:113]
    ds_write_b64 v29, v[114:115]
    ds_write_b64 v30, v[116:117]
    ds_write_b64 v31, v[118:119]
    v_mad_u32_u16 v28, v121, 8, s32
    v_mad_u32_u16 v29, v123, 8, s32
    v_mad_u32_u16 v30, v125, 8, s32
    v_mad_u32_u16 v31, v127, 8, s32
    ds_write_b64 v28, v[120:121]
    ds_write_b64 v29, v[122:123]
    ds_write_b64 v30, v[124:125]
    ds_write_b64 v31, v[126:127]
    s_mov_b32 s50, 180096
    buffer_store_dwordx3 v[24:26], v4, s[16:19], s50 offen sc1
    v_mad_u32_u16 v28, v129, 8, s32
    v_mad_u32_u16 v29, v131, 8, s32
    v_mad_u32_u16 v30, v133, 8, s32
    v_mad_u32_u16 v31, v135, 8, s32
    ds_write_b64 v28, v[128:129]
    ds_write_b64 v29, v[130:131]
    ds_write_b64 v30, v[132:133]
    ds_write_b64 v31, v[134:135]
    v_mad_u32_u16 v28, v137, 8, s32
    v_mad_u32_u16 v29, v139, 8, s32
    v_mad_u32_u16 v30, v141, 8, s32
    v_mad_u32_u16 v31, v143, 8, s32
    ds_write_b64 v28, v[136:137]
    ds_write_b64 v29, v[138:139]
    ds_write_b64 v30, v[140:141]
    ds_write_b64 v31, v[142:143]
    s_mov_b32 s50, 186240
    buffer_store_dwordx3 v[32:34], v4, s[16:19], s50 offen sc1
    v_mad_u32_u16 v28, v145, 8, s32
    v_mad_u32_u16 v29, v147, 8, s32
    v_mad_u32_u16 v30, v149, 8, s32
    v_mad_u32_u16 v31, v151, 8, s32
    ds_write_b64 v28, v[144:145]
    ds_write_b64 v29, v[146:147]
    ds_write_b64 v30, v[148:149]
    ds_write_b64 v31, v[150:151]
    v_mad_u32_u16 v28, v153, 8, s32
    v_mad_u32_u16 v29, v155, 8, s32
    v_mad_u32_u16 v30, v157, 8, s32
    v_mad_u32_u16 v31, v159, 8, s32
    ds_write_b64 v28, v[152:153]
    ds_write_b64 v29, v[154:155]
    ds_write_b64 v30, v[156:157]
    ds_write_b64 v31, v[158:159]
    s_mov_b32 s50, 192384
    buffer_store_dwordx3 v[36:38], v4, s[16:19], s50 offen sc1
    v_mad_u32_u16 v28, v161, 8, s32
    v_mad_u32_u16 v29, v163, 8, s32
    v_mad_u32_u16 v30, v165, 8, s32
    v_mad_u32_u16 v31, v167, 8, s32
    ds_write_b64 v28, v[160:161]
    ds_write_b64 v29, v[162:163]
    ds_write_b64 v30, v[164:165]
    ds_write_b64 v31, v[166:167]
    v_mad_u32_u16 v28, v169, 8, s32
    v_mad_u32_u16 v29, v171, 8, s32
    v_mad_u32_u16 v30, v173, 8, s32
    v_mad_u32_u16 v31, v175, 8, s32
    ds_write_b64 v28, v[168:169]
    ds_write_b64 v29, v[170:171]
    ds_write_b64 v30, v[172:173]
    ds_write_b64 v31, v[174:175]
    s_mov_b32 s50, 198528
    buffer_store_dwordx3 v[40:42], v4, s[16:19], s50 offen sc1
    v_mad_u32_u16 v28, v177, 8, s32
    v_mad_u32_u16 v29, v179, 8, s32
    v_mad_u32_u16 v30, v181, 8, s32
    v_mad_u32_u16 v31, v183, 8, s32
    ds_write_b64 v28, v[176:177]
    ds_write_b64 v29, v[178:179]
    ds_write_b64 v30, v[180:181]
    ds_write_b64 v31, v[182:183]
    v_mad_u32_u16 v28, v185, 8, s32
    v_mad_u32_u16 v29, v187, 8, s32
    v_mad_u32_u16 v30, v189, 8, s32
    v_mad_u32_u16 v31, v191, 8, s32
    ds_write_b64 v28, v[184:185]
    ds_write_b64 v29, v[186:187]
    ds_write_b64 v30, v[188:189]
    ds_write_b64 v31, v[190:191]
    s_mov_b32 s50, 204672
    buffer_store_dwordx3 v[44:46], v4, s[16:19], s50 offen sc1
    v_mad_u32_u16 v28, v193, 8, s32
    v_mad_u32_u16 v29, v195, 8, s32
    v_mad_u32_u16 v30, v197, 8, s32
    v_mad_u32_u16 v31, v199, 8, s32
    ds_write_b64 v28, v[192:193]
    ds_write_b64 v29, v[194:195]
    ds_write_b64 v30, v[196:197]
    ds_write_b64 v31, v[198:199]
    v_mad_u32_u16 v28, v201, 8, s32
    v_mad_u32_u16 v29, v203, 8, s32
    v_mad_u32_u16 v30, v205, 8, s32
    v_mad_u32_u16 v31, v207, 8, s32
    ds_write_b64 v28, v[200:201]
    ds_write_b64 v29, v[202:203]
    ds_write_b64 v30, v[204:205]
    ds_write_b64 v31, v[206:207]
    s_mov_b32 s50, 210816
    buffer_store_dwordx3 v[48:50], v4, s[16:19], s50 offen sc1
    v_mad_u32_u16 v28, v209, 8, s32
    v_mad_u32_u16 v29, v211, 8, s32
    v_mad_u32_u16 v30, v213, 8, s32
    v_mad_u32_u16 v31, v215, 8, s32
    ds_write_b64 v28, v[208:209]
    ds_write_b64 v29, v[210:211]
    ds_write_b64 v30, v[212:213]
    ds_write_b64 v31, v[214:215]
    v_mad_u32_u16 v28, v217, 8, s32
    v_mad_u32_u16 v29, v219, 8, s32
    v_mad_u32_u16 v30, v221, 8, s32
    v_mad_u32_u16 v31, v223, 8, s32
    ds_write_b64 v28, v[216:217]
    ds_write_b64 v29, v[218:219]
    ds_write_b64 v30, v[220:221]
    ds_write_b64 v31, v[222:223]
    v_mad_u32_u16 v28, v225, 8, s32
    v_mad_u32_u16 v29, v227, 8, s32
    v_mad_u32_u16 v30, v229, 8, s32
    v_mad_u32_u16 v31, v231, 8, s32
    ds_write_b64 v28, v[224:225]
    ds_write_b64 v29, v[226:227]
    ds_write_b64 v30, v[228:229]
    ds_write_b64 v31, v[230:231]
    v_mad_u32_u16 v28, v233, 8, s32
    v_mad_u32_u16 v29, v235, 8, s32
    v_mad_u32_u16 v30, v237, 8, s32
    v_mad_u32_u16 v31, v239, 8, s32
    ds_write_b64 v28, v[232:233]
    ds_write_b64 v29, v[234:235]
    ds_write_b64 v30, v[236:237]
    ds_write_b64 v31, v[238:239]
    v_mad_u32_u16 v28, v241, 8, s32
    v_mad_u32_u16 v29, v243, 8, s32
    v_mad_u32_u16 v30, v245, 8, s32
    v_mad_u32_u16 v31, v247, 8, s32
    ds_write_b64 v28, v[240:241]
    ds_write_b64 v29, v[242:243]
    ds_write_b64 v30, v[244:245]
    ds_write_b64 v31, v[246:247]
    v_mad_u32_u16 v28, v249, 8, s32
    v_mad_u32_u16 v29, v251, 8, s32
    v_mad_u32_u16 v30, v253, 8, s32
    v_mad_u32_u16 v31, v255, 8, s32
    ds_write_b64 v28, v[248:249]
    ds_write_b64 v29, v[250:251]
    ds_write_b64 v30, v[252:253]
    ds_write_b64 v31, v[254:255]
    s_waitcnt lgkmcnt(0)
    s_barrier
    s_min_u32 s18, s34, 319104
    ds_read_b128 v[52:55], v5 offset:0
    ds_read_b128 v[48:51], v5 offset:8192
    ds_read_b128 v[44:47], v5 offset:16384
    ds_read_b128 v[40:43], v5 offset:24576
    s_waitcnt lgkmcnt(3)
    v_perm_b32 v53, v55, v53, s33
    s_mov_b32 s50, 212736
    buffer_store_dwordx3 v[52:54], v4, s[16:19], s50 offen sc1
    ds_read_b128 v[36:39], v5 offset:32768
    s_waitcnt lgkmcnt(3)
    v_perm_b32 v49, v51, v49, s33
    s_mov_b32 s50, 218880
    buffer_store_dwordx3 v[48:50], v4, s[16:19], s50 offen sc1
    ds_read_b128 v[32:35], v5 offset:40960
    s_waitcnt lgkmcnt(3)
    v_perm_b32 v45, v47, v45, s33
    s_mov_b32 s50, 225024
    buffer_store_dwordx3 v[44:46], v4, s[16:19], s50 offen sc1
    ds_read_b128 v[52:55], v5 offset:49152
    s_waitcnt lgkmcnt(3)
    v_perm_b32 v41, v43, v41, s33
    s_mov_b32 s50, 231168
    buffer_store_dwordx3 v[40:42], v4, s[16:19], s50 offen sc1
    ds_read_b128 v[48:51], v5 offset:57344
    s_waitcnt lgkmcnt(3)
    v_perm_b32 v37, v39, v37, s33
    s_mov_b32 s50, 237312
    buffer_store_dwordx3 v[36:38], v4, s[16:19], s50 offen sc1
    ds_read_b128 v[44:47], v6 offset:0
    s_waitcnt lgkmcnt(3)
    v_perm_b32 v33, v35, v33, s33
    s_mov_b32 s50, 243456
    buffer_store_dwordx3 v[32:34], v4, s[16:19], s50 offen sc1
    ds_read_b128 v[40:43], v6 offset:8192
    s_waitcnt lgkmcnt(3)
    v_perm_b32 v53, v55, v53, s33
    s_mov_b32 s50, 249600
    buffer_store_dwordx3 v[52:54], v4, s[16:19], s50 offen sc1
    ds_read_b128 v[36:39], v6 offset:16384
    s_waitcnt lgkmcnt(3)
    v_perm_b32 v49, v51, v49, s33
    s_mov_b32 s50, 255744
    buffer_store_dwordx3 v[48:50], v4, s[16:19], s50 offen sc1
    ds_read_b128 v[32:35], v6 offset:24576
    s_waitcnt lgkmcnt(3)
    v_perm_b32 v45, v47, v45, s33
    s_mov_b32 s50, 261888
    buffer_store_dwordx3 v[44:46], v4, s[16:19], s50 offen sc1
    ds_read_b128 v[52:55], v6 offset:32768
    s_waitcnt lgkmcnt(3)
    v_perm_b32 v41, v43, v41, s33
    s_mov_b32 s50, 268032
    buffer_store_dwordx3 v[40:42], v4, s[16:19], s50 offen sc1
    ds_read_b128 v[48:51], v6 offset:40960
    s_waitcnt lgkmcnt(3)
    v_perm_b32 v37, v39, v37, s33
    s_mov_b32 s50, 274176
    buffer_store_dwordx3 v[36:38], v4, s[16:19], s50 offen sc1
    ds_read_b128 v[44:47], v6 offset:49152
    s_waitcnt lgkmcnt(3)
    v_perm_b32 v33, v35, v33, s33
    s_mov_b32 s50, 280320
    buffer_store_dwordx3 v[32:34], v4, s[16:19], s50 offen sc1
    ds_read_b128 v[40:43], v6 offset:57344
    s_waitcnt lgkmcnt(3)
    v_perm_b32 v53, v55, v53, s33
    s_mov_b32 s50, 286464
    buffer_store_dwordx3 v[52:54], v4, s[16:19], s50 offen sc1
    ds_read_b128 v[36:39], v7 offset:0
    s_waitcnt lgkmcnt(3)
    v_perm_b32 v49, v51, v49, s33
    s_mov_b32 s50, 292608
    buffer_store_dwordx3 v[48:50], v4, s[16:19], s50 offen sc1
    ds_read_b128 v[32:35], v7 offset:8192
    s_waitcnt lgkmcnt(3)
    v_perm_b32 v45, v47, v45, s33
    s_mov_b32 s50, 298752
    buffer_store_dwordx3 v[44:46], v4, s[16:19], s50 offen sc1
    s_waitcnt lgkmcnt(2)
    v_perm_b32 v41, v43, v41, s33
    s_mov_b32 s50, 304896
    buffer_store_dwordx3 v[40:42], v4, s[16:19], s50 offen sc1
    s_waitcnt lgkmcnt(1)
    v_perm_b32 v37, v39, v37, s33
    s_mov_b32 s50, 311040
    buffer_store_dwordx3 v[36:38], v4, s[16:19], s50 offen sc1
    s_waitcnt lgkmcnt(0)
    v_perm_b32 v33, v35, v33, s33
    s_mov_b32 s50, 317184
    buffer_store_dwordx3 v[32:34], v4, s[16:19], s50 offen sc1
A_end:
    s_endpgm
.section .rodata,"a"
.p2align 6
.amdhsa_kernel bin_kernel
  .amdhsa_next_free_vgpr 256
  .amdhsa_next_free_sgpr 80
  .amdhsa_accum_offset 256
  .amdhsa_group_segment_fixed_size 0
  .amdhsa_kernarg_size 112
  .amdhsa_user_sgpr_count 2
  .amdhsa_user_sgpr_kernarg_segment_ptr 1
  .amdhsa_system_sgpr_workgroup_id_x 1
.end_amdhsa_kernel
.text
.globl agg_kernel
.p2align 8
.type agg_kernel,@function
agg_kernel:
    s_cmp_ge_u32 s2, 256
    s_cbranch_scc1 B_end
    s_load_dwordx2 s[56:57], s[0:1], 104
    s_load_dwordx2 s[54:55], s[0:1], 0
    s_load_dwordx2 s[58:59], s[0:1], 24
    s_load_dwordx4 s[60:63], s[0:1], 40
    s_load_dwordx8 s[64:71], s[0:1], 56
    s_and_b32 s35, s2, 7
    s_lshl_b32 s35, s35, 5
    s_lshr_b32 s36, s2, 3
    s_add_u32 s35, s35, s36
    s_add_u32 s35, s35, 8
    s_and_b32 s35, s35, 255
    v_lshrrev_b32 v34, 6, v0
    v_lshrrev_b32 v35, 1, v0
    v_mul_u32_u24 v35, 12288, v35
    v_and_b32 v36, 1, v0
    v_mad_u32_u24 v35, v36, 24, v35
    v_lshlrev_b32 v36, 2, v0
    v_readfirstlane_b32 s3, v34
    s_mul_i32 s36, s35, 48
    v_and_b32 v37, 63, v0
    v_and_b32 v38, 15, v0
    v_lshrrev_b32 v39, 5, v37
    v_lshrrev_b32 v33, 4, v37
    v_lshlrev_b32 v41, 1, v38
    v_lshl_add_u32 v40, v39, 8, v41
    s_mul_i32 s51, s3, 25
    s_sub_i32 s37, s3, 4
    s_max_i32 s37, s37, 0
    s_sub_u32 s51, s51, s37
    s_mul_i32 s100, s35, 3125
    s_add_u32 s101, s100, 3125
    s_and_b32 s100, s100, -4
    s_and_b32 s101, s101, -4
    s_sub_u32 s101, s101, s100
    s_lshl_b32 s37, s100, 1
    s_lshl_b32 s38, s101, 1
    s_waitcnt lgkmcnt(0)
    s_add_u32 s12, s56, 81592576
    s_addc_u32 s13, s57, 0
    s_mov_b32 s14, 3145728
    s_mov_b32 s15, 0x20000
    s_load_dword s99, s[62:63], 0
    s_mov_b32 s39, s36
    buffer_load_dwordx4 v[104:107], v35, s[12:15], s39 offen
    buffer_load_dwordx2 v[108:109], v35, s[12:15], s39 offen offset:16
    s_mov_b32 s76, s68
    s_mov_b32 s77, s69
    s_mov_b32 s78, 512
    s_mov_b32 s79, 0x20000
    buffer_load_ushort v72, v40, s[76:79], 0 offen offset:0
    buffer_load_ushort v73, v40, s[76:79], 0 offen offset:32
    buffer_load_ushort v74, v40, s[76:79], 0 offen offset:64
    buffer_load_ushort v75, v40, s[76:79], 0 offen offset:96
    buffer_load_ushort v76, v40, s[76:79], 0 offen offset:128
    buffer_load_ushort v77, v40, s[76:79], 0 offen offset:160
    buffer_load_ushort v78, v40, s[76:79], 0 offen offset:192
    buffer_load_ushort v79, v40, s[76:79], 0 offen offset:224
    s_add_u32 s80, s58, s37
    s_addc_u32 s81, s59, 0
    s_mov_b32 s82, s38
    s_mov_b32 s83, 0x20000
    s_lshl_b32 s36, s51, 5
    v_lshlrev_b32 v32, 4, v37
    v_mov_b32 v96, v32
    buffer_load_dwordx4 v[80:83], v32, s[80:83], s36 offen
    v_lshl_add_u32 v42, v33, 7, v41
    v_lshl_add_u32 v43, v33, 6, v41
    v_lshlrev_b32 v44, 2, v33
    s_mov_b32 s84, s70
    s_mov_b32 s85, s71
    s_mov_b32 s86, 512
    s_mov_b32 s87, 0x20000
    buffer_load_ushort v84, v42, s[84:87], 0 offen offset:0
    buffer_load_ushort v85, v42, s[84:87], 0 offen offset:32
    buffer_load_ushort v86, v42, s[84:87], 0 offen offset:64
    buffer_load_ushort v87, v42, s[84:87], 0 offen offset:96
    s_mov_b32 s88, s66
    s_mov_b32 s89, s67
    s_mov_b32 s90, 512
    s_mov_b32 s91, 0x20000
    buffer_load_ushort v88, v42, s[88:91], 0 offen offset:0
    buffer_load_ushort v89, v42, s[88:91], 0 offen offset:32
    buffer_load_ushort v90, v42, s[88:91], 0 offen offset:64
    buffer_load_ushort v91, v42, s[88:91], 0 offen offset:96
    s_mov_b32 s72, s64
    s_mov_b32 s73, s65
    s_mov_b32 s74, 256
    s_mov_b32 s75, 0x20000
    buffer_load_ushort v92, v43, s[72:75], 0 offen offset:0
    buffer_load_ushort v93, v43, s[72:75], 0 offen offset:32
    s_mov_b32 s44, s60
    s_mov_b32 s45, s61
    s_mov_b32 s46, 16
    s_mov_b32 s47, 0x20000
    buffer_load_ushort v94, v44, s[44:47], 0 offen offset:0
    buffer_load_ushort v95, v44, s[44:47], 0 offen offset:2
    s_mov_b32 s4, s54
    s_mov_b32 s5, s55
    s_mov_b32 s6, 25600000
    s_mov_b32 s7, 0x20000
    s_mov_b32 s8, s56
    s_mov_b32 s9, s57
    s_mov_b32 s10, 81592336
    s_mov_b32 s11, 0x20000
    v_lshlrev_b32 v41, 4, v0
    v_mov_b32 v42, 0
    v_mov_b32 v43, 0
    v_mov_b32 v44, 0
    v_mov_b32 v45, 0
    v_add_u32 v52, 1664, v41
    v_add_u32 v53, 51840, v41
    s_mul_i32 s39, s3, 3328
    s_add_u32 s39, s39, 118400
    v_add_u32 v54, s39, v32
    ds_write_b128 v52, v[42:45] offset:0
    ds_write_b128 v52, v[42:45] offset:8192
    ds_write_b128 v52, v[42:45] offset:16384
    ds_write_b128 v52, v[42:45] offset:24576
    ds_write_b128 v52, v[42:45] offset:32768
    ds_write_b128 v52, v[42:45] offset:40960
    ds_write_b128 v54, v[42:45] offset:0
    ds_write_b128 v54, v[42:45] offset:1024
    ds_write_b128 v54, v[42:45] offset:2048
    s_mov_b64 exec, 65535
    ds_write_b128 v54, v[42:45] offset:3072
    s_mov_b64 exec, -1
    v_mov_b32 v98, v53
    v_cmp_gt_u32 s[14:15], 64, v0
    s_mov_b64 exec, s[14:15]
    ds_write_b128 v52, v[42:45] offset:49152
    s_mov_b64 exec, -1
    v_and_b32 v52, 31, v0
    v_lshlrev_b32 v52, 3, v52
    v_cmp_gt_u32 vcc, 200, v0
    s_mov_b64 exec, vcc
    ds_write_b32 v36, v52 offset:0
    ds_write_b32 v36, v52 offset:800
    ds_write_b96 v42, v[42:44] offset:1600
    s_mov_b64 exec, -1
    s_mov_b32 s16, 0
    s_mov_b32 s21, 1
    s_mov_b32 s18, 0xffffffe0
    s_mov_b32 s19, 2097152
    s_mov_b32 s20, 0xf8
    s_mov_b32 s22, 0xffff
    s_mov_b32 s27, 0
    s_mov_b32 s28, 0
    s_mov_b64 s[30:31], -1
    s_mov_b64 s[32:33], 0
    s_mov_b32 s34, 0
    s_mul_i32 s48, s3, 1024
    s_add_u32 s48, s48, 145024
    s_cmp_lt_u32 s3, 4
    s_cselect_b32 s37, 25, 24
    s_cselect_b32 s50, 0, 0x100
    s_bfm_b32 s52, s37, 0
    s_mov_b32 s53, 0
    s_lshl_b32 s36, s51, 8
    v_and_b32 v52, 31, v37
    v_lshl_add_u32 v2, v52, 3, s36
    v_lshlrev_b32 v3, 4, v39
    s_lshl_b32 s36, s3, 11
    s_add_u32 s36, s36, 102016
    s_sub_u32 s37, s36, 65280
    v_lshl_add_u32 v53, v39, 10, s37
    v_bfe_u32 v54, v52, 2, 2
    v_lshl_add_u32 v53, v54, 8, v53
    v_lshrrev_b32 v54, 4, v52
    v_lshl_add_u32 v53, v54, 3, v53
    v_and_b32 v54, 3, v52
    v_lshl_add_u32 v4, v54, 1, v53
    v_lshl_add_u32 v54, v33, 8, s36
    v_lshl_add_u32 v5, v38, 4, v54
    v_lshlrev_b32 v6, 3, v33
    v_lshl_or_b32 v6, v38, 17, v6
    s_add_u32 s23, s39, 224
    s_add_u32 s49, s23, 3072
    v_and_b32 v53, 1, v33
    v_cmp_eq_u32 s[56:57], 0, v53
    v_lshrrev_b32 v52, 1, v0
    s_mov_b32 s36, 318720
    v_mul_u32_u24 v120, s36, v52
    v_and_b32 v53, 1, v0
    v_mul_u32_u24 v54, 1536, v53
    v_lshrrev_b32 v55, 1, v37
    v_lshl_add_u32 v54, v55, 3, v54
    v_add_u32 v121, s23, v54
    s_mov_b32 s25, s23
    s_mov_b32 s26, s49
    s_sub_u32 s13, s23, 32
    s_waitcnt vmcnt(21)
    v_lshrrev_b32 v110, 16, v104
    v_lshrrev_b32 v111, 16, v105
    v_lshrrev_b32 v112, 16, v106
    v_lshrrev_b32 v113, 16, v107
    v_lshrrev_b32 v114, 16, v108
    v_lshrrev_b32 v115, 16, v109
    v_max3_u32 v116, v110, v111, v112
    v_max3_u32 v116, v116, v113, v114
    v_max_u32 v116, v116, v115
    v_cmp_lt_u32 vcc, 32, v116
    s_cbranch_vccnz B_x
B_xb:
    v_max_u32 v119, 1, v110
    v_mad_u32_u16 v118, v104, 6, v120
    v_subrev_u32 v119, 1, v119
    v_lshl_or_b32 v119, v119, 16, v110
    ds_write_b64 v121, v[118:119] offset:0
    s_waitcnt lgkmcnt(0)
    s_mov_b32 s36, s13
    v_add_u32_sdwa v0, s36, v6 dst_sel:DWORD dst_unused:UNUSED_PAD src0_sel:DWORD src1_sel:WORD_0
    ds_read_b64 v[54:55], v0
    s_add_u32 s36, s23, 0
    v_add_u32_sdwa v0, s36, v6 dst_sel:DWORD dst_unused:UNUSED_PAD src0_sel:DWORD src1_sel:WORD_0
    ds_read_b64 v[56:57], v0
    s_add_u32 s36, s23, 32
    v_add_u32_sdwa v0, s36, v6 dst_sel:DWORD dst_unused:UNUSED_PAD src0_sel:DWORD src1_sel:WORD_0
    ds_read_b64 v[58:59], v0
    s_add_u32 s36, s23, 64
    v_add_u32_sdwa v0, s36, v6 dst_sel:DWORD dst_unused:UNUSED_PAD src0_sel:DWORD src1_sel:WORD_0
    ds_read_b64 v[60:61], v0
    s_add_u32 s36, s23, 96
    v_add_u32_sdwa v0, s36, v6 dst_sel:DWORD dst_unused:UNUSED_PAD src0_sel:DWORD src1_sel:WORD_0
    ds_read_b64 v[62:63], v0
    s_add_u32 s36, s23, 128
    v_add_u32_sdwa v0, s36, v6 dst_sel:DWORD dst_unused:UNUSED_PAD src0_sel:DWORD src1_sel:WORD_0
    ds_read_b64 v[64:65], v0
    s_add_u32 s36, s23, 160
    v_add_u32_sdwa v0, s36, v6 dst_sel:DWORD dst_unused:UNUSED_PAD src0_sel:DWORD src1_sel:WORD_0
    ds_read_b64 v[66:67], v0
    s_add_u32 s36, s23, 192
    v_add_u32_sdwa v0, s36, v6 dst_sel:DWORD dst_unused:UNUSED_PAD src0_sel:DWORD src1_sel:WORD_0
    ds_read_b64 v[68:69], v0
    s_add_u32 s36, s23, 224
    v_add_u32_sdwa v0, s36, v6 dst_sel:DWORD dst_unused:UNUSED_PAD src0_sel:DWORD src1_sel:WORD_0
    ds_read_b64 v[70:71], v0
    s_waitcnt lgkmcnt(8)
    v_cmp_lt_u32_sdwa s[40:41], v6, v55 src0_sel:WORD_1 src1_sel:WORD_0
    v_mad_u32_u16 v0, v6, 6, v54 op_sel:[1,0,0,0]
    v_cmp_lt_u32_sdwa s[42:43], v6, v55 src0_sel:WORD_1 src1_sel:WORD_1
    s_mov_b64 exec, s[40:41]
    buffer_load_dwordx3 v[16:18], v0, s[8:11], 0 offen
    s_mov_b64 exec, -1
    s_waitcnt lgkmcnt(7)
    v_cmp_lt_u32_sdwa s[58:59], v6, v57 src0_sel:WORD_1 src1_sel:WORD_0
    v_mad_u32_u16 v0, v6, 6, v56 op_sel:[1,0,0,0]
    v_cmp_lt_u32_sdwa s[60:61], v6, v57 src0_sel:WORD_1 src1_sel:WORD_1
    s_mov_b64 exec, s[58:59]
    buffer_load_dwordx3 v[20:22], v0, s[8:11], 0 offen
    s_mov_b64 exec, -1
    s_andn2_b64 s[58:59], s[58:59], s[32:33]
    s_waitcnt lgkmcnt(6)
    v_cmp_lt_u32_sdwa s[62:63], v6, v59 src0_sel:WORD_1 src1_sel:WORD_0
    v_mad_u32_u16 v0, v6, 6, v58 op_sel:[1,0,0,0]
    v_cmp_lt_u32_sdwa s[64:65], v6, v59 src0_sel:WORD_1 src1_sel:WORD_1
    s_mov_b64 exec, s[62:63]
    buffer_load_dwordx3 v[24:26], v0, s[8:11], 0 offen
    s_mov_b64 exec, -1
    s_waitcnt lgkmcnt(5)
    v_cmp_lt_u32_sdwa s[66:67], v6, v61 src0_sel:WORD_1 src1_sel:WORD_0
    v_mad_u32_u16 v0, v6, 6, v60 op_sel:[1,0,0,0]
    v_cmp_lt_u32_sdwa s[68:69], v6, v61 src0_sel:WORD_1 src1_sel:WORD_1
    s_mov_b64 exec, s[66:67]
    buffer_load_dwordx3 v[28:30], v0, s[8:11], 0 offen
    s_mov_b64 exec, -1
    s_waitcnt lgkmcnt(4)
    v_cmp_lt_u32_sdwa s[72:73], v6, v63 src0_sel:WORD_1 src1_sel:WORD_0
    v_mad_u32_u16 v0, v6, 6, v62 op_sel:[1,0,0,0]
    v_cmp_lt_u32_sdwa s[74:75], v6, v63 src0_sel:WORD_1 src1_sel:WORD_1
    s_mov_b64 exec, s[72:73]
    buffer_load_dwordx3 v[32:34], v0, s[8:11], 0 offen
    s_mov_b64 exec, -1
    s_waitcnt lgkmcnt(3)
    v_cmp_lt_u32_sdwa s[76:77], v6, v65 src0_sel:WORD_1 src1_sel:WORD_0
    v_mad_u32_u16 v0, v6, 6, v64 op_sel:[1,0,0,0]
    v_cmp_lt_u32_sdwa s[78:79], v6, v65 src0_sel:WORD_1 src1_sel:WORD_1
    s_mov_b64 exec, s[76:77]
    buffer_load_dwordx3 v[36:38], v0, s[8:11], 0 offen
    s_mov_b64 exec, -1
    s_waitcnt lgkmcnt(2)
    v_cmp_lt_u32_sdwa s[80:81], v6, v67 src0_sel:WORD_1 src1_sel:WORD_0
    v_mad_u32_u16 v0, v6, 6, v66 op_sel:[1,0,0,0]
    v_cmp_lt_u32_sdwa s[82:83], v6, v67 src0_sel:WORD_1 src1_sel:WORD_1
    s_mov_b64 exec, s[80:81]
    buffer_load_dwordx3 v[40:42], v0, s[8:11], 0 offen
    s_mov_b64 exec, -1
    s_waitcnt lgkmcnt(1)
    v_cmp_lt_u32_sdwa s[84:85], v6, v69 src0_sel:WORD_1 src1_sel:WORD_0
    v_mad_u32_u16 v0, v6, 6, v68 op_sel:[1,0,0,0]
    v_cmp_lt_u32_sdwa s[86:87], v6, v69 src0_sel:WORD_1 src1_sel:WORD_1
    s_mov_b64 exec, s[84:85]
    buffer_load_dwordx3 v[44:46], v0, s[8:11], 0 offen
    s_mov_b64 exec, -1
    s_waitcnt lgkmcnt(0)
    v_cmp_lt_u32_sdwa s[88:89], v6, v71 src0_sel:WORD_1 src1_sel:WORD_0
    v_mad_u32_u16 v0, v6, 6, v70 op_sel:[1,0,0,0]
    v_cmp_lt_u32_sdwa s[90:91], v6, v71 src0_sel:WORD_1 src1_sel:WORD_1
    s_mov_b64 exec, s[88:89]
    buffer_load_dwordx3 v[48:50], v0, s[8:11], 0 offen
    s_mov_b64 exec, -1
    v_max_u32 v119, 1, v111
    v_mad_u32_u16 v118, v105, 6, v120
    v_subrev_u32 v119, 1, v119
    v_lshl_or_b32 v119, v119, 16, v111
    ds_write_b64 v121, v[118:119] offset:256
    v_max_u32 v119, 1, v112
    v_mad_u32_u16 v118, v106, 6, v120
    v_subrev_u32 v119, 1, v119
    v_lshl_or_b32 v119, v119, 16, v112
    ds_write_b64 v121, v[118:119] offset:512
    v_max_u32 v119, 1, v113
    v_mad_u32_u16 v118, v107, 6, v120
    v_subrev_u32 v119, 1, v119
    v_lshl_or_b32 v119, v119, 16, v113
    ds_write_b64 v121, v[118:119] offset:768
    v_max_u32 v119, 1, v114
    v_mad_u32_u16 v118, v108, 6, v120
    v_subrev_u32 v119, 1, v119
    v_lshl_or_b32 v119, v119, 16, v114
    ds_write_b64 v121, v[118:119] offset:1024
    v_max_u32 v119, 1, v115
    v_mad_u32_u16 v118, v109, 6, v120
    v_subrev_u32 v119, 1, v119
    v_lshl_or_b32 v119, v119, 16, v115
    ds_write_b64 v121, v[118:119] offset:1280
    s_lshl_b32 s36, s99, 16
    s_and_b32 s37, s99, 0xffff0000
    v_mov_b32 v116, s36
    v_mov_b32 v117, s37
    v_mul_f32 v116, 0.15915494, v116
    v_mul_f32 v117, 0.15915494, v117
    v_readfirstlane_b32 s70, v116
    v_readfirstlane_b32 s71, v117
    s_waitcnt vmcnt(9)
    v_lshl_or_b32 v72, v73, 16, v72
    v_cndmask_b32 v12, v72, 0, s[56:57]
    v_cndmask_b32 v8, 0, v72, s[56:57]
    v_lshl_or_b32 v74, v75, 16, v74
    v_cndmask_b32 v13, v74, 0, s[56:57]
    v_cndmask_b32 v9, 0, v74, s[56:57]
    v_lshl_or_b32 v76, v77, 16, v76
    v_cndmask_b32 v14, v76, 0, s[56:57]
    v_cndmask_b32 v10, 0, v76, s[56:57]
    v_lshl_or_b32 v78, v79, 16, v78
    v_cndmask_b32 v15, v78, 0, s[56:57]
    v_cndmask_b32 v11, 0, v78, s[56:57]
    s_lshl_b32 s36, s3, 10
    s_add_u32 s36, s36, 153216
    v_add_u32 v97, s36, v96
    ds_write_b128 v97, v[80:83]
    v_lshl_or_b32 v72, v85, 16, v84
    v_lshl_or_b32 v73, v87, 16, v86
    v_lshl_or_b32 v74, v90, 16, v88
    v_lshl_or_b32 v75, v91, 16, v89
    v_lshl_or_b32 v76, v93, 16, v92
    v_mov_b32 v77, 0
    v_lshlrev_b32 v78, 16, v94
    v_lshlrev_b32 v79, 16, v95
    v_mul_f32 v78, 0xc0731710, v78
    v_mul_f32 v79, 0xc0731710, v79
    v_add_u32 v97, 161408, v96
    ds_write_b128 v97, v[72:75]
    ds_write_b128 v97, v[76:79] offset:1024
    v_mov_b32 v100, 0
    v_mov_b32 v101, 0
    v_mov_b32 v102, 0
    v_mov_b32 v103, 0
    ds_write_b128 v98, v[100:103] offset:0
    v_mov_b32 v104, 0
    v_mov_b32 v105, 0
    v_mov_b32 v106, 0
    v_mov_b32 v107, 0
    v_mov_b32 v108, 0
    v_mov_b32 v109, 0
    v_mov_b32 v110, 0
    v_mov_b32 v111, 0
    v_mov_b32 v112, 0
    v_mov_b32 v113, 0
    v_mov_b32 v114, 0
    v_mov_b32 v115, 0
    v_mov_b32 v116, 0
    v_mov_b32 v117, 0
    v_mov_b32 v118, 0
    v_mov_b32 v119, 0
    v_mov_b32 v120, 0
    v_mov_b32 v121, 0
    v_mov_b32 v122, 0
    ds_write_b128 v98, v[100:103] offset:8192
    v_mov_b32 v123, 0
    v_mov_b32 v124, 0
    v_mov_b32 v125, 0
    v_mov_b32 v126, 0
    v_mov_b32 v127, 0
    v_mov_b32 v128, 0
    v_mov_b32 v129, 0
    v_mov_b32 v130, 0
    v_mov_b32 v131, 0
    v_mov_b32 v132, 0
    v_mov_b32 v133, 0
    v_mov_b32 v134, 0
    v_mov_b32 v135, 0
    v_mov_b32 v136, 0
    v_mov_b32 v137, 0
    v_mov_b32 v138, 0
    v_mov_b32 v139, 0
    v_mov_b32 v140, 0
    v_mov_b32 v141, 0
    ds_write_b128 v98, v[100:103] offset:16384
    v_mov_b32 v142, 0
    v_mov_b32 v143, 0
    v_mov_b32 v144, 0
    v_mov_b32 v145, 0
    v_mov_b32 v146, 0
    v_mov_b32 v147, 0
    v_mov_b32 v148, 0
    v_mov_b32 v149, 0
    v_mov_b32 v150, 0
    v_mov_b32 v151, 0
    v_mov_b32 v152, 0
    v_mov_b32 v153, 0
    v_mov_b32 v154, 0
    v_mov_b32 v155, 0
    v_mov_b32 v156, 0
    v_mov_b32 v157, 0
    v_mov_b32 v158, 0
    v_mov_b32 v159, 0
    v_mov_b32 v160, 0
    ds_write_b128 v98, v[100:103] offset:24576
    v_mov_b32 v161, 0
    v_mov_b32 v162, 0
    v_mov_b32 v163, 0
    v_mov_b32 v164, 0
    v_mov_b32 v165, 0
    v_mov_b32 v166, 0
    v_mov_b32 v167, 0
    v_mov_b32 v168, 0
    v_mov_b32 v169, 0
    v_mov_b32 v170, 0
    v_mov_b32 v171, 0
    v_mov_b32 v172, 0
    v_mov_b32 v173, 0
    v_mov_b32 v174, 0
    v_mov_b32 v175, 0
    v_mov_b32 v176, 0
    v_mov_b32 v177, 0
    v_mov_b32 v178, 0
    v_mov_b32 v179, 0
    ds_write_b128 v98, v[100:103] offset:32768
    v_mov_b32 v180, 0
    v_mov_b32 v181, 0
    v_mov_b32 v182, 0
    v_mov_b32 v183, 0
    v_mov_b32 v184, 0
    v_mov_b32 v185, 0
    v_mov_b32 v186, 0
    v_mov_b32 v187, 0
    v_mov_b32 v188, 0
    v_mov_b32 v189, 0
    v_mov_b32 v190, 0
    v_mov_b32 v191, 0
    v_mov_b32 v192, 0
    v_mov_b32 v193, 0
    v_mov_b32 v194, 0
    v_mov_b32 v195, 0
    v_mov_b32 v196, 0
    v_mov_b32 v197, 0
    v_mov_b32 v198, 0
    ds_write_b128 v98, v[100:103] offset:40960
    v_mov_b32 v199, 0
    v_mov_b32 v200, 0
    v_mov_b32 v201, 0
    v_mov_b32 v202, 0
    v_mov_b32 v203, 0
    v_mov_b32 v204, 0
    v_mov_b32 v205, 0
    v_mov_b32 v206, 0
    v_mov_b32 v207, 0
    v_mov_b32 v208, 0
    v_mov_b32 v209, 0
    v_mov_b32 v210, 0
    v_mov_b32 v211, 0
    v_mov_b32 v212, 0
    v_mov_b32 v213, 0
    v_mov_b32 v214, 0
    v_mov_b32 v215, 0
    v_mov_b32 v216, 0
    v_mov_b32 v217, 0
    ds_write_b128 v98, v[100:103] offset:49152
    v_mov_b32 v218, 0
    v_mov_b32 v219, 0
    v_mov_b32 v220, 0
    v_mov_b32 v221, 0
    v_mov_b32 v222, 0
    v_mov_b32 v223, 0
    v_mov_b32 v224, 0
    v_mov_b32 v225, 0
    v_mov_b32 v226, 0
    v_mov_b32 v227, 0
    v_mov_b32 v228, 0
    v_mov_b32 v229, 0
    v_mov_b32 v230, 0
    v_mov_b32 v231, 0
    v_mov_b32 v232, 0
    v_mov_b32 v233, 0
    v_mov_b32 v234, 0
    v_mov_b32 v235, 0
    v_mov_b32 v236, 0
    ds_write_b128 v98, v[100:103] offset:57344
    v_mov_b32 v237, 0
    v_mov_b32 v238, 0
    v_mov_b32 v239, 0
    v_mov_b32 v240, 0
    v_mov_b32 v241, 0
    v_mov_b32 v242, 0
    v_mov_b32 v243, 0
    v_mov_b32 v244, 0
    v_mov_b32 v245, 0
    v_mov_b32 v246, 0
    v_mov_b32 v247, 0
    v_mov_b32 v248, 0
    v_mov_b32 v249, 0
    v_mov_b32 v250, 0
    v_mov_b32 v251, 0
    v_mov_b32 v252, 0
    v_mov_b32 v253, 0
    v_mov_b32 v254, 0
    v_mov_b32 v255, 0
    v_add_u32 v98, 65536, v98
    s_mov_b64 exec, s[14:15]
    ds_write_b128 v98, v[100:103]
    s_mov_b64 exec, -1
    s_waitcnt lgkmcnt(0)
    s_barrier
B_xl:
    s_add_u32 s36, s25, 32
    s_cmp_ge_u32 s36, s23
    s_cbranch_scc1 B_xe
    s_add_u32 s36, s25, 0
    s_cmp_ge_u32 s36, s49
    s_cbranch_scc1 B_far1
B_farb1:
    v_add_u32_sdwa v0, s36, v6 dst_sel:DWORD dst_unused:UNUSED_PAD src0_sel:DWORD src1_sel:WORD_0
    ds_read_b64 v[108:109], v0
    s_waitcnt lgkmcnt(0)
    v_cmp_lt_u32_sdwa s[44:45], v6, v109 src0_sel:WORD_1 src1_sel:WORD_0
    v_mad_u32_u16 v0, v6, 6, v108 op_sel:[1,0,0,0]
    v_cmp_lt_u32_sdwa s[46:47], v6, v109 src0_sel:WORD_1 src1_sel:WORD_1
    s_mov_b64 exec, s[44:45]
    buffer_load_dwordx3 v[104:106], v0, s[8:11], 0 offen
    s_mov_b64 exec, -1
    s_waitcnt vmcnt(0)
    v_cvt_f32_bf16_sdwa v0, v105 dst_sel:DWORD dst_unused:UNUSED_PAD src0_sel:WORD_1
    v_pk_mul_f32 v[0:1], v[0:1], s[70:71] op_sel_hi:[0,1]
    v_cos_f32 v0, v0
    v_cos_f32 v1, v1
    v_mov_b32 v109, 65544
    v_cvt_pk_bf16_f32 v107, v0, v1
    v_cvt_f32_bf16_sdwa v0, v105 dst_sel:DWORD dst_unused:UNUSED_PAD src0_sel:WORD_0
    v_pk_mul_f32 v[0:1], v[0:1], s[70:71] op_sel_hi:[0,1]
    v_cos_f32 v0, v0
    v_cos_f32 v1, v1
    s_and_b64 exec, s[44:45], s[30:31]
    v_cvt_pk_bf16_f32 v105, v0, v1
    v_lshlrev_b32_sdwa v0, 2, v104 dst_sel:DWORD dst_unused:UNUSED_PAD src0_sel:DWORD src1_sel:BYTE_0
    ds_add_rtn_u32 v108, v0, v109 offset:0
    s_and_b64 exec, s[46:47], s[30:31]
    v_lshlrev_b32_sdwa v0, 2, v106 dst_sel:DWORD dst_unused:UNUSED_PAD src0_sel:DWORD src1_sel:BYTE_0
    ds_add_rtn_u32 v109, v0, v109 offset:0
    s_mov_b64 exec, -1
    s_waitcnt lgkmcnt(0)
    s_and_b64 exec, s[44:45], s[30:31]
    v_lshlrev_b32_sdwa v0, 8, v104 dst_sel:DWORD dst_unused:UNUSED_PAD src0_sel:DWORD src1_sel:BYTE_0
    v_cmp_le_u32 vcc, s19, v108
    v_and_or_b32 v0, v108, s20, v0
    s_cbranch_vccnz B_sp2
B_spb2:
    v_mov_b32_sdwa v104, s21 dst_sel:BYTE_0 dst_unused:UNUSED_PRESERVE src0_sel:BYTE_0
    ds_write_b64 v0, v[104:105] offset:1664
    s_and_b64 exec, s[46:47], s[30:31]
    v_lshlrev_b32_sdwa v0, 8, v106 dst_sel:DWORD dst_unused:UNUSED_PAD src0_sel:DWORD src1_sel:BYTE_0
    v_cmp_le_u32 vcc, s19, v109
    v_and_or_b32 v0, v109, s20, v0
    s_cbranch_vccnz B_sp3
B_spb3:
    v_mov_b32_sdwa v106, s21 dst_sel:BYTE_0 dst_unused:UNUSED_PRESERVE src0_sel:BYTE_0
    ds_write_b64 v0, v[106:107] offset:1664
    s_mov_b64 exec, -1
    s_cmp_eq_u32 s30, 0
    s_cbranch_scc1 B_pz
    s_add_u32 s25, s25, 32
    s_branch B_xl
B_xe:
    s_mov_b32 s25, s23
    s_waitcnt vmcnt(8)
    v_mov_b32 v55, 65544
    s_mov_b64 exec, s[40:41]
    v_lshlrev_b32_sdwa v0, 2, v16 dst_sel:DWORD dst_unused:UNUSED_PAD src0_sel:DWORD src1_sel:BYTE_0
    ds_add_rtn_u32 v54, v0, v55 offset:0
    s_mov_b64 exec, s[42:43]
    v_lshlrev_b32_sdwa v0, 2, v18 dst_sel:DWORD dst_unused:UNUSED_PAD src0_sel:DWORD src1_sel:BYTE_0
    ds_add_rtn_u32 v55, v0, v55 offset:0
    s_mov_b64 exec, -1
    s_waitcnt vmcnt(7)
    v_mov_b32 v57, 65544
    s_mov_b64 exec, s[58:59]
    v_lshlrev_b32_sdwa v0, 2, v20 dst_sel:DWORD dst_unused:UNUSED_PAD src0_sel:DWORD src1_sel:BYTE_0
    ds_add_rtn_u32 v56, v0, v57 offset:0
    s_mov_b64 exec, s[60:61]
    v_lshlrev_b32_sdwa v0, 2, v22 dst_sel:DWORD dst_unused:UNUSED_PAD src0_sel:DWORD src1_sel:BYTE_0
    ds_add_rtn_u32 v57, v0, v57 offset:0
    s_mov_b64 exec, -1
    s_waitcnt vmcnt(6)
    v_mov_b32 v59, 65544
    s_mov_b64 exec, s[62:63]
    v_lshlrev_b32_sdwa v0, 2, v24 dst_sel:DWORD dst_unused:UNUSED_PAD src0_sel:DWORD src1_sel:BYTE_0
    ds_add_rtn_u32 v58, v0, v59 offset:0
    s_mov_b64 exec, s[64:65]
    v_lshlrev_b32_sdwa v0, 2, v26 dst_sel:DWORD dst_unused:UNUSED_PAD src0_sel:DWORD src1_sel:BYTE_0
    ds_add_rtn_u32 v59, v0, v59 offset:0
    s_mov_b64 exec, -1
    v_cvt_f32_bf16_sdwa v74, v17 dst_sel:DWORD dst_unused:UNUSED_PAD src0_sel:WORD_1
    v_cvt_f32_bf16_sdwa v72, v17 dst_sel:DWORD dst_unused:UNUSED_PAD src0_sel:WORD_0
    v_cvt_f32_bf16_sdwa v78, v21 dst_sel:DWORD dst_unused:UNUSED_PAD src0_sel:WORD_1
    v_cvt_f32_bf16_sdwa v76, v21 dst_sel:DWORD dst_unused:UNUSED_PAD src0_sel:WORD_0
    v_cvt_f32_bf16_sdwa v82, v25 dst_sel:DWORD dst_unused:UNUSED_PAD src0_sel:WORD_1
    v_cvt_f32_bf16_sdwa v80, v25 dst_sel:DWORD dst_unused:UNUSED_PAD src0_sel:WORD_0
    v_pk_mul_f32 v[74:75], v[74:75], s[70:71] op_sel_hi:[0,1]
    v_pk_mul_f32 v[72:73], v[72:73], s[70:71] op_sel_hi:[0,1]
    v_pk_mul_f32 v[78:79], v[78:79], s[70:71] op_sel_hi:[0,1]
    v_pk_mul_f32 v[76:77], v[76:77], s[70:71] op_sel_hi:[0,1]
    v_pk_mul_f32 v[82:83], v[82:83], s[70:71] op_sel_hi:[0,1]
    v_pk_mul_f32 v[80:81], v[80:81], s[70:71] op_sel_hi:[0,1]
    v_cos_f32 v74, v74
    v_cos_f32 v75, v75
    v_cos_f32 v72, v72
    v_cos_f32 v73, v73
    v_cos_f32 v78, v78
    v_cos_f32 v79, v79
    v_cos_f32 v76, v76
    v_cos_f32 v77, v77
    v_cos_f32 v82, v82
    v_cos_f32 v83, v83
    v_cos_f32 v80, v80
    v_cos_f32 v81, v81
    v_cvt_pk_bf16_f32 v19, v74, v75
    v_cvt_pk_bf16_f32 v17, v72, v73
    v_cvt_pk_bf16_f32 v23, v78, v79
    v_cvt_pk_bf16_f32 v21, v76, v77
    v_cvt_pk_bf16_f32 v27, v82, v83
    v_cvt_pk_bf16_f32 v25, v80, v81
    s_waitcnt vmcnt(5)
    v_mov_b32 v61, 65544
    s_mov_b64 exec, s[66:67]
    v_lshlrev_b32_sdwa v0, 2, v28 dst_sel:DWORD dst_unused:UNUSED_PAD src0_sel:DWORD src1_sel:BYTE_0
    ds_add_rtn_u32 v60, v0, v61 offset:0
    s_mov_b64 exec, s[68:69]
    v_lshlrev_b32_sdwa v0, 2, v30 dst_sel:DWORD dst_unused:UNUSED_PAD src0_sel:DWORD src1_sel:BYTE_0
    ds_add_rtn_u32 v61, v0, v61 offset:0
    s_mov_b64 exec, -1
    s_waitcnt vmcnt(4)
    v_mov_b32 v63, 65544
    s_mov_b64 exec, s[72:73]
    v_lshlrev_b32_sdwa v0, 2, v32 dst_sel:DWORD dst_unused:UNUSED_PAD src0_sel:DWORD src1_sel:BYTE_0
    ds_add_rtn_u32 v62, v0, v63 offset:0
    s_mov_b64 exec, s[74:75]
    v_lshlrev_b32_sdwa v0, 2, v34 dst_sel:DWORD dst_unused:UNUSED_PAD src0_sel:DWORD src1_sel:BYTE_0
    ds_add_rtn_u32 v63, v0, v63 offset:0
    s_mov_b64 exec, -1
    s_waitcnt vmcnt(3)
    v_mov_b32 v65, 65544
    s_mov_b64 exec, s[76:77]
    v_lshlrev_b32_sdwa v0, 2, v36 dst_sel:DWORD dst_unused:UNUSED_PAD src0_sel:DWORD src1_sel:BYTE_0
    ds_add_rtn_u32 v64, v0, v65 offset:0
    s_mov_b64 exec, s[78:79]
    v_lshlrev_b32_sdwa v0, 2, v38 dst_sel:DWORD dst_unused:UNUSED_PAD src0_sel:DWORD src1_sel:BYTE_0
    ds_add_rtn_u32 v65, v0, v65 offset:0
    s_mov_b64 exec, -1
    v_cvt_f32_bf16_sdwa v86, v29 dst_sel:DWORD dst_unused:UNUSED_PAD src0_sel:WORD_1
    v_cvt_f32_bf16_sdwa v84, v29 dst_sel:DWORD dst_unused:UNUSED_PAD src0_sel:WORD_0
    v_cvt_f32_bf16_sdwa v90, v33 dst_sel:DWORD dst_unused:UNUSED_PAD src0_sel:WORD_1
    v_cvt_f32_bf16_sdwa v88, v33 dst_sel:DWORD dst_unused:UNUSED_PAD src0_sel:WORD_0
    v_cvt_f32_bf16_sdwa v94, v37 dst_sel:DWORD dst_unused:UNUSED_PAD src0_sel:WORD_1
    v_cvt_f32_bf16_sdwa v92, v37 dst_sel:DWORD dst_unused:UNUSED_PAD src0_sel:WORD_0
    v_pk_mul_f32 v[86:87], v[86:87], s[70:71] op_sel_hi:[0,1]
    v_pk_mul_f32 v[84:85], v[84:85], s[70:71] op_sel_hi:[0,1]
    v_pk_mul_f32 v[90:91], v[90:91], s[70:71] op_sel_hi:[0,1]
    v_pk_mul_f32 v[88:89], v[88:89], s[70:71] op_sel_hi:[0,1]
    v_pk_mul_f32 v[94:95], v[94:95], s[70:71] op_sel_hi:[0,1]
    v_pk_mul_f32 v[92:93], v[92:93], s[70:71] op_sel_hi:[0,1]
    v_cos_f32 v86, v86
    v_cos_f32 v87, v87
    v_cos_f32 v84, v84
    v_cos_f32 v85, v85
    v_cos_f32 v90, v90
    v_cos_f32 v91, v91
    v_cos_f32 v88, v88
    v_cos_f32 v89, v89
    v_cos_f32 v94, v94
    v_cos_f32 v95, v95
    v_cos_f32 v92, v92
    v_cos_f32 v93, v93
    v_cvt_pk_bf16_f32 v31, v86, v87
    v_cvt_pk_bf16_f32 v29, v84, v85
    v_cvt_pk_bf16_f32 v35, v90, v91
    v_cvt_pk_bf16_f32 v33, v88, v89
    v_cvt_pk_bf16_f32 v39, v94, v95
    v_cvt_pk_bf16_f32 v37, v92, v93
    s_waitcnt vmcnt(2)
    v_mov_b32 v67, 65544
    s_mov_b64 exec, s[80:81]
    v_lshlrev_b32_sdwa v0, 2, v40 dst_sel:DWORD dst_unused:UNUSED_PAD src0_sel:DWORD src1_sel:BYTE_0
    ds_add_rtn_u32 v66, v0, v67 offset:0
    s_mov_b64 exec, s[82:83]
    v_lshlrev_b32_sdwa v0, 2, v42 dst_sel:DWORD dst_unused:UNUSED_PAD src0_sel:DWORD src1_sel:BYTE_0
    ds_add_rtn_u32 v67, v0, v67 offset:0
    s_mov_b64 exec, -1
    s_waitcnt vmcnt(1)
    v_mov_b32 v69, 65544
    s_mov_b64 exec, s[84:85]
    v_lshlrev_b32_sdwa v0, 2, v44 dst_sel:DWORD dst_unused:UNUSED_PAD src0_sel:DWORD src1_sel:BYTE_0
    ds_add_rtn_u32 v68, v0, v69 offset:0
    s_mov_b64 exec, s[86:87]
    v_lshlrev_b32_sdwa v0, 2, v46 dst_sel:DWORD dst_unused:UNUSED_PAD src0_sel:DWORD src1_sel:BYTE_0
    ds_add_rtn_u32 v69, v0, v69 offset:0
    s_mov_b64 exec, -1
    s_waitcnt vmcnt(0)
    v_mov_b32 v71, 65544
    s_mov_b64 exec, s[88:89]
    v_lshlrev_b32_sdwa v0, 2, v48 dst_sel:DWORD dst_unused:UNUSED_PAD src0_sel:DWORD src1_sel:BYTE_0
    ds_add_rtn_u32 v70, v0, v71 offset:0
    s_mov_b64 exec, s[90:91]
    v_lshlrev_b32_sdwa v0, 2, v50 dst_sel:DWORD dst_unused:UNUSED_PAD src0_sel:DWORD src1_sel:BYTE_0
    ds_add_rtn_u32 v71, v0, v71 offset:0
    s_mov_b64 exec, -1
    v_cvt_f32_bf16_sdwa v74, v41 dst_sel:DWORD dst_unused:UNUSED_PAD src0_sel:WORD_1
    v_cvt_f32_bf16_sdwa v72, v41 dst_sel:DWORD dst_unused:UNUSED_PAD src0_sel:WORD_0
    v_cvt_f32_bf16_sdwa v78, v45 dst_sel:DWORD dst_unused:UNUSED_PAD src0_sel:WORD_1
    v_cvt_f32_bf16_sdwa v76, v45 dst_sel:DWORD dst_unused:UNUSED_PAD src0_sel:WORD_0
    v_cvt_f32_bf16_sdwa v82, v49 dst_sel:DWORD dst_unused:UNUSED_PAD src0_sel:WORD_1
    v_cvt_f32_bf16_sdwa v80, v49 dst_sel:DWORD dst_unused:UNUSED_PAD src0_sel:WORD_0
    v_pk_mul_f32 v[74:75], v[74:75], s[70:71] op_sel_hi:[0,1]
    v_pk_mul_f32 v[72:73], v[72:73], s[70:71] op_sel_hi:[0,1]
    v_pk_mul_f32 v[78:79], v[78:79], s[70:71] op_sel_hi:[0,1]
    v_pk_mul_f32 v[76:77], v[76:77], s[70:71] op_sel_hi:[0,1]
    v_pk_mul_f32 v[82:83], v[82:83], s[70:71] op_sel_hi:[0,1]
    v_pk_mul_f32 v[80:81], v[80:81], s[70:71] op_sel_hi:[0,1]
    v_cos_f32 v74, v74
    v_cos_f32 v75, v75
    v_cos_f32 v72, v72
    v_cos_f32 v73, v73
    v_cos_f32 v78, v78
    v_cos_f32 v79, v79
    v_cos_f32 v76, v76
    v_cos_f32 v77, v77
    v_cos_f32 v82, v82
    v_cos_f32 v83, v83
    v_cos_f32 v80, v80
    v_cos_f32 v81, v81
    v_cvt_pk_bf16_f32 v43, v74, v75
    v_cvt_pk_bf16_f32 v41, v72, v73
    v_cvt_pk_bf16_f32 v47, v78, v79
    v_cvt_pk_bf16_f32 v45, v76, v77
    v_cvt_pk_bf16_f32 v51, v82, v83
    v_cvt_pk_bf16_f32 v49, v80, v81
    s_waitcnt lgkmcnt(15)
    s_and_b64 exec, s[40:41], s[30:31]
    v_lshlrev_b32_sdwa v0, 8, v16 dst_sel:DWORD dst_unused:UNUSED_PAD src0_sel:DWORD src1_sel:BYTE_0
    v_cmp_le_u32 vcc, s19, v54
    v_and_or_b32 v0, v54, s20, v0
    s_cbranch_vccnz B_sp4
B_spb4:
    v_mov_b32_sdwa v16, s21 dst_sel:BYTE_0 dst_unused:UNUSED_PRESERVE src0_sel:BYTE_0
    ds_write_b64 v0, v[16:17] offset:1664
    s_and_b64 exec, s[42:43], s[30:31]
    v_lshlrev_b32_sdwa v0, 8, v18 dst_sel:DWORD dst_unused:UNUSED_PAD src0_sel:DWORD src1_sel:BYTE_0
    v_cmp_le_u32 vcc, s19, v55
    v_and_or_b32 v0, v55, s20, v0
    s_cbranch_vccnz B_sp5
B_spb5:
    v_mov_b32_sdwa v18, s21 dst_sel:BYTE_0 dst_unused:UNUSED_PRESERVE src0_sel:BYTE_0
    ds_write_b64 v0, v[18:19] offset:1664
    s_mov_b64 exec, -1
    s_waitcnt lgkmcnt(15)
    s_and_b64 exec, s[58:59], s[30:31]
    v_lshlrev_b32_sdwa v0, 8, v20 dst_sel:DWORD dst_unused:UNUSED_PAD src0_sel:DWORD src1_sel:BYTE_0
    v_cmp_le_u32 vcc, s19, v56
    v_and_or_b32 v0, v56, s20, v0
    s_cbranch_vccnz B_sp6
B_spb6:
    v_mov_b32_sdwa v20, s21 dst_sel:BYTE_0 dst_unused:UNUSED_PRESERVE src0_sel:BYTE_0
    ds_write_b64 v0, v[20:21] offset:1664
    s_and_b64 exec, s[60:61], s[30:31]
    v_lshlrev_b32_sdwa v0, 8, v22 dst_sel:DWORD dst_unused:UNUSED_PAD src0_sel:DWORD src1_sel:BYTE_0
    v_cmp_le_u32 vcc, s19, v57
    v_and_or_b32 v0, v57, s20, v0
    s_cbranch_vccnz B_sp7
B_spb7:
    v_mov_b32_sdwa v22, s21 dst_sel:BYTE_0 dst_unused:UNUSED_PRESERVE src0_sel:BYTE_0
    ds_write_b64 v0, v[22:23] offset:1664
    s_mov_b64 exec, -1
    s_waitcnt lgkmcnt(15)
    s_and_b64 exec, s[62:63], s[30:31]
    v_lshlrev_b32_sdwa v0, 8, v24 dst_sel:DWORD dst_unused:UNUSED_PAD src0_sel:DWORD src1_sel:BYTE_0
    v_cmp_le_u32 vcc, s19, v58
    v_and_or_b32 v0, v58, s20, v0
    s_cbranch_vccnz B_sp8
B_spb8:
    v_mov_b32_sdwa v24, s21 dst_sel:BYTE_0 dst_unused:UNUSED_PRESERVE src0_sel:BYTE_0
    ds_write_b64 v0, v[24:25] offset:1664
    s_and_b64 exec, s[64:65], s[30:31]
    v_lshlrev_b32_sdwa v0, 8, v26 dst_sel:DWORD dst_unused:UNUSED_PAD src0_sel:DWORD src1_sel:BYTE_0
    v_cmp_le_u32 vcc, s19, v59
    v_and_or_b32 v0, v59, s20, v0
    s_cbranch_vccnz B_sp9
B_spb9:
    v_mov_b32_sdwa v26, s21 dst_sel:BYTE_0 dst_unused:UNUSED_PRESERVE src0_sel:BYTE_0
    ds_write_b64 v0, v[26:27] offset:1664
    s_mov_b64 exec, -1
    s_waitcnt lgkmcnt(15)
    s_and_b64 exec, s[66:67], s[30:31]
    v_lshlrev_b32_sdwa v0, 8, v28 dst_sel:DWORD dst_unused:UNUSED_PAD src0_sel:DWORD src1_sel:BYTE_0
    v_cmp_le_u32 vcc, s19, v60
    v_and_or_b32 v0, v60, s20, v0
    s_cbranch_vccnz B_sp10
B_spb10:
    v_mov_b32_sdwa v28, s21 dst_sel:BYTE_0 dst_unused:UNUSED_PRESERVE src0_sel:BYTE_0
    ds_write_b64 v0, v[28:29] offset:1664
    s_and_b64 exec, s[68:69], s[30:31]
    v_lshlrev_b32_sdwa v0, 8, v30 dst_sel:DWORD dst_unused:UNUSED_PAD src0_sel:DWORD src1_sel:BYTE_0
    v_cmp_le_u32 vcc, s19, v61
    v_and_or_b32 v0, v61, s20, v0
    s_cbranch_vccnz B_sp11
B_spb11:
    v_mov_b32_sdwa v30, s21 dst_sel:BYTE_0 dst_unused:UNUSED_PRESERVE src0_sel:BYTE_0
    ds_write_b64 v0, v[30:31] offset:1664
    s_mov_b64 exec, -1
    s_waitcnt lgkmcnt(15)
    s_and_b64 exec, s[72:73], s[30:31]
    v_lshlrev_b32_sdwa v0, 8, v32 dst_sel:DWORD dst_unused:UNUSED_PAD src0_sel:DWORD src1_sel:BYTE_0
    v_cmp_le_u32 vcc, s19, v62
    v_and_or_b32 v0, v62, s20, v0
    s_cbranch_vccnz B_sp12
B_spb12:
    v_mov_b32_sdwa v32, s21 dst_sel:BYTE_0 dst_unused:UNUSED_PRESERVE src0_sel:BYTE_0
    ds_write_b64 v0, v[32:33] offset:1664
    s_and_b64 exec, s[74:75], s[30:31]
    v_lshlrev_b32_sdwa v0, 8, v34 dst_sel:DWORD dst_unused:UNUSED_PAD src0_sel:DWORD src1_sel:BYTE_0
    v_cmp_le_u32 vcc, s19, v63
    v_and_or_b32 v0, v63, s20, v0
    s_cbranch_vccnz B_sp13
B_spb13:
    v_mov_b32_sdwa v34, s21 dst_sel:BYTE_0 dst_unused:UNUSED_PRESERVE src0_sel:BYTE_0
    ds_write_b64 v0, v[34:35] offset:1664
    s_mov_b64 exec, -1
    s_waitcnt lgkmcnt(15)
    s_and_b64 exec, s[76:77], s[30:31]
    v_lshlrev_b32_sdwa v0, 8, v36 dst_sel:DWORD dst_unused:UNUSED_PAD src0_sel:DWORD src1_sel:BYTE_0
    v_cmp_le_u32 vcc, s19, v64
    v_and_or_b32 v0, v64, s20, v0
    s_cbranch_vccnz B_sp14
B_spb14:
    v_mov_b32_sdwa v36, s21 dst_sel:BYTE_0 dst_unused:UNUSED_PRESERVE src0_sel:BYTE_0
    ds_write_b64 v0, v[36:37] offset:1664
    s_and_b64 exec, s[78:79], s[30:31]
    v_lshlrev_b32_sdwa v0, 8, v38 dst_sel:DWORD dst_unused:UNUSED_PAD src0_sel:DWORD src1_sel:BYTE_0
    v_cmp_le_u32 vcc, s19, v65
    v_and_or_b32 v0, v65, s20, v0
    s_cbranch_vccnz B_sp15
B_spb15:
    v_mov_b32_sdwa v38, s21 dst_sel:BYTE_0 dst_unused:UNUSED_PRESERVE src0_sel:BYTE_0
    ds_write_b64 v0, v[38:39] offset:1664
    s_mov_b64 exec, -1
    s_waitcnt lgkmcnt(15)
    s_and_b64 exec, s[80:81], s[30:31]
    v_lshlrev_b32_sdwa v0, 8, v40 dst_sel:DWORD dst_unused:UNUSED_PAD src0_sel:DWORD src1_sel:BYTE_0
    v_cmp_le_u32 vcc, s19, v66
    v_and_or_b32 v0, v66, s20, v0
    s_cbranch_vccnz B_sp16
B_spb16:
    v_mov_b32_sdwa v40, s21 dst_sel:BYTE_0 dst_unused:UNUSED_PRESERVE src0_sel:BYTE_0
    ds_write_b64 v0, v[40:41] offset:1664
    s_and_b64 exec, s[82:83], s[30:31]
    v_lshlrev_b32_sdwa v0, 8, v42 dst_sel:DWORD dst_unused:UNUSED_PAD src0_sel:DWORD src1_sel:BYTE_0
    v_cmp_le_u32 vcc, s19, v67
    v_and_or_b32 v0, v67, s20, v0
    s_cbranch_vccnz B_sp17
B_spb17:
    v_mov_b32_sdwa v42, s21 dst_sel:BYTE_0 dst_unused:UNUSED_PRESERVE src0_sel:BYTE_0
    ds_write_b64 v0, v[42:43] offset:1664
    s_mov_b64 exec, -1
    s_waitcnt lgkmcnt(15)
    s_and_b64 exec, s[84:85], s[30:31]
    v_lshlrev_b32_sdwa v0, 8, v44 dst_sel:DWORD dst_unused:UNUSED_PAD src0_sel:DWORD src1_sel:BYTE_0
    v_cmp_le_u32 vcc, s19, v68
    v_and_or_b32 v0, v68, s20, v0
    s_cbranch_vccnz B_sp18
B_spb18:
    v_mov_b32_sdwa v44, s21 dst_sel:BYTE_0 dst_unused:UNUSED_PRESERVE src0_sel:BYTE_0
    ds_write_b64 v0, v[44:45] offset:1664
    s_and_b64 exec, s[86:87], s[30:31]
    v_lshlrev_b32_sdwa v0, 8, v46 dst_sel:DWORD dst_unused:UNUSED_PAD src0_sel:DWORD src1_sel:BYTE_0
    v_cmp_le_u32 vcc, s19, v69
    v_and_or_b32 v0, v69, s20, v0
    s_cbranch_vccnz B_sp19
B_spb19:
    v_mov_b32_sdwa v46, s21 dst_sel:BYTE_0 dst_unused:UNUSED_PRESERVE src0_sel:BYTE_0
    ds_write_b64 v0, v[46:47] offset:1664
    s_mov_b64 exec, -1
    s_waitcnt lgkmcnt(15)
    s_and_b64 exec, s[88:89], s[30:31]
    v_lshlrev_b32_sdwa v0, 8, v48 dst_sel:DWORD dst_unused:UNUSED_PAD src0_sel:DWORD src1_sel:BYTE_0
    v_cmp_le_u32 vcc, s19, v70
    v_and_or_b32 v0, v70, s20, v0
    s_cbranch_vccnz B_sp20
B_spb20:
    v_mov_b32_sdwa v48, s21 dst_sel:BYTE_0 dst_unused:UNUSED_PRESERVE src0_sel:BYTE_0
    ds_write_b64 v0, v[48:49] offset:1664
    s_and_b64 exec, s[90:91], s[30:31]
    v_lshlrev_b32_sdwa v0, 8, v50 dst_sel:DWORD dst_unused:UNUSED_PAD src0_sel:DWORD src1_sel:BYTE_0
    v_cmp_le_u32 vcc, s19, v71
    v_and_or_b32 v0, v71, s20, v0
    s_cbranch_vccnz B_sp21
B_spb21:
    v_mov_b32_sdwa v50, s21 dst_sel:BYTE_0 dst_unused:UNUSED_PRESERVE src0_sel:BYTE_0
    ds_write_b64 v0, v[50:51] offset:1664
    s_mov_b64 exec, -1
B_pz:
B_pe:
    s_mov_b64 s[72:73], 0
    v_mov_b32 v7, v4
    s_mov_b64 s[60:61], 0
    v_mov_b32 v52, v4
    s_mov_b64 s[62:63], 0
    v_mov_b32 v53, v4
    s_mov_b64 s[64:65], 0
    v_mov_b32 v54, v4
    s_mov_b64 s[66:67], 0
    v_mov_b32 v55, v4
    s_mov_b64 s[68:69], 0
    v_mov_b32 v16, 0
    v_mov_b32 v17, 0
    v_mov_b32 v18, 0
    v_mov_b32 v19, 0
    v_mov_b32 v20, 0
    v_mov_b32 v21, 0
    v_mov_b32 v22, 0
    v_mov_b32 v23, 0
    v_mov_b32 v24, 0
    v_mov_b32 v25, 0
    v_mov_b32 v26, 0
    v_mov_b32 v27, 0
    v_mov_b32 v30, 0
    v_mov_b32 v31, 0
    v_mov_b32 v32, 0
    v_mov_b32 v33, 0
    v_mov_b32 v34, 0
    v_mov_b32 v35, 0
    v_mov_b32 v36, 0
    v_mov_b32 v37, 0
    v_mov_b32 v38, 0
    v_mov_b32 v39, 0
    v_mov_b32 v40, 0
    v_mov_b32 v41, 0
    v_mov_b32 v42, 0
    v_mov_b32 v43, 0
    v_mov_b32 v44, 0
    v_mov_b32 v45, 0
    v_mov_b32 v56, 0
    v_mov_b32 v57, 0
    v_mov_b32 v58, 0
    v_mov_b32 v59, 0
    v_mov_b32 v60, 0
    v_mov_b32 v61, 0
    v_mov_b32 v62, 0
    v_mov_b32 v63, 0
    v_mov_b32 v64, 0
    v_mov_b32 v65, 0
    v_mov_b32 v66, 0
    v_mov_b32 v67, 0
    v_mov_b32 v68, 0
    v_mov_b32 v69, 0
    v_mov_b32 v70, 0
    v_mov_b32 v71, 0
    v_mov_b32 v72, 0
    v_mov_b32 v73, 0
    v_mov_b32 v74, 0
    v_mov_b32 v75, 0
    v_mov_b32 v76, 0
    v_mov_b32 v77, 0
    v_mov_b32 v78, 0
    v_mov_b32 v79, 0
    v_mov_b32 v80, 0
    v_mov_b32 v81, 0
    v_mov_b32 v82, 0
    v_mov_b32 v83, 0
    v_mov_b32 v84, 0
    v_mov_b32 v85, 0
    v_mov_b32 v86, 0
    v_mov_b32 v87, 0
    v_mov_b32 v88, 0
    v_mov_b32 v89, 0
    v_mov_b32 v90, 0
    v_mov_b32 v91, 0
    v_mov_b32 v92, 0
    v_mov_b32 v93, 0
    v_mov_b32 v94, 0
    v_mov_b32 v95, 0
    v_mov_b32 v96, 0
    v_mov_b32 v97, 0
    v_mov_b32 v98, 0
    v_mov_b32 v99, 0
    v_mov_b32 v104, 0
    v_mov_b32 v105, 0
    v_mov_b32 v106, 0
    v_mov_b32 v107, 0
    v_mov_b32 v108, 0
    v_mov_b32 v109, 0
    s_add_u32 s25, s25, 256
    s_mov_b64 s[32:33], 0
    s_cmp_eq_u32 s30, 0
    s_cbranch_scc1 B_st22
B_stb22:
    s_add_u32 s34, s34, 1
    s_mov_b32 s16, s21
    s_add_u32 s21, s21, 1
    s_and_b32 s21, s21, 255
    s_or_b32 s17, s16, s50
    s_waitcnt lgkmcnt(0)
    s_barrier
B_loop0:
    s_cmp_lt_u32 s25, s26
    s_cselect_b32 s36, 1, s27
    s_cmp_eq_u32 s36, 0
    s_cbranch_scc1 B_free0
    ds_read_b64 v[28:29], v2 offset:1664
    s_cmp_eq_u32 s50, 0
    s_cbranch_scc1 B_pr0_0
    s_setprio 1
B_pr0_0:
    v_mfma_f32_16x16x32_bf16 v[224:227], v[38:41], v[30:33], v[224:227]
    v_mfma_f32_16x16x32_bf16 v[228:231], v[38:41], v[34:37], v[228:231]
    s_waitcnt lgkmcnt(0)
    v_lshrrev_b32 v0, 7, v28
    v_and_or_b32 v0, v0, s18, v3
    v_cmpx_eq_u32_sdwa s[60:61], s16, v28 src0_sel:DWORD src1_sel:BYTE_0
    v_bfe_u32 v1, v28, 8, 4
    v_lshl_add_u32 v7, v1, 4, v4
    v_lshrrev_b32_sdwa v7, v3, v29 dst_sel:WORD_1 dst_unused:UNUSED_PRESERVE src0_sel:DWORD src1_sel:DWORD
    s_waitcnt vmcnt(2)
    v_mfma_f32_16x16x32_bf16 v[30:33], v[20:23], v[8:11], 0
    v_mfma_f32_16x16x32_bf16 v[34:37], v[20:23], v[12:15], 0
    buffer_load_dwordx4 v[16:19], v0, s[4:7], 0 offen
    s_mov_b64 exec, s[62:63]
    v_and_b32 v0, s22, v52
    ds_write_b16_d16_hi v0, v3 offset:65280
    s_mov_b64 exec, s[64:65]
    v_and_b32 v1, s22, v53
    ds_write_b16_d16_hi v1, v53 offset:65280
    s_mov_b64 exec, -1
    ds_read_b64 v[28:29], v2 offset:1920
    v_cvt_pk_bf16_f32 v38, v30, v31
    v_cvt_pk_bf16_f32 v39, v32, v33
    v_cvt_pk_bf16_f32 v40, v34, v35
    v_cvt_pk_bf16_f32 v41, v36, v37
    ds_read_b128 v[30:33], v5
    ds_read_b128 v[34:37], v5 offset:1024
    s_add_u32 s36, s25, 0
    s_cmp_ge_u32 s36, s49
    s_cbranch_scc1 B_far23
B_farb23:
    v_add_u32_sdwa v0, s36, v6 dst_sel:DWORD dst_unused:UNUSED_PAD src0_sel:DWORD src1_sel:WORD_0
    ds_read_b64 v[50:51], v0
    v_mbcnt_lo_u32_b32 v0, -1, 0
    v_mbcnt_hi_u32_b32 v0, -1, v0
    v_add_u32 v0, s51, v0
    v_and_b32 v1, 31, v0
    v_lshl_add_u32 v0, v0, 2, 0
    v_lshlrev_b32 v1, 3, v1
    s_mov_b64 exec, s[52:53]
    ds_write_b32 v0, v1 offset:0
    s_mov_b64 exec, 1
    v_mov_b32 v0, s34
    v_mov_b32 v1, 0
    ds_max_u32 v1, v0 offset:1600
    s_mov_b64 exec, -1
    s_waitcnt lgkmcnt(3)
    v_mfma_f32_16x16x32_bf16 v[232:235], v[38:41], v[30:33], v[232:235]
    v_mfma_f32_16x16x32_bf16 v[236:239], v[38:41], v[34:37], v[236:239]
    v_lshrrev_b32 v0, 7, v28
    v_and_or_b32 v0, v0, s18, v3
    v_cmpx_eq_u32_sdwa s[62:63], s16, v28 src0_sel:DWORD src1_sel:BYTE_0
    v_bfe_u32 v1, v28, 8, 4
    v_lshl_add_u32 v52, v1, 4, v4
    v_lshrrev_b32_sdwa v52, v3, v29 dst_sel:WORD_1 dst_unused:UNUSED_PRESERVE src0_sel:DWORD src1_sel:DWORD
    s_waitcnt vmcnt(2)
    v_mfma_f32_16x16x32_bf16 v[30:33], v[24:27], v[8:11], 0
    v_mfma_f32_16x16x32_bf16 v[34:37], v[24:27], v[12:15], 0
    buffer_load_dwordx4 v[20:23], v0, s[4:7], 0 offen
    s_mov_b64 exec, s[64:65]
    v_and_b32 v0, s22, v53
    ds_write_b16_d16_hi v0, v3 offset:65280
    s_mov_b64 exec, s[66:67]
    v_and_b32 v1, s22, v54
    ds_write_b16_d16_hi v1, v54 offset:65280
    s_mov_b64 exec, -1
    ds_read_b64 v[28:29], v2 offset:2176
    v_cvt_pk_bf16_f32 v38, v30, v31
    v_cvt_pk_bf16_f32 v39, v32, v33
    v_cvt_pk_bf16_f32 v40, v34, v35
    v_cvt_pk_bf16_f32 v41, v36, v37
    ds_read_b128 v[30:33], v5
    ds_read_b128 v[34:37], v5 offset:1024
    s_waitcnt lgkmcnt(7)
    v_cmp_lt_u32_sdwa s[40:41], v6, v51 src0_sel:WORD_1 src1_sel:WORD_0
    v_mad_u32_u16 v0, v6, 6, v50 op_sel:[1,0,0,0]
    v_cmp_lt_u32_sdwa s[42:43], v6, v51 src0_sel:WORD_1 src1_sel:WORD_1
    s_mov_b64 exec, s[40:41]
    buffer_load_dwordx3 v[46:48], v0, s[8:11], 0 offen
    s_mov_b64 exec, -1
    s_andn2_b64 s[40:41], s[40:41], s[32:33]
    v_mov_b32 v0, 0
    ds_read_b32 v50, v0 offset:1608
    s_waitcnt lgkmcnt(1)
    v_mfma_f32_16x16x32_bf16 v[240:243], v[38:41], v[30:33], v[240:243]
    v_mfma_f32_16x16x32_bf16 v[244:247], v[38:41], v[34:37], v[244:247]
    v_lshrrev_b32 v0, 7, v28
    v_and_or_b32 v0, v0, s18, v3
    v_cmpx_eq_u32_sdwa s[64:65], s16, v28 src0_sel:DWORD src1_sel:BYTE_0
    v_bfe_u32 v1, v28, 8, 4
    v_lshl_add_u32 v53, v1, 4, v4
    v_lshrrev_b32_sdwa v53, v3, v29 dst_sel:WORD_1 dst_unused:UNUSED_PRESERVE src0_sel:DWORD src1_sel:DWORD
    s_waitcnt vmcnt(3)
    v_mfma_f32_16x16x32_bf16 v[30:33], v[42:45], v[8:11], 0
    v_mfma_f32_16x16x32_bf16 v[34:37], v[42:45], v[12:15], 0
    buffer_load_dwordx4 v[24:27], v0, s[4:7], 0 offen
    s_mov_b64 exec, s[66:67]
    v_and_b32 v0, s22, v54
    ds_write_b16_d16_hi v0, v3 offset:65280
    s_mov_b64 exec, s[68:69]
    v_and_b32 v1, s22, v55
    ds_write_b16_d16_hi v1, v55 offset:65280
    s_mov_b64 exec, -1
    ds_read_b64 v[28:29], v2 offset:2432
    v_cvt_pk_bf16_f32 v38, v30, v31
    v_cvt_pk_bf16_f32 v39, v32, v33
    v_cvt_pk_bf16_f32 v40, v34, v35
    v_cvt_pk_bf16_f32 v41, v36, v37
    ds_read_b128 v[30:33], v5
    ds_read_b128 v[34:37], v5 offset:1024
    s_waitcnt lgkmcnt(5)
    v_readfirstlane_b32 s36, v50
    s_cmp_lt_u32 s36, s72
    s_cbranch_scc1 B_sy24
B_syb24:
    s_cmp_lg_u32 s27, 0
    s_cbranch_scc1 B_ra25
B_rab25:
    s_add_u32 s36, s25, 32
    s_cmp_ge_u32 s36, s49
    s_cbranch_scc1 B_far29
B_farb29:
    v_add_u32_sdwa v0, s36, v6 dst_sel:DWORD dst_unused:UNUSED_PAD src0_sel:DWORD src1_sel:WORD_0
    ds_read_b64 v[50:51], v0
    s_waitcnt lgkmcnt(1)
    v_mfma_f32_16x16x32_bf16 v[248:251], v[38:41], v[30:33], v[248:251]
    v_mfma_f32_16x16x32_bf16 v[252:255], v[38:41], v[34:37], v[252:255]
    v_lshrrev_b32 v0, 7, v28
    v_and_or_b32 v0, v0, s18, v3
    v_cmpx_eq_u32_sdwa s[66:67], s16, v28 src0_sel:DWORD src1_sel:BYTE_0
    v_bfe_u32 v1, v28, 8, 4
    v_lshl_add_u32 v54, v1, 4, v4
    v_lshrrev_b32_sdwa v54, v3, v29 dst_sel:WORD_1 dst_unused:UNUSED_PRESERVE src0_sel:DWORD src1_sel:DWORD
    s_waitcnt vmcnt(3)
    v_mfma_f32_16x16x32_bf16 v[30:33], v[16:19], v[8:11], 0
    v_mfma_f32_16x16x32_bf16 v[34:37], v[16:19], v[12:15], 0
    buffer_load_dwordx4 v[16:19], v0, s[4:7], 0 offen
    s_mov_b64 exec, s[68:69]
    v_and_b32 v0, s22, v55
    ds_write_b16_d16_hi v0, v3 offset:65280
    s_mov_b64 exec, s[60:61]
    v_and_b32 v1, s22, v7
    ds_write_b16_d16_hi v1, v7 offset:65280
    s_mov_b64 exec, -1
    ds_read_b64 v[28:29], v2 offset:2688
    v_cvt_pk_bf16_f32 v38, v30, v31
    v_cvt_pk_bf16_f32 v39, v32, v33
    v_cvt_pk_bf16_f32 v40, v34, v35
    v_cvt_pk_bf16_f32 v41, v36, v37
    ds_read_b128 v[30:33], v5
    ds_read_b128 v[34:37], v5 offset:1024
    s_waitcnt lgkmcnt(5)
    v_cmp_lt_u32_sdwa s[44:45], v6, v51 src0_sel:WORD_1 src1_sel:WORD_0
    v_mad_u32_u16 v0, v6, 6, v50 op_sel:[1,0,0,0]
    v_cmp_lt_u32_sdwa s[46:47], v6, v51 src0_sel:WORD_1 src1_sel:WORD_1
    s_mov_b64 exec, s[44:45]
    buffer_load_dwordx3 v[42:44], v0, s[8:11], 0 offen
    s_mov_b64 exec, -1
    s_waitcnt vmcnt(3)
    v_cvt_f32_bf16_sdwa v0, v47 dst_sel:DWORD dst_unused:UNUSED_PAD src0_sel:WORD_1
    v_pk_mul_f32 v[0:1], v[0:1], s[70:71] op_sel_hi:[0,1]
    v_cos_f32 v0, v0
    v_cos_f32 v1, v1
    v_mov_b32 v51, 65544
    v_cvt_pk_bf16_f32 v49, v0, v1
    v_cvt_f32_bf16_sdwa v0, v47 dst_sel:DWORD dst_unused:UNUSED_PAD src0_sel:WORD_0
    v_pk_mul_f32 v[0:1], v[0:1], s[70:71] op_sel_hi:[0,1]
    v_cos_f32 v0, v0
    v_cos_f32 v1, v1
    s_and_b64 exec, s[40:41], s[30:31]
    v_cvt_pk_bf16_f32 v47, v0, v1
    v_lshlrev_b32_sdwa v0, 2, v46 dst_sel:DWORD dst_unused:UNUSED_PAD src0_sel:DWORD src1_sel:BYTE_0
    ds_add_rtn_u32 v50, v0, v51 offset:800
    s_and_b64 exec, s[42:43], s[30:31]
    v_lshlrev_b32_sdwa v0, 2, v48 dst_sel:DWORD dst_unused:UNUSED_PAD src0_sel:DWORD src1_sel:BYTE_0
    ds_add_rtn_u32 v51, v0, v51 offset:800
    s_mov_b64 exec, -1
    s_waitcnt lgkmcnt(2)
    v_mfma_f32_16x16x32_bf16 v[56:59], v[38:41], v[30:33], v[56:59]
    v_mfma_f32_16x16x32_bf16 v[60:63], v[38:41], v[34:37], v[60:63]
    v_lshrrev_b32 v0, 7, v28
    v_and_or_b32 v0, v0, s18, v3
    v_cmpx_eq_u32_sdwa s[68:69], s16, v28 src0_sel:DWORD src1_sel:BYTE_0
    v_bfe_u32 v1, v28, 8, 4
    v_lshl_add_u32 v55, v1, 4, v4
    v_lshrrev_b32_sdwa v55, v3, v29 dst_sel:WORD_1 dst_unused:UNUSED_PRESERVE src0_sel:DWORD src1_sel:DWORD
    s_waitcnt vmcnt(4)
    v_mfma_f32_16x16x32_bf16 v[30:33], v[20:23], v[8:11], 0
    v_mfma_f32_16x16x32_bf16 v[34:37], v[20:23], v[12:15], 0
    buffer_load_dwordx4 v[20:23], v0, s[4:7], 0 offen
    s_mov_b64 exec, s[60:61]
    v_and_b32 v0, s22, v7
    ds_write_b16_d16_hi v0, v3 offset:65280
    s_mov_b64 exec, s[62:63]
    v_and_b32 v1, s22, v52
    ds_write_b16_d16_hi v1, v52 offset:65280
    s_mov_b64 exec, -1
    ds_read_b64 v[28:29], v2 offset:2944
    v_cvt_pk_bf16_f32 v38, v30, v31
    v_cvt_pk_bf16_f32 v39, v32, v33
    v_cvt_pk_bf16_f32 v40, v34, v35
    v_cvt_pk_bf16_f32 v41, v36, v37
    ds_read_b128 v[30:33], v5
    ds_read_b128 v[34:37], v5 offset:1024
    s_waitcnt lgkmcnt(5)
    s_and_b64 exec, s[40:41], s[30:31]
    v_lshlrev_b32_sdwa v0, 8, v46 dst_sel:DWORD dst_unused:UNUSED_PAD src0_sel:DWORD src1_sel:BYTE_0
    v_cmp_le_u32 vcc, s19, v50
    v_and_or_b32 v0, v50, s20, v0
    s_cbranch_vccnz B_sp30
B_spb30:
    v_mov_b32_sdwa v46, s21 dst_sel:BYTE_0 dst_unused:UNUSED_PRESERVE src0_sel:BYTE_0
    ds_write_b64 v0, v[46:47] offset:51840
    s_and_b64 exec, s[42:43], s[30:31]
    v_lshlrev_b32_sdwa v0, 8, v48 dst_sel:DWORD dst_unused:UNUSED_PAD src0_sel:DWORD src1_sel:BYTE_0
    v_cmp_le_u32 vcc, s19, v51
    v_and_or_b32 v0, v51, s20, v0
    s_cbranch_vccnz B_sp31
B_spb31:
    v_mov_b32_sdwa v48, s21 dst_sel:BYTE_0 dst_unused:UNUSED_PRESERVE src0_sel:BYTE_0
    ds_write_b64 v0, v[48:49] offset:51840
    s_mov_b64 exec, -1
    s_add_u32 s36, s25, 64
    s_cmp_ge_u32 s36, s49
    s_cbranch_scc1 B_far32
B_farb32:
    v_add_u32_sdwa v0, s36, v6 dst_sel:DWORD dst_unused:UNUSED_PAD src0_sel:DWORD src1_sel:WORD_0
    ds_read_b64 v[50:51], v0
    s_waitcnt lgkmcnt(3)
    v_mfma_f32_16x16x32_bf16 v[64:67], v[38:41], v[30:33], v[64:67]
    v_mfma_f32_16x16x32_bf16 v[68:71], v[38:41], v[34:37], v[68:71]
    v_lshrrev_b32 v0, 7, v28
    v_and_or_b32 v0, v0, s18, v3
    v_cmpx_eq_u32_sdwa s[60:61], s16, v28 src0_sel:DWORD src1_sel:BYTE_0
    v_bfe_u32 v1, v28, 8, 4
    v_lshl_add_u32 v7, v1, 4, v4
    v_lshrrev_b32_sdwa v7, v3, v29 dst_sel:WORD_1 dst_unused:UNUSED_PRESERVE src0_sel:DWORD src1_sel:DWORD
    s_waitcnt vmcnt(3)
    v_mfma_f32_16x16x32_bf16 v[30:33], v[24:27], v[8:11], 0
    v_mfma_f32_16x16x32_bf16 v[34:37], v[24:27], v[12:15], 0
    buffer_load_dwordx4 v[24:27], v0, s[4:7], 0 offen
    s_mov_b64 exec, s[62:63]
    v_and_b32 v0, s22, v52
    ds_write_b16_d16_hi v0, v3 offset:65280
    s_mov_b64 exec, s[64:65]
    v_and_b32 v1, s22, v53
    ds_write_b16_d16_hi v1, v53 offset:65280
    s_mov_b64 exec, -1
    ds_read_b64 v[28:29], v2 offset:3200
    v_cvt_pk_bf16_f32 v38, v30, v31
    v_cvt_pk_bf16_f32 v39, v32, v33
    v_cvt_pk_bf16_f32 v40, v34, v35
    v_cvt_pk_bf16_f32 v41, v36, v37
    ds_read_b128 v[30:33], v5
    ds_read_b128 v[34:37], v5 offset:1024
    s_waitcnt lgkmcnt(5)
    v_cmp_lt_u32_sdwa s[40:41], v6, v51 src0_sel:WORD_1 src1_sel:WORD_0
    v_mad_u32_u16 v0, v6, 6, v50 op_sel:[1,0,0,0]
    v_cmp_lt_u32_sdwa s[42:43], v6, v51 src0_sel:WORD_1 src1_sel:WORD_1
    s_mov_b64 exec, s[40:41]
    buffer_load_dwordx3 v[46:48], v0, s[8:11], 0 offen
    s_mov_b64 exec, -1
    s_waitcnt vmcnt(3)
    v_cvt_f32_bf16_sdwa v0, v43 dst_sel:DWORD dst_unused:UNUSED_PAD src0_sel:WORD_1
    v_pk_mul_f32 v[0:1], v[0:1], s[70:71] op_sel_hi:[0,1]
    v_cos_f32 v0, v0
    v_cos_f32 v1, v1
    v_mov_b32 v51, 65544
    v_cvt_pk_bf16_f32 v45, v0, v1
    v_cvt_f32_bf16_sdwa v0, v43 dst_sel:DWORD dst_unused:UNUSED_PAD src0_sel:WORD_0
    v_pk_mul_f32 v[0:1], v[0:1], s[70:71] op_sel_hi:[0,1]
    v_cos_f32 v0, v0
    v_cos_f32 v1, v1
    s_and_b64 exec, s[44:45], s[30:31]
    v_cvt_pk_bf16_f32 v43, v0, v1
    v_lshlrev_b32_sdwa v0, 2, v42 dst_sel:DWORD dst_unused:UNUSED_PAD src0_sel:DWORD src1_sel:BYTE_0
    ds_add_rtn_u32 v50, v0, v51 offset:800
    s_and_b64 exec, s[46:47], s[30:31]
    v_lshlrev_b32_sdwa v0, 2, v44 dst_sel:DWORD dst_unused:UNUSED_PAD src0_sel:DWORD src1_sel:BYTE_0
    ds_add_rtn_u32 v51, v0, v51 offset:800
    s_mov_b64 exec, -1
    s_waitcnt lgkmcnt(2)
    v_mfma_f32_16x16x32_bf16 v[72:75], v[38:41], v[30:33], v[72:75]
    v_mfma_f32_16x16x32_bf16 v[76:79], v[38:41], v[34:37], v[76:79]
    v_lshrrev_b32 v0, 7, v28
    v_and_or_b32 v0, v0, s18, v3
    v_cmpx_eq_u32_sdwa s[62:63], s16, v28 src0_sel:DWORD src1_sel:BYTE_0
    v_bfe_u32 v1, v28, 8, 4
    v_lshl_add_u32 v52, v1, 4, v4
    v_lshrrev_b32_sdwa v52, v3, v29 dst_sel:WORD_1 dst_unused:UNUSED_PRESERVE src0_sel:DWORD src1_sel:DWORD
    s_waitcnt vmcnt(4)
    v_mfma_f32_16x16x32_bf16 v[30:33], v[16:19], v[8:11], 0
    v_mfma_f32_16x16x32_bf16 v[34:37], v[16:19], v[12:15], 0
    buffer_load_dwordx4 v[16:19], v0, s[4:7], 0 offen
    s_mov_b64 exec, s[64:65]
    v_and_b32 v0, s22, v53
    ds_write_b16_d16_hi v0, v3 offset:65280
    s_mov_b64 exec, s[66:67]
    v_and_b32 v1, s22, v54
    ds_write_b16_d16_hi v1, v54 offset:65280
    s_mov_b64 exec, -1
    ds_read_b64 v[28:29], v2 offset:3456
    v_cvt_pk_bf16_f32 v38, v30, v31
    v_cvt_pk_bf16_f32 v39, v32, v33
    v_cvt_pk_bf16_f32 v40, v34, v35
    v_cvt_pk_bf16_f32 v41, v36, v37
    ds_read_b128 v[30:33], v5
    ds_read_b128 v[34:37], v5 offset:1024
    s_waitcnt lgkmcnt(5)
    s_and_b64 exec, s[44:45], s[30:31]
    v_lshlrev_b32_sdwa v0, 8, v42 dst_sel:DWORD dst_unused:UNUSED_PAD src0_sel:DWORD src1_sel:BYTE_0
    v_cmp_le_u32 vcc, s19, v50
    v_and_or_b32 v0, v50, s20, v0
    s_cbranch_vccnz B_sp33
B_spb33:
    v_mov_b32_sdwa v42, s21 dst_sel:BYTE_0 dst_unused:UNUSED_PRESERVE src0_sel:BYTE_0
    ds_write_b64 v0, v[42:43] offset:51840
    s_and_b64 exec, s[46:47], s[30:31]
    v_lshlrev_b32_sdwa v0, 8, v44 dst_sel:DWORD dst_unused:UNUSED_PAD src0_sel:DWORD src1_sel:BYTE_0
    v_cmp_le_u32 vcc, s19, v51
    v_and_or_b32 v0, v51, s20, v0
    s_cbranch_vccnz B_sp34
B_spb34:
    v_mov_b32_sdwa v44, s21 dst_sel:BYTE_0 dst_unused:UNUSED_PRESERVE src0_sel:BYTE_0
    ds_write_b64 v0, v[44:45] offset:51840
    s_mov_b64 exec, -1
    s_add_u32 s36, s25, 96
    s_cmp_ge_u32 s36, s49
    s_cbranch_scc1 B_far35
B_farb35:
    v_add_u32_sdwa v0, s36, v6 dst_sel:DWORD dst_unused:UNUSED_PAD src0_sel:DWORD src1_sel:WORD_0
    ds_read_b64 v[50:51], v0
    s_waitcnt lgkmcnt(3)
    v_mfma_f32_16x16x32_bf16 v[80:83], v[38:41], v[30:33], v[80:83]
    v_mfma_f32_16x16x32_bf16 v[84:87], v[38:41], v[34:37], v[84:87]
    v_lshrrev_b32 v0, 7, v28
    v_and_or_b32 v0, v0, s18, v3
    v_cmpx_eq_u32_sdwa s[64:65], s16, v28 src0_sel:DWORD src1_sel:BYTE_0
    v_bfe_u32 v1, v28, 8, 4
    v_lshl_add_u32 v53, v1, 4, v4
    v_lshrrev_b32_sdwa v53, v3, v29 dst_sel:WORD_1 dst_unused:UNUSED_PRESERVE src0_sel:DWORD src1_sel:DWORD
    s_waitcnt vmcnt(3)
    v_mfma_f32_16x16x32_bf16 v[30:33], v[20:23], v[8:11], 0
    v_mfma_f32_16x16x32_bf16 v[34:37], v[20:23], v[12:15], 0
    buffer_load_dwordx4 v[20:23], v0, s[4:7], 0 offen
    s_mov_b64 exec, s[66:67]
    v_and_b32 v0, s22, v54
    ds_write_b16_d16_hi v0, v3 offset:65280
    s_mov_b64 exec, s[68:69]
    v_and_b32 v1, s22, v55
    ds_write_b16_d16_hi v1, v55 offset:65280
    s_mov_b64 exec, -1
    ds_read_b64 v[28:29], v2 offset:3712
    v_cvt_pk_bf16_f32 v38, v30, v31
    v_cvt_pk_bf16_f32 v39, v32, v33
    v_cvt_pk_bf16_f32 v40, v34, v35
    v_cvt_pk_bf16_f32 v41, v36, v37
    ds_read_b128 v[30:33], v5
    ds_read_b128 v[34:37], v5 offset:1024
    s_waitcnt lgkmcnt(5)
    v_cmp_lt_u32_sdwa s[44:45], v6, v51 src0_sel:WORD_1 src1_sel:WORD_0
    v_mad_u32_u16 v0, v6, 6, v50 op_sel:[1,0,0,0]
    v_cmp_lt_u32_sdwa s[46:47], v6, v51 src0_sel:WORD_1 src1_sel:WORD_1
    s_mov_b64 exec, s[44:45]
    buffer_load_dwordx3 v[42:44], v0, s[8:11], 0 offen
    s_mov_b64 exec, -1
    s_waitcnt vmcnt(3)
    v_cvt_f32_bf16_sdwa v0, v47 dst_sel:DWORD dst_unused:UNUSED_PAD src0_sel:WORD_1
    v_pk_mul_f32 v[0:1], v[0:1], s[70:71] op_sel_hi:[0,1]
    v_cos_f32 v0, v0
    v_cos_f32 v1, v1
    v_mov_b32 v51, 65544
    v_cvt_pk_bf16_f32 v49, v0, v1
    v_cvt_f32_bf16_sdwa v0, v47 dst_sel:DWORD dst_unused:UNUSED_PAD src0_sel:WORD_0
    v_pk_mul_f32 v[0:1], v[0:1], s[70:71] op_sel_hi:[0,1]
    v_cos_f32 v0, v0
    v_cos_f32 v1, v1
    s_and_b64 exec, s[40:41], s[30:31]
    v_cvt_pk_bf16_f32 v47, v0, v1
    v_lshlrev_b32_sdwa v0, 2, v46 dst_sel:DWORD dst_unused:UNUSED_PAD src0_sel:DWORD src1_sel:BYTE_0
    ds_add_rtn_u32 v50, v0, v51 offset:800
    s_and_b64 exec, s[42:43], s[30:31]
    v_lshlrev_b32_sdwa v0, 2, v48 dst_sel:DWORD dst_unused:UNUSED_PAD src0_sel:DWORD src1_sel:BYTE_0
    ds_add_rtn_u32 v51, v0, v51 offset:800
    s_mov_b64 exec, -1
    s_waitcnt lgkmcnt(2)
    v_mfma_f32_16x16x32_bf16 v[88:91], v[38:41], v[30:33], v[88:91]
    v_mfma_f32_16x16x32_bf16 v[92:95], v[38:41], v[34:37], v[92:95]
    v_lshrrev_b32 v0, 7, v28
    v_and_or_b32 v0, v0, s18, v3
    v_cmpx_eq_u32_sdwa s[66:67], s16, v28 src0_sel:DWORD src1_sel:BYTE_0
    v_bfe_u32 v1, v28, 8, 4
    v_lshl_add_u32 v54, v1, 4, v4
    v_lshrrev_b32_sdwa v54, v3, v29 dst_sel:WORD_1 dst_unused:UNUSED_PRESERVE src0_sel:DWORD src1_sel:DWORD
    s_waitcnt vmcnt(4)
    v_mfma_f32_16x16x32_bf16 v[30:33], v[24:27], v[8:11], 0
    v_mfma_f32_16x16x32_bf16 v[34:37], v[24:27], v[12:15], 0
    buffer_load_dwordx4 v[24:27], v0, s[4:7], 0 offen
    s_mov_b64 exec, s[68:69]
    v_and_b32 v0, s22, v55
    ds_write_b16_d16_hi v0, v3 offset:65280
    s_mov_b64 exec, s[60:61]
    v_and_b32 v1, s22, v7
    ds_write_b16_d16_hi v1, v7 offset:65280
    s_mov_b64 exec, -1
    ds_read_b64 v[28:29], v2 offset:3968
    v_cvt_pk_bf16_f32 v38, v30, v31
    v_cvt_pk_bf16_f32 v39, v32, v33
    v_cvt_pk_bf16_f32 v40, v34, v35
    v_cvt_pk_bf16_f32 v41, v36, v37
    ds_read_b128 v[30:33], v5
    ds_read_b128 v[34:37], v5 offset:1024
    s_waitcnt lgkmcnt(5)
    s_and_b64 exec, s[40:41], s[30:31]
    v_lshlrev_b32_sdwa v0, 8, v46 dst_sel:DWORD dst_unused:UNUSED_PAD src0_sel:DWORD src1_sel:BYTE_0
    v_cmp_le_u32 vcc, s19, v50
    v_and_or_b32 v0, v50, s20, v0
    s_cbranch_vccnz B_sp36
B_spb36:
    v_mov_b32_sdwa v46, s21 dst_sel:BYTE_0 dst_unused:UNUSED_PRESERVE src0_sel:BYTE_0
    ds_write_b64 v0, v[46:47] offset:51840
    s_and_b64 exec, s[42:43], s[30:31]
    v_lshlrev_b32_sdwa v0, 8, v48 dst_sel:DWORD dst_unused:UNUSED_PAD src0_sel:DWORD src1_sel:BYTE_0
    v_cmp_le_u32 vcc, s19, v51
    v_and_or_b32 v0, v51, s20, v0
    s_cbranch_vccnz B_sp37
B_spb37:
    v_mov_b32_sdwa v48, s21 dst_sel:BYTE_0 dst_unused:UNUSED_PRESERVE src0_sel:BYTE_0
    ds_write_b64 v0, v[48:49] offset:51840
    s_mov_b64 exec, -1
    s_add_u32 s36, s25, 128
    s_cmp_ge_u32 s36, s49
    s_cbranch_scc1 B_far38
B_farb38:
    v_add_u32_sdwa v0, s36, v6 dst_sel:DWORD dst_unused:UNUSED_PAD src0_sel:DWORD src1_sel:WORD_0
    ds_read_b64 v[50:51], v0
    s_waitcnt lgkmcnt(3)
    v_mfma_f32_16x16x32_bf16 v[96:99], v[38:41], v[30:33], v[96:99]
    v_mfma_f32_16x16x32_bf16 v[100:103], v[38:41], v[34:37], v[100:103]
    v_lshrrev_b32 v0, 7, v28
    v_and_or_b32 v0, v0, s18, v3
    v_cmpx_eq_u32_sdwa s[68:69], s16, v28 src0_sel:DWORD src1_sel:BYTE_0
    v_bfe_u32 v1, v28, 8, 4
    v_lshl_add_u32 v55, v1, 4, v4
    v_lshrrev_b32_sdwa v55, v3, v29 dst_sel:WORD_1 dst_unused:UNUSED_PRESERVE src0_sel:DWORD src1_sel:DWORD
    s_waitcnt vmcnt(3)
    v_mfma_f32_16x16x32_bf16 v[30:33], v[16:19], v[8:11], 0
    v_mfma_f32_16x16x32_bf16 v[34:37], v[16:19], v[12:15], 0
    buffer_load_dwordx4 v[16:19], v0, s[4:7], 0 offen
    s_mov_b64 exec, s[60:61]
    v_and_b32 v0, s22, v7
    ds_write_b16_d16_hi v0, v3 offset:65280
    s_mov_b64 exec, s[62:63]
    v_and_b32 v1, s22, v52
    ds_write_b16_d16_hi v1, v52 offset:65280
    s_mov_b64 exec, -1
    ds_read_b64 v[28:29], v2 offset:4224
    v_cvt_pk_bf16_f32 v38, v30, v31
    v_cvt_pk_bf16_f32 v39, v32, v33
    v_cvt_pk_bf16_f32 v40, v34, v35
    v_cvt_pk_bf16_f32 v41, v36, v37
    ds_read_b128 v[30:33], v5
    ds_read_b128 v[34:37], v5 offset:1024
    s_waitcnt lgkmcnt(5)
    v_cmp_lt_u32_sdwa s[40:41], v6, v51 src0_sel:WORD_1 src1_sel:WORD_0
    v_mad_u32_u16 v0, v6, 6, v50 op_sel:[1,0,0,0]
    v_cmp_lt_u32_sdwa s[42:43], v6, v51 src0_sel:WORD_1 src1_sel:WORD_1
    s_mov_b64 exec, s[40:41]
    buffer_load_dwordx3 v[46:48], v0, s[8:11], 0 offen
    s_mov_b64 exec, -1
    s_waitcnt vmcnt(3)
    v_cvt_f32_bf16_sdwa v0, v43 dst_sel:DWORD dst_unused:UNUSED_PAD src0_sel:WORD_1
    v_pk_mul_f32 v[0:1], v[0:1], s[70:71] op_sel_hi:[0,1]
    v_cos_f32 v0, v0
    v_cos_f32 v1, v1
    v_mov_b32 v51, 65544
    v_cvt_pk_bf16_f32 v45, v0, v1
    v_cvt_f32_bf16_sdwa v0, v43 dst_sel:DWORD dst_unused:UNUSED_PAD src0_sel:WORD_0
    v_pk_mul_f32 v[0:1], v[0:1], s[70:71] op_sel_hi:[0,1]
    v_cos_f32 v0, v0
    v_cos_f32 v1, v1
    s_and_b64 exec, s[44:45], s[30:31]
    v_cvt_pk_bf16_f32 v43, v0, v1
    v_lshlrev_b32_sdwa v0, 2, v42 dst_sel:DWORD dst_unused:UNUSED_PAD src0_sel:DWORD src1_sel:BYTE_0
    ds_add_rtn_u32 v50, v0, v51 offset:800
    s_and_b64 exec, s[46:47], s[30:31]
    v_lshlrev_b32_sdwa v0, 2, v44 dst_sel:DWORD dst_unused:UNUSED_PAD src0_sel:DWORD src1_sel:BYTE_0
    ds_add_rtn_u32 v51, v0, v51 offset:800
    s_mov_b64 exec, -1
    s_waitcnt lgkmcnt(2)
    v_mfma_f32_16x16x32_bf16 v[104:107], v[38:41], v[30:33], v[104:107]
    v_mfma_f32_16x16x32_bf16 v[108:111], v[38:41], v[34:37], v[108:111]
    v_lshrrev_b32 v0, 7, v28
    v_and_or_b32 v0, v0, s18, v3
    v_cmpx_eq_u32_sdwa s[60:61], s16, v28 src0_sel:DWORD src1_sel:BYTE_0
    v_bfe_u32 v1, v28, 8, 4
    v_lshl_add_u32 v7, v1, 4, v4
    v_lshrrev_b32_sdwa v7, v3, v29 dst_sel:WORD_1 dst_unused:UNUSED_PRESERVE src0_sel:DWORD src1_sel:DWORD
    s_waitcnt vmcnt(4)
    v_mfma_f32_16x16x32_bf16 v[30:33], v[20:23], v[8:11], 0
    v_mfma_f32_16x16x32_bf16 v[34:37], v[20:23], v[12:15], 0
    buffer_load_dwordx4 v[20:23], v0, s[4:7], 0 offen
    s_mov_b64 exec, s[62:63]
    v_and_b32 v0, s22, v52
    ds_write_b16_d16_hi v0, v3 offset:65280
    s_mov_b64 exec, s[64:65]
    v_and_b32 v1, s22, v53
    ds_write_b16_d16_hi v1, v53 offset:65280
    s_mov_b64 exec, -1
    ds_read_b64 v[28:29], v2 offset:4480
    v_cvt_pk_bf16_f32 v38, v30, v31
    v_cvt_pk_bf16_f32 v39, v32, v33
    v_cvt_pk_bf16_f32 v40, v34, v35
    v_cvt_pk_bf16_f32 v41, v36, v37
    ds_read_b128 v[30:33], v5
    ds_read_b128 v[34:37], v5 offset:1024
    s_waitcnt lgkmcnt(5)
    s_and_b64 exec, s[44:45], s[30:31]
    v_lshlrev_b32_sdwa v0, 8, v42 dst_sel:DWORD dst_unused:UNUSED_PAD src0_sel:DWORD src1_sel:BYTE_0
    v_cmp_le_u32 vcc, s19, v50
    v_and_or_b32 v0, v50, s20, v0
    s_cbranch_vccnz B_sp39
B_spb39:
    v_mov_b32_sdwa v42, s21 dst_sel:BYTE_0 dst_unused:UNUSED_PRESERVE src0_sel:BYTE_0
    ds_write_b64 v0, v[42:43] offset:51840
    s_and_b64 exec, s[46:47], s[30:31]
    v_lshlrev_b32_sdwa v0, 8, v44 dst_sel:DWORD dst_unused:UNUSED_PAD src0_sel:DWORD src1_sel:BYTE_0
    v_cmp_le_u32 vcc, s19, v51
    v_and_or_b32 v0, v51, s20, v0
    s_cbranch_vccnz B_sp40
B_spb40:
    v_mov_b32_sdwa v44, s21 dst_sel:BYTE_0 dst_unused:UNUSED_PRESERVE src0_sel:BYTE_0
    ds_write_b64 v0, v[44:45] offset:51840
    s_mov_b64 exec, -1
    s_add_u32 s36, s25, 160
    s_cmp_ge_u32 s36, s49
    s_cbranch_scc1 B_far41
B_farb41:
    v_add_u32_sdwa v0, s36, v6 dst_sel:DWORD dst_unused:UNUSED_PAD src0_sel:DWORD src1_sel:WORD_0
    ds_read_b64 v[50:51], v0
    s_waitcnt lgkmcnt(3)
    v_mfma_f32_16x16x32_bf16 v[112:115], v[38:41], v[30:33], v[112:115]
    v_mfma_f32_16x16x32_bf16 v[116:119], v[38:41], v[34:37], v[116:119]
    v_lshrrev_b32 v0, 7, v28
    v_and_or_b32 v0, v0, s18, v3
    v_cmpx_eq_u32_sdwa s[62:63], s16, v28 src0_sel:DWORD src1_sel:BYTE_0
    v_bfe_u32 v1, v28, 8, 4
    v_lshl_add_u32 v52, v1, 4, v4
    v_lshrrev_b32_sdwa v52, v3, v29 dst_sel:WORD_1 dst_unused:UNUSED_PRESERVE src0_sel:DWORD src1_sel:DWORD
    s_waitcnt vmcnt(3)
    v_mfma_f32_16x16x32_bf16 v[30:33], v[24:27], v[8:11], 0
    v_mfma_f32_16x16x32_bf16 v[34:37], v[24:27], v[12:15], 0
    buffer_load_dwordx4 v[24:27], v0, s[4:7], 0 offen
    s_mov_b64 exec, s[64:65]
    v_and_b32 v0, s22, v53
    ds_write_b16_d16_hi v0, v3 offset:65280
    s_mov_b64 exec, s[66:67]
    v_and_b32 v1, s22, v54
    ds_write_b16_d16_hi v1, v54 offset:65280
    s_mov_b64 exec, -1
    ds_read_b64 v[28:29], v2 offset:4736
    v_cvt_pk_bf16_f32 v38, v30, v31
    v_cvt_pk_bf16_f32 v39, v32, v33
    v_cvt_pk_bf16_f32 v40, v34, v35
    v_cvt_pk_bf16_f32 v41, v36, v37
    ds_read_b128 v[30:33], v5
    ds_read_b128 v[34:37], v5 offset:1024
    s_waitcnt lgkmcnt(5)
    v_cmp_lt_u32_sdwa s[44:45], v6, v51 src0_sel:WORD_1 src1_sel:WORD_0
    v_mad_u32_u16 v0, v6, 6, v50 op_sel:[1,0,0,0]
    v_cmp_lt_u32_sdwa s[46:47], v6, v51 src0_sel:WORD_1 src1_sel:WORD_1
    s_mov_b64 exec, s[44:45]
    buffer_load_dwordx3 v[42:44], v0, s[8:11], 0 offen
    s_mov_b64 exec, -1
    s_waitcnt vmcnt(3)
    v_cvt_f32_bf16_sdwa v0, v47 dst_sel:DWORD dst_unused:UNUSED_PAD src0_sel:WORD_1
    v_pk_mul_f32 v[0:1], v[0:1], s[70:71] op_sel_hi:[0,1]
    v_cos_f32 v0, v0
    v_cos_f32 v1, v1
    v_mov_b32 v51, 65544
    v_cvt_pk_bf16_f32 v49, v0, v1
    v_cvt_f32_bf16_sdwa v0, v47 dst_sel:DWORD dst_unused:UNUSED_PAD src0_sel:WORD_0
    v_pk_mul_f32 v[0:1], v[0:1], s[70:71] op_sel_hi:[0,1]
    v_cos_f32 v0, v0
    v_cos_f32 v1, v1
    s_and_b64 exec, s[40:41], s[30:31]
    v_cvt_pk_bf16_f32 v47, v0, v1
    v_lshlrev_b32_sdwa v0, 2, v46 dst_sel:DWORD dst_unused:UNUSED_PAD src0_sel:DWORD src1_sel:BYTE_0
    ds_add_rtn_u32 v50, v0, v51 offset:800
    s_and_b64 exec, s[42:43], s[30:31]
    v_lshlrev_b32_sdwa v0, 2, v48 dst_sel:DWORD dst_unused:UNUSED_PAD src0_sel:DWORD src1_sel:BYTE_0
    ds_add_rtn_u32 v51, v0, v51 offset:800
    s_mov_b64 exec, -1
    s_setprio 0
    s_waitcnt lgkmcnt(2)
    v_mfma_f32_16x16x32_bf16 v[120:123], v[38:41], v[30:33], v[120:123]
    v_mfma_f32_16x16x32_bf16 v[124:127], v[38:41], v[34:37], v[124:127]
    v_lshrrev_b32 v0, 7, v28
    v_and_or_b32 v0, v0, s18, v3
    v_cmpx_eq_u32_sdwa s[64:65], s16, v28 src0_sel:DWORD src1_sel:BYTE_0
    v_bfe_u32 v1, v28, 8, 4
    v_lshl_add_u32 v53, v1, 4, v4
    v_lshrrev_b32_sdwa v53, v3, v29 dst_sel:WORD_1 dst_unused:UNUSED_PRESERVE src0_sel:DWORD src1_sel:DWORD
    s_waitcnt vmcnt(4)
    v_mfma_f32_16x16x32_bf16 v[30:33], v[16:19], v[8:11], 0
    v_mfma_f32_16x16x32_bf16 v[34:37], v[16:19], v[12:15], 0
    buffer_load_dwordx4 v[16:19], v0, s[4:7], 0 offen
    s_mov_b64 exec, s[66:67]
    v_and_b32 v0, s22, v54
    ds_write_b16_d16_hi v0, v3 offset:65280
    s_mov_b64 exec, s[68:69]
    v_and_b32 v1, s22, v55
    ds_write_b16_d16_hi v1, v55 offset:65280
    s_mov_b64 exec, -1
    ds_read_b64 v[28:29], v2 offset:4992
    v_cvt_pk_bf16_f32 v38, v30, v31
    v_cvt_pk_bf16_f32 v39, v32, v33
    v_cvt_pk_bf16_f32 v40, v34, v35
    v_cvt_pk_bf16_f32 v41, v36, v37
    ds_read_b128 v[30:33], v5
    ds_read_b128 v[34:37], v5 offset:1024
    s_waitcnt lgkmcnt(5)
    s_and_b64 exec, s[40:41], s[30:31]
    v_lshlrev_b32_sdwa v0, 8, v46 dst_sel:DWORD dst_unused:UNUSED_PAD src0_sel:DWORD src1_sel:BYTE_0
    v_cmp_le_u32 vcc, s19, v50
    v_and_or_b32 v0, v50, s20, v0
    s_cbranch_vccnz B_sp42
B_spb42:
    v_mov_b32_sdwa v46, s21 dst_sel:BYTE_0 dst_unused:UNUSED_PRESERVE src0_sel:BYTE_0
    ds_write_b64 v0, v[46:47] offset:51840
    s_and_b64 exec, s[42:43], s[30:31]
    v_lshlrev_b32_sdwa v0, 8, v48 dst_sel:DWORD dst_unused:UNUSED_PAD src0_sel:DWORD src1_sel:BYTE_0
    v_cmp_le_u32 vcc, s19, v51
    v_and_or_b32 v0, v51, s20, v0
    s_cbranch_vccnz B_sp43
B_spb43:
    v_mov_b32_sdwa v48, s21 dst_sel:BYTE_0 dst_unused:UNUSED_PRESERVE src0_sel:BYTE_0
    ds_write_b64 v0, v[48:49] offset:51840
    s_mov_b64 exec, -1
    s_add_u32 s36, s25, 192
    s_cmp_ge_u32 s36, s49
    s_cbranch_scc1 B_far44
B_farb44:
    v_add_u32_sdwa v0, s36, v6 dst_sel:DWORD dst_unused:UNUSED_PAD src0_sel:DWORD src1_sel:WORD_0
    ds_read_b64 v[50:51], v0
    s_waitcnt lgkmcnt(3)
    v_mfma_f32_16x16x32_bf16 v[128:131], v[38:41], v[30:33], v[128:131]
    v_mfma_f32_16x16x32_bf16 v[132:135], v[38:41], v[34:37], v[132:135]
    v_lshrrev_b32 v0, 7, v28
    v_and_or_b32 v0, v0, s18, v3
    v_cmpx_eq_u32_sdwa s[66:67], s16, v28 src0_sel:DWORD src1_sel:BYTE_0
    v_bfe_u32 v1, v28, 8, 4
    v_lshl_add_u32 v54, v1, 4, v4
    v_lshrrev_b32_sdwa v54, v3, v29 dst_sel:WORD_1 dst_unused:UNUSED_PRESERVE src0_sel:DWORD src1_sel:DWORD
    s_waitcnt vmcnt(3)
    v_mfma_f32_16x16x32_bf16 v[30:33], v[20:23], v[8:11], 0
    v_mfma_f32_16x16x32_bf16 v[34:37], v[20:23], v[12:15], 0
    buffer_load_dwordx4 v[20:23], v0, s[4:7], 0 offen
    s_mov_b64 exec, s[68:69]
    v_and_b32 v0, s22, v55
    ds_write_b16_d16_hi v0, v3 offset:65280
    s_mov_b64 exec, s[60:61]
    v_and_b32 v1, s22, v7
    ds_write_b16_d16_hi v1, v7 offset:65280
    s_mov_b64 exec, -1
    ds_read_b64 v[28:29], v2 offset:5248
    v_cvt_pk_bf16_f32 v38, v30, v31
    v_cvt_pk_bf16_f32 v39, v32, v33
    v_cvt_pk_bf16_f32 v40, v34, v35
    v_cvt_pk_bf16_f32 v41, v36, v37
    ds_read_b128 v[30:33], v5
    ds_read_b128 v[34:37], v5 offset:1024
    s_waitcnt lgkmcnt(5)
    v_cmp_lt_u32_sdwa s[40:41], v6, v51 src0_sel:WORD_1 src1_sel:WORD_0
    v_mad_u32_u16 v0, v6, 6, v50 op_sel:[1,0,0,0]
    v_cmp_lt_u32_sdwa s[42:43], v6, v51 src0_sel:WORD_1 src1_sel:WORD_1
    s_mov_b64 exec, s[40:41]
    buffer_load_dwordx3 v[46:48], v0, s[8:11], 0 offen
    s_mov_b64 exec, -1
    s_waitcnt vmcnt(3)
    v_cvt_f32_bf16_sdwa v0, v43 dst_sel:DWORD dst_unused:UNUSED_PAD src0_sel:WORD_1
    v_pk_mul_f32 v[0:1], v[0:1], s[70:71] op_sel_hi:[0,1]
    v_cos_f32 v0, v0
    v_cos_f32 v1, v1
    v_mov_b32 v51, 65544
    v_cvt_pk_bf16_f32 v45, v0, v1
    v_cvt_f32_bf16_sdwa v0, v43 dst_sel:DWORD dst_unused:UNUSED_PAD src0_sel:WORD_0
    v_pk_mul_f32 v[0:1], v[0:1], s[70:71] op_sel_hi:[0,1]
    v_cos_f32 v0, v0
    v_cos_f32 v1, v1
    s_and_b64 exec, s[44:45], s[30:31]
    v_cvt_pk_bf16_f32 v43, v0, v1
    v_lshlrev_b32_sdwa v0, 2, v42 dst_sel:DWORD dst_unused:UNUSED_PAD src0_sel:DWORD src1_sel:BYTE_0
    ds_add_rtn_u32 v50, v0, v51 offset:800
    s_and_b64 exec, s[46:47], s[30:31]
    v_lshlrev_b32_sdwa v0, 2, v44 dst_sel:DWORD dst_unused:UNUSED_PAD src0_sel:DWORD src1_sel:BYTE_0
    ds_add_rtn_u32 v51, v0, v51 offset:800
    s_mov_b64 exec, -1
    s_waitcnt lgkmcnt(2)
    v_mfma_f32_16x16x32_bf16 v[136:139], v[38:41], v[30:33], v[136:139]
    v_mfma_f32_16x16x32_bf16 v[140:143], v[38:41], v[34:37], v[140:143]
    v_lshrrev_b32 v0, 7, v28
    v_and_or_b32 v0, v0, s18, v3
    v_cmpx_eq_u32_sdwa s[68:69], s16, v28 src0_sel:DWORD src1_sel:BYTE_0
    v_bfe_u32 v1, v28, 8, 4
    v_lshl_add_u32 v55, v1, 4, v4
    v_lshrrev_b32_sdwa v55, v3, v29 dst_sel:WORD_1 dst_unused:UNUSED_PRESERVE src0_sel:DWORD src1_sel:DWORD
    s_waitcnt vmcnt(4)
    v_mfma_f32_16x16x32_bf16 v[30:33], v[24:27], v[8:11], 0
    v_mfma_f32_16x16x32_bf16 v[34:37], v[24:27], v[12:15], 0
    buffer_load_dwordx4 v[24:27], v0, s[4:7], 0 offen
    s_mov_b64 exec, s[60:61]
    v_and_b32 v0, s22, v7
    ds_write_b16_d16_hi v0, v3 offset:65280
    s_mov_b64 exec, s[62:63]
    v_and_b32 v1, s22, v52
    ds_write_b16_d16_hi v1, v52 offset:65280
    s_mov_b64 exec, -1
    ds_read_b64 v[28:29], v2 offset:5504
    v_cvt_pk_bf16_f32 v38, v30, v31
    v_cvt_pk_bf16_f32 v39, v32, v33
    v_cvt_pk_bf16_f32 v40, v34, v35
    v_cvt_pk_bf16_f32 v41, v36, v37
    ds_read_b128 v[30:33], v5
    ds_read_b128 v[34:37], v5 offset:1024
    s_waitcnt lgkmcnt(5)
    s_and_b64 exec, s[44:45], s[30:31]
    v_lshlrev_b32_sdwa v0, 8, v42 dst_sel:DWORD dst_unused:UNUSED_PAD src0_sel:DWORD src1_sel:BYTE_0
    v_cmp_le_u32 vcc, s19, v50
    v_and_or_b32 v0, v50, s20, v0
    s_cbranch_vccnz B_sp45
B_spb45:
    v_mov_b32_sdwa v42, s21 dst_sel:BYTE_0 dst_unused:UNUSED_PRESERVE src0_sel:BYTE_0
    ds_write_b64 v0, v[42:43] offset:51840
    s_and_b64 exec, s[46:47], s[30:31]
    v_lshlrev_b32_sdwa v0, 8, v44 dst_sel:DWORD dst_unused:UNUSED_PAD src0_sel:DWORD src1_sel:BYTE_0
    v_cmp_le_u32 vcc, s19, v51
    v_and_or_b32 v0, v51, s20, v0
    s_cbranch_vccnz B_sp46
B_spb46:
    v_mov_b32_sdwa v44, s21 dst_sel:BYTE_0 dst_unused:UNUSED_PRESERVE src0_sel:BYTE_0
    ds_write_b64 v0, v[44:45] offset:51840
    s_mov_b64 exec, -1
    s_add_u32 s36, s25, 224
    s_cmp_ge_u32 s36, s49
    s_cbranch_scc1 B_far47
B_farb47:
    v_add_u32_sdwa v0, s36, v6 dst_sel:DWORD dst_unused:UNUSED_PAD src0_sel:DWORD src1_sel:WORD_0
    ds_read_b64 v[50:51], v0
    s_waitcnt lgkmcnt(3)
    v_mfma_f32_16x16x32_bf16 v[144:147], v[38:41], v[30:33], v[144:147]
    v_mfma_f32_16x16x32_bf16 v[148:151], v[38:41], v[34:37], v[148:151]
    v_lshrrev_b32 v0, 7, v28
    v_and_or_b32 v0, v0, s18, v3
    v_cmpx_eq_u32_sdwa s[60:61], s16, v28 src0_sel:DWORD src1_sel:BYTE_0
    v_bfe_u32 v1, v28, 8, 4
    v_lshl_add_u32 v7, v1, 4, v4
    v_lshrrev_b32_sdwa v7, v3, v29 dst_sel:WORD_1 dst_unused:UNUSED_PRESERVE src0_sel:DWORD src1_sel:DWORD
    s_waitcnt vmcnt(3)
    v_mfma_f32_16x16x32_bf16 v[30:33], v[16:19], v[8:11], 0
    v_mfma_f32_16x16x32_bf16 v[34:37], v[16:19], v[12:15], 0
    buffer_load_dwordx4 v[16:19], v0, s[4:7], 0 offen
    s_mov_b64 exec, s[62:63]
    v_and_b32 v0, s22, v52
    ds_write_b16_d16_hi v0, v3 offset:65280
    s_mov_b64 exec, s[64:65]
    v_and_b32 v1, s22, v53
    ds_write_b16_d16_hi v1, v53 offset:65280
    s_mov_b64 exec, -1
    ds_read_b64 v[28:29], v2 offset:5760
    v_cvt_pk_bf16_f32 v38, v30, v31
    v_cvt_pk_bf16_f32 v39, v32, v33
    v_cvt_pk_bf16_f32 v40, v34, v35
    v_cvt_pk_bf16_f32 v41, v36, v37
    ds_read_b128 v[30:33], v5
    ds_read_b128 v[34:37], v5 offset:1024
    s_waitcnt lgkmcnt(5)
    v_cmp_lt_u32_sdwa s[44:45], v6, v51 src0_sel:WORD_1 src1_sel:WORD_0
    v_mad_u32_u16 v0, v6, 6, v50 op_sel:[1,0,0,0]
    v_cmp_lt_u32_sdwa s[46:47], v6, v51 src0_sel:WORD_1 src1_sel:WORD_1
    s_mov_b64 exec, s[44:45]
    buffer_load_dwordx3 v[42:44], v0, s[8:11], 0 offen
    s_mov_b64 exec, -1
    s_waitcnt vmcnt(3)
    v_cvt_f32_bf16_sdwa v0, v47 dst_sel:DWORD dst_unused:UNUSED_PAD src0_sel:WORD_1
    v_pk_mul_f32 v[0:1], v[0:1], s[70:71] op_sel_hi:[0,1]
    v_cos_f32 v0, v0
    v_cos_f32 v1, v1
    v_mov_b32 v51, 65544
    v_cvt_pk_bf16_f32 v49, v0, v1
    v_cvt_f32_bf16_sdwa v0, v47 dst_sel:DWORD dst_unused:UNUSED_PAD src0_sel:WORD_0
    v_pk_mul_f32 v[0:1], v[0:1], s[70:71] op_sel_hi:[0,1]
    v_cos_f32 v0, v0
    v_cos_f32 v1, v1
    s_and_b64 exec, s[40:41], s[30:31]
    v_cvt_pk_bf16_f32 v47, v0, v1
    v_lshlrev_b32_sdwa v0, 2, v46 dst_sel:DWORD dst_unused:UNUSED_PAD src0_sel:DWORD src1_sel:BYTE_0
    ds_add_rtn_u32 v50, v0, v51 offset:800
    s_and_b64 exec, s[42:43], s[30:31]
    v_lshlrev_b32_sdwa v0, 2, v48 dst_sel:DWORD dst_unused:UNUSED_PAD src0_sel:DWORD src1_sel:BYTE_0
    ds_add_rtn_u32 v51, v0, v51 offset:800
    s_mov_b64 exec, -1
    s_waitcnt lgkmcnt(2)
    v_mfma_f32_16x16x32_bf16 v[152:155], v[38:41], v[30:33], v[152:155]
    v_mfma_f32_16x16x32_bf16 v[156:159], v[38:41], v[34:37], v[156:159]
    v_lshrrev_b32 v0, 7, v28
    v_and_or_b32 v0, v0, s18, v3
    v_cmpx_eq_u32_sdwa s[62:63], s16, v28 src0_sel:DWORD src1_sel:BYTE_0
    v_bfe_u32 v1, v28, 8, 4
    v_lshl_add_u32 v52, v1, 4, v4
    v_lshrrev_b32_sdwa v52, v3, v29 dst_sel:WORD_1 dst_unused:UNUSED_PRESERVE src0_sel:DWORD src1_sel:DWORD
    s_waitcnt vmcnt(4)
    v_mfma_f32_16x16x32_bf16 v[30:33], v[20:23], v[8:11], 0
    v_mfma_f32_16x16x32_bf16 v[34:37], v[20:23], v[12:15], 0
    buffer_load_dwordx4 v[20:23], v0, s[4:7], 0 offen
    s_mov_b64 exec, s[64:65]
    v_and_b32 v0, s22, v53
    ds_write_b16_d16_hi v0, v3 offset:65280
    s_mov_b64 exec, s[66:67]
    v_and_b32 v1, s22, v54
    ds_write_b16_d16_hi v1, v54 offset:65280
    s_mov_b64 exec, -1
    ds_read_b64 v[28:29], v2 offset:6016
    v_cvt_pk_bf16_f32 v38, v30, v31
    v_cvt_pk_bf16_f32 v39, v32, v33
    v_cvt_pk_bf16_f32 v40, v34, v35
    v_cvt_pk_bf16_f32 v41, v36, v37
    ds_read_b128 v[30:33], v5
    ds_read_b128 v[34:37], v5 offset:1024
    s_waitcnt lgkmcnt(5)
    s_and_b64 exec, s[40:41], s[30:31]
    v_lshlrev_b32_sdwa v0, 8, v46 dst_sel:DWORD dst_unused:UNUSED_PAD src0_sel:DWORD src1_sel:BYTE_0
    v_cmp_le_u32 vcc, s19, v50
    v_and_or_b32 v0, v50, s20, v0
    s_cbranch_vccnz B_sp48
B_spb48:
    v_mov_b32_sdwa v46, s21 dst_sel:BYTE_0 dst_unused:UNUSED_PRESERVE src0_sel:BYTE_0
    ds_write_b64 v0, v[46:47] offset:51840
    s_and_b64 exec, s[42:43], s[30:31]
    v_lshlrev_b32_sdwa v0, 8, v48 dst_sel:DWORD dst_unused:UNUSED_PAD src0_sel:DWORD src1_sel:BYTE_0
    v_cmp_le_u32 vcc, s19, v51
    v_and_or_b32 v0, v51, s20, v0
    s_cbranch_vccnz B_sp49
B_spb49:
    v_mov_b32_sdwa v48, s21 dst_sel:BYTE_0 dst_unused:UNUSED_PRESERVE src0_sel:BYTE_0
    ds_write_b64 v0, v[48:49] offset:51840
    s_mov_b64 exec, -1
    s_waitcnt lgkmcnt(2)
    v_mfma_f32_16x16x32_bf16 v[160:163], v[38:41], v[30:33], v[160:163]
    v_mfma_f32_16x16x32_bf16 v[164:167], v[38:41], v[34:37], v[164:167]
    v_lshrrev_b32 v0, 7, v28
    v_and_or_b32 v0, v0, s18, v3
    v_cmpx_eq_u32_sdwa s[64:65], s16, v28 src0_sel:DWORD src1_sel:BYTE_0
    v_bfe_u32 v1, v28, 8, 4
    v_lshl_add_u32 v53, v1, 4, v4
    v_lshrrev_b32_sdwa v53, v3, v29 dst_sel:WORD_1 dst_unused:UNUSED_PRESERVE src0_sel:DWORD src1_sel:DWORD
    s_waitcnt vmcnt(3)
    v_mfma_f32_16x16x32_bf16 v[30:33], v[24:27], v[8:11], 0
    v_mfma_f32_16x16x32_bf16 v[34:37], v[24:27], v[12:15], 0
    buffer_load_dwordx4 v[24:27], v0, s[4:7], 0 offen
    s_mov_b64 exec, s[66:67]
    v_and_b32 v0, s22, v54
    ds_write_b16_d16_hi v0, v3 offset:65280
    s_mov_b64 exec, s[68:69]
    v_and_b32 v1, s22, v55
    ds_write_b16_d16_hi v1, v55 offset:65280
    s_mov_b64 exec, -1
    ds_read_b64 v[28:29], v2 offset:6272
    v_cvt_pk_bf16_f32 v38, v30, v31
    v_cvt_pk_bf16_f32 v39, v32, v33
    v_cvt_pk_bf16_f32 v40, v34, v35
    v_cvt_pk_bf16_f32 v41, v36, v37
    ds_read_b128 v[30:33], v5
    ds_read_b128 v[34:37], v5 offset:1024
    s_waitcnt vmcnt(2)
    v_cvt_f32_bf16_sdwa v0, v43 dst_sel:DWORD dst_unused:UNUSED_PAD src0_sel:WORD_1
    v_pk_mul_f32 v[0:1], v[0:1], s[70:71] op_sel_hi:[0,1]
    v_cos_f32 v0, v0
    v_cos_f32 v1, v1
    v_mov_b32 v51, 65544
    v_cvt_pk_bf16_f32 v45, v0, v1
    v_cvt_f32_bf16_sdwa v0, v43 dst_sel:DWORD dst_unused:UNUSED_PAD src0_sel:WORD_0
    v_pk_mul_f32 v[0:1], v[0:1], s[70:71] op_sel_hi:[0,1]
    v_cos_f32 v0, v0
    v_cos_f32 v1, v1
    s_and_b64 exec, s[44:45], s[30:31]
    v_cvt_pk_bf16_f32 v43, v0, v1
    v_lshlrev_b32_sdwa v0, 2, v42 dst_sel:DWORD dst_unused:UNUSED_PAD src0_sel:DWORD src1_sel:BYTE_0
    ds_add_rtn_u32 v50, v0, v51 offset:800
    s_and_b64 exec, s[46:47], s[30:31]
    v_lshlrev_b32_sdwa v0, 2, v44 dst_sel:DWORD dst_unused:UNUSED_PAD src0_sel:DWORD src1_sel:BYTE_0
    ds_add_rtn_u32 v51, v0, v51 offset:800
    s_mov_b64 exec, -1
    s_waitcnt lgkmcnt(2)
    v_mfma_f32_16x16x32_bf16 v[168:171], v[38:41], v[30:33], v[168:171]
    v_mfma_f32_16x16x32_bf16 v[172:175], v[38:41], v[34:37], v[172:175]
    v_lshrrev_b32 v0, 7, v28
    v_and_or_b32 v0, v0, s18, v3
    v_cmpx_eq_u32_sdwa s[66:67], s16, v28 src0_sel:DWORD src1_sel:BYTE_0
    v_bfe_u32 v1, v28, 8, 4
    v_lshl_add_u32 v54, v1, 4, v4
    v_lshrrev_b32_sdwa v54, v3, v29 dst_sel:WORD_1 dst_unused:UNUSED_PRESERVE src0_sel:DWORD src1_sel:DWORD
    s_waitcnt vmcnt(3)
    v_mfma_f32_16x16x32_bf16 v[30:33], v[16:19], v[8:11], 0
    v_mfma_f32_16x16x32_bf16 v[34:37], v[16:19], v[12:15], 0
    buffer_load_dwordx4 v[16:19], v0, s[4:7], 0 offen
    s_mov_b64 exec, s[68:69]
    v_and_b32 v0, s22, v55
    ds_write_b16_d16_hi v0, v3 offset:65280
    s_mov_b64 exec, s[60:61]
    v_and_b32 v1, s22, v7
    ds_write_b16_d16_hi v1, v7 offset:65280
    s_mov_b64 exec, -1
    ds_read_b64 v[28:29], v2 offset:6528
    v_cvt_pk_bf16_f32 v38, v30, v31
    v_cvt_pk_bf16_f32 v39, v32, v33
    v_cvt_pk_bf16_f32 v40, v34, v35
    v_cvt_pk_bf16_f32 v41, v36, v37
    ds_read_b128 v[30:33], v5
    ds_read_b128 v[34:37], v5 offset:1024
    s_waitcnt lgkmcnt(5)
    s_and_b64 exec, s[44:45], s[30:31]
    v_lshlrev_b32_sdwa v0, 8, v42 dst_sel:DWORD dst_unused:UNUSED_PAD src0_sel:DWORD src1_sel:BYTE_0
    v_cmp_le_u32 vcc, s19, v50
    v_and_or_b32 v0, v50, s20, v0
    s_cbranch_vccnz B_sp50
B_spb50:
    v_mov_b32_sdwa v42, s21 dst_sel:BYTE_0 dst_unused:UNUSED_PRESERVE src0_sel:BYTE_0
    ds_write_b64 v0, v[42:43] offset:51840
    s_and_b64 exec, s[46:47], s[30:31]
    v_lshlrev_b32_sdwa v0, 8, v44 dst_sel:DWORD dst_unused:UNUSED_PAD src0_sel:DWORD src1_sel:BYTE_0
    v_cmp_le_u32 vcc, s19, v51
    v_and_or_b32 v0, v51, s20, v0
    s_cbranch_vccnz B_sp51
B_spb51:
    v_mov_b32_sdwa v44, s21 dst_sel:BYTE_0 dst_unused:UNUSED_PRESERVE src0_sel:BYTE_0
    ds_write_b64 v0, v[44:45] offset:51840
    s_mov_b64 exec, -1
    s_mov_b64 exec, 1
    v_mov_b32 v0, 0
    v_mov_b32 v1, 1
    ds_add_u32 v0, v1 offset:1604
    s_mov_b64 exec, -1
    s_waitcnt lgkmcnt(3)
    v_mfma_f32_16x16x32_bf16 v[176:179], v[38:41], v[30:33], v[176:179]
    v_mfma_f32_16x16x32_bf16 v[180:183], v[38:41], v[34:37], v[180:183]
    v_lshrrev_b32 v0, 7, v28
    v_and_or_b32 v0, v0, s18, v3
    v_cmpx_eq_u32_sdwa s[68:69], s16, v28 src0_sel:DWORD src1_sel:BYTE_0
    v_bfe_u32 v1, v28, 8, 4
    v_lshl_add_u32 v55, v1, 4, v4
    v_lshrrev_b32_sdwa v55, v3, v29 dst_sel:WORD_1 dst_unused:UNUSED_PRESERVE src0_sel:DWORD src1_sel:DWORD
    s_waitcnt vmcnt(2)
    v_mfma_f32_16x16x32_bf16 v[30:33], v[20:23], v[8:11], 0
    v_mfma_f32_16x16x32_bf16 v[34:37], v[20:23], v[12:15], 0
    buffer_load_dwordx4 v[20:23], v0, s[4:7], 0 offen
    s_mov_b64 exec, s[60:61]
    v_and_b32 v0, s22, v7
    ds_write_b16_d16_hi v0, v3 offset:65280
    s_mov_b64 exec, s[62:63]
    v_and_b32 v1, s22, v52
    ds_write_b16_d16_hi v1, v52 offset:65280
    s_mov_b64 exec, -1
    ds_read_b64 v[28:29], v2 offset:6784
    v_cvt_pk_bf16_f32 v38, v30, v31
    v_cvt_pk_bf16_f32 v39, v32, v33
    v_cvt_pk_bf16_f32 v40, v34, v35
    v_cvt_pk_bf16_f32 v41, v36, v37
    ds_read_b128 v[30:33], v5
    ds_read_b128 v[34:37], v5 offset:1024
    s_waitcnt lgkmcnt(0)
    v_mfma_f32_16x16x32_bf16 v[184:187], v[38:41], v[30:33], v[184:187]
    v_mfma_f32_16x16x32_bf16 v[188:191], v[38:41], v[34:37], v[188:191]
    v_lshrrev_b32 v0, 7, v28
    v_and_or_b32 v0, v0, s18, v3
    v_cmpx_eq_u32_sdwa s[60:61], s16, v28 src0_sel:DWORD src1_sel:BYTE_0
    v_bfe_u32 v1, v28, 8, 4
    v_lshl_add_u32 v7, v1, 4, v4
    v_lshrrev_b32_sdwa v7, v3, v29 dst_sel:WORD_1 dst_unused:UNUSED_PRESERVE src0_sel:DWORD src1_sel:DWORD
    s_waitcnt vmcnt(2)
    v_mfma_f32_16x16x32_bf16 v[30:33], v[24:27], v[8:11], 0
    v_mfma_f32_16x16x32_bf16 v[34:37], v[24:27], v[12:15], 0
    buffer_load_dwordx4 v[24:27], v0, s[4:7], 0 offen
    s_mov_b64 exec, s[62:63]
    v_and_b32 v0, s22, v52
    ds_write_b16_d16_hi v0, v3 offset:65280
    s_mov_b64 exec, s[64:65]
    v_and_b32 v1, s22, v53
    ds_write_b16_d16_hi v1, v53 offset:65280
    s_mov_b64 exec, -1
    ds_read_b64 v[28:29], v2 offset:7040
    v_cvt_pk_bf16_f32 v38, v30, v31
    v_cvt_pk_bf16_f32 v39, v32, v33
    v_cvt_pk_bf16_f32 v40, v34, v35
    v_cvt_pk_bf16_f32 v41, v36, v37
    ds_read_b128 v[30:33], v5
    ds_read_b128 v[34:37], v5 offset:1024
    s_waitcnt lgkmcnt(0)
    v_mfma_f32_16x16x32_bf16 v[192:195], v[38:41], v[30:33], v[192:195]
    v_mfma_f32_16x16x32_bf16 v[196:199], v[38:41], v[34:37], v[196:199]
    v_lshrrev_b32 v0, 7, v28
    v_and_or_b32 v0, v0, s18, v3
    v_cmpx_eq_u32_sdwa s[62:63], s16, v28 src0_sel:DWORD src1_sel:BYTE_0
    v_bfe_u32 v1, v28, 8, 4
    v_lshl_add_u32 v52, v1, 4, v4
    v_lshrrev_b32_sdwa v52, v3, v29 dst_sel:WORD_1 dst_unused:UNUSED_PRESERVE src0_sel:DWORD src1_sel:DWORD
    s_waitcnt vmcnt(2)
    v_mfma_f32_16x16x32_bf16 v[30:33], v[16:19], v[8:11], 0
    v_mfma_f32_16x16x32_bf16 v[34:37], v[16:19], v[12:15], 0
    buffer_load_dwordx4 v[16:19], v0, s[4:7], 0 offen
    s_mov_b64 exec, s[64:65]
    v_and_b32 v0, s22, v53
    ds_write_b16_d16_hi v0, v3 offset:65280
    s_mov_b64 exec, s[66:67]
    v_and_b32 v1, s22, v54
    ds_write_b16_d16_hi v1, v54 offset:65280
    s_mov_b64 exec, -1
    ds_read_b64 v[28:29], v2 offset:7296
    v_cvt_pk_bf16_f32 v38, v30, v31
    v_cvt_pk_bf16_f32 v39, v32, v33
    v_cvt_pk_bf16_f32 v40, v34, v35
    v_cvt_pk_bf16_f32 v41, v36, v37
    ds_read_b128 v[30:33], v5
    ds_read_b128 v[34:37], v5 offset:1024
    s_waitcnt lgkmcnt(0)
    v_mfma_f32_16x16x32_bf16 v[200:203], v[38:41], v[30:33], v[200:203]
    v_mfma_f32_16x16x32_bf16 v[204:207], v[38:41], v[34:37], v[204:207]
    v_lshrrev_b32 v0, 7, v28
    v_and_or_b32 v0, v0, s18, v3
    v_cmpx_eq_u32_sdwa s[64:65], s16, v28 src0_sel:DWORD src1_sel:BYTE_0
    v_bfe_u32 v1, v28, 8, 4
    v_lshl_add_u32 v53, v1, 4, v4
    v_lshrrev_b32_sdwa v53, v3, v29 dst_sel:WORD_1 dst_unused:UNUSED_PRESERVE src0_sel:DWORD src1_sel:DWORD
    s_waitcnt vmcnt(2)
    v_mfma_f32_16x16x32_bf16 v[30:33], v[20:23], v[8:11], 0
    v_mfma_f32_16x16x32_bf16 v[34:37], v[20:23], v[12:15], 0
    buffer_load_dwordx4 v[20:23], v0, s[4:7], 0 offen
    s_mov_b64 exec, s[66:67]
    v_and_b32 v0, s22, v54
    ds_write_b16_d16_hi v0, v3 offset:65280
    s_mov_b64 exec, s[68:69]
    v_and_b32 v1, s22, v55
    ds_write_b16_d16_hi v1, v55 offset:65280
    s_mov_b64 exec, -1
    ds_read_b64 v[28:29], v2 offset:7552
    v_cvt_pk_bf16_f32 v38, v30, v31
    v_cvt_pk_bf16_f32 v39, v32, v33
    v_cvt_pk_bf16_f32 v40, v34, v35
    v_cvt_pk_bf16_f32 v41, v36, v37
    ds_read_b128 v[30:33], v5
    ds_read_b128 v[34:37], v5 offset:1024
    s_waitcnt lgkmcnt(0)
    v_mfma_f32_16x16x32_bf16 v[208:211], v[38:41], v[30:33], v[208:211]
    v_mfma_f32_16x16x32_bf16 v[212:215], v[38:41], v[34:37], v[212:215]
    v_lshrrev_b32 v0, 7, v28
    v_and_or_b32 v0, v0, s18, v3
    v_cmpx_eq_u32_sdwa s[66:67], s16, v28 src0_sel:DWORD src1_sel:BYTE_0
    v_bfe_u32 v1, v28, 8, 4
    v_lshl_add_u32 v54, v1, 4, v4
    v_lshrrev_b32_sdwa v54, v3, v29 dst_sel:WORD_1 dst_unused:UNUSED_PRESERVE src0_sel:DWORD src1_sel:DWORD
    s_waitcnt vmcnt(2)
    v_mfma_f32_16x16x32_bf16 v[30:33], v[24:27], v[8:11], 0
    v_mfma_f32_16x16x32_bf16 v[34:37], v[24:27], v[12:15], 0
    buffer_load_dwordx4 v[24:27], v0, s[4:7], 0 offen
    s_mov_b64 exec, s[68:69]
    v_and_b32 v0, s22, v55
    ds_write_b16_d16_hi v0, v3 offset:65280
    s_mov_b64 exec, s[60:61]
    v_and_b32 v1, s22, v7
    ds_write_b16_d16_hi v1, v7 offset:65280
    s_mov_b64 exec, -1
    ds_read_b64 v[28:29], v2 offset:7808
    v_cvt_pk_bf16_f32 v38, v30, v31
    v_cvt_pk_bf16_f32 v39, v32, v33
    v_cvt_pk_bf16_f32 v40, v34, v35
    v_cvt_pk_bf16_f32 v41, v36, v37
    ds_read_b128 v[30:33], v5
    ds_read_b128 v[34:37], v5 offset:1024
    v_mov_b32 v42, 0
    v_mov_b32 v43, 0
    v_mov_b32 v44, 0
    v_mov_b32 v45, 0
    s_add_u32 s36, s34, 1
    s_and_b32 s36, s36, 126
    s_cbranch_scc0 B_cl52
B_clb52:
    s_mov_b64 exec, 1
    v_mov_b32 v0, 0
    v_mov_b32 v1, 1
    ds_add_u32 v0, v1 offset:1608
    s_mov_b64 exec, -1
    s_waitcnt lgkmcnt(1)
    v_mfma_f32_16x16x32_bf16 v[216:219], v[38:41], v[30:33], v[216:219]
    v_mfma_f32_16x16x32_bf16 v[220:223], v[38:41], v[34:37], v[220:223]
    v_lshrrev_b32 v0, 7, v28
    v_and_or_b32 v0, v0, s18, v3
    v_cmpx_eq_u32_sdwa s[68:69], s17, v28 src0_sel:DWORD src1_sel:BYTE_0
    v_bfe_u32 v1, v28, 8, 4
    v_lshl_add_u32 v55, v1, 4, v4
    v_lshrrev_b32_sdwa v55, v3, v29 dst_sel:WORD_1 dst_unused:UNUSED_PRESERVE src0_sel:DWORD src1_sel:DWORD
    s_waitcnt vmcnt(2)
    v_mfma_f32_16x16x32_bf16 v[30:33], v[16:19], v[8:11], 0
    v_mfma_f32_16x16x32_bf16 v[34:37], v[16:19], v[12:15], 0
    buffer_load_dwordx4 v[42:45], v0, s[4:7], 0 offen
    s_mov_b64 exec, s[60:61]
    v_and_b32 v0, s22, v7
    ds_write_b16_d16_hi v0, v3 offset:65280
    s_mov_b64 exec, s[62:63]
    v_and_b32 v1, s22, v52
    ds_write_b16_d16_hi v1, v52 offset:65280
    s_mov_b64 exec, -1
    v_cvt_pk_bf16_f32 v38, v30, v31
    v_cvt_pk_bf16_f32 v39, v32, v33
    v_cvt_pk_bf16_f32 v40, v34, v35
    v_cvt_pk_bf16_f32 v41, v36, v37
    ds_read_b128 v[30:33], v5
    ds_read_b128 v[34:37], v5 offset:1024
    v_mov_b32 v0, 0
    ds_read_b32 v50, v0 offset:1604
    s_add_u32 s25, s25, 256
    s_mov_b64 s[32:33], 0
    s_cmp_eq_u32 s30, 0
    s_cbranch_scc1 B_st53
B_stb53:
    s_add_u32 s34, s34, 1
    s_add_u32 s72, s72, 8
    s_mov_b32 s16, s21
    s_add_u32 s21, s21, 1
    s_and_b32 s21, s21, 255
    s_or_b32 s17, s16, s50
    s_waitcnt lgkmcnt(0)
    v_readfirstlane_b32 s36, v50
    s_cmp_lt_u32 s36, s72
    s_cbranch_scc1 B_sy54
B_syb54:
B_loop1:
    s_cmp_lt_u32 s25, s26
    s_cselect_b32 s36, 1, s27
    s_cmp_eq_u32 s36, 0
    s_cbranch_scc1 B_free1
    ds_read_b64 v[28:29], v2 offset:51840
    s_cmp_eq_u32 s50, 0
    s_cbranch_scc1 B_pr1_0
    s_setprio 1
B_pr1_0:
    v_mfma_f32_16x16x32_bf16 v[224:227], v[38:41], v[30:33], v[224:227]
    v_mfma_f32_16x16x32_bf16 v[228:231], v[38:41], v[34:37], v[228:231]
    s_waitcnt lgkmcnt(0)
    v_lshrrev_b32 v0, 7, v28
    v_and_or_b32 v0, v0, s18, v3
    v_cmpx_eq_u32_sdwa s[60:61], s16, v28 src0_sel:DWORD src1_sel:BYTE_0
    v_bfe_u32 v1, v28, 8, 4
    v_lshl_add_u32 v7, v1, 4, v4
    v_lshrrev_b32_sdwa v7, v3, v29 dst_sel:WORD_1 dst_unused:UNUSED_PRESERVE src0_sel:DWORD src1_sel:DWORD
    s_waitcnt vmcnt(2)
    v_mfma_f32_16x16x32_bf16 v[30:33], v[20:23], v[8:11], 0
    v_mfma_f32_16x16x32_bf16 v[34:37], v[20:23], v[12:15], 0
    buffer_load_dwordx4 v[16:19], v0, s[4:7], 0 offen
    s_mov_b64 exec, s[62:63]
    v_and_b32 v0, s22, v52
    ds_write_b16_d16_hi v0, v3 offset:65280
    s_mov_b64 exec, s[64:65]
    v_and_b32 v1, s22, v53
    ds_write_b16_d16_hi v1, v53 offset:65280
    s_mov_b64 exec, -1
    ds_read_b64 v[28:29], v2 offset:52096
    v_cvt_pk_bf16_f32 v38, v30, v31
    v_cvt_pk_bf16_f32 v39, v32, v33
    v_cvt_pk_bf16_f32 v40, v34, v35
    v_cvt_pk_bf16_f32 v41, v36, v37
    ds_read_b128 v[30:33], v5
    ds_read_b128 v[34:37], v5 offset:1024
    s_add_u32 s36, s25, 0
    s_cmp_ge_u32 s36, s49
    s_cbranch_scc1 B_far55
B_farb55:
    v_add_u32_sdwa v0, s36, v6 dst_sel:DWORD dst_unused:UNUSED_PAD src0_sel:DWORD src1_sel:WORD_0
    ds_read_b64 v[50:51], v0
    s_movk_i32 s36, 800
    v_mbcnt_lo_u32_b32 v0, -1, 0
    v_mbcnt_hi_u32_b32 v0, -1, v0
    v_add_u32 v0, s51, v0
    v_and_b32 v1, 31, v0
    v_lshl_add_u32 v0, v0, 2, s36
    v_lshlrev_b32 v1, 3, v1
    s_mov_b64 exec, s[52:53]
    ds_write_b32 v0, v1 offset:0
    s_mov_b64 exec, 1
    v_mov_b32 v0, s34
    v_mov_b32 v1, 0
    ds_max_u32 v1, v0 offset:1600
    s_mov_b64 exec, -1
    s_waitcnt lgkmcnt(3)
    v_mfma_f32_16x16x32_bf16 v[232:235], v[38:41], v[30:33], v[232:235]
    v_mfma_f32_16x16x32_bf16 v[236:239], v[38:41], v[34:37], v[236:239]
    v_lshrrev_b32 v0, 7, v28
    v_and_or_b32 v0, v0, s18, v3
    v_cmpx_eq_u32_sdwa s[62:63], s16, v28 src0_sel:DWORD src1_sel:BYTE_0
    v_bfe_u32 v1, v28, 8, 4
    v_lshl_add_u32 v52, v1, 4, v4
    v_lshrrev_b32_sdwa v52, v3, v29 dst_sel:WORD_1 dst_unused:UNUSED_PRESERVE src0_sel:DWORD src1_sel:DWORD
    s_waitcnt vmcnt(2)
    v_mfma_f32_16x16x32_bf16 v[30:33], v[24:27], v[8:11], 0
    v_mfma_f32_16x16x32_bf16 v[34:37], v[24:27], v[12:15], 0
    buffer_load_dwordx4 v[20:23], v0, s[4:7], 0 offen
    s_mov_b64 exec, s[64:65]
    v_and_b32 v0, s22, v53
    ds_write_b16_d16_hi v0, v3 offset:65280
    s_mov_b64 exec, s[66:67]
    v_and_b32 v1, s22, v54
    ds_write_b16_d16_hi v1, v54 offset:65280
    s_mov_b64 exec, -1
    ds_read_b64 v[28:29], v2 offset:52352
    v_cvt_pk_bf16_f32 v38, v30, v31
    v_cvt_pk_bf16_f32 v39, v32, v33
    v_cvt_pk_bf16_f32 v40, v34, v35
    v_cvt_pk_bf16_f32 v41, v36, v37
    ds_read_b128 v[30:33], v5
    ds_read_b128 v[34:37], v5 offset:1024
    s_waitcnt lgkmcnt(7)
    v_cmp_lt_u32_sdwa s[40:41], v6, v51 src0_sel:WORD_1 src1_sel:WORD_0
    v_mad_u32_u16 v0, v6, 6, v50 op_sel:[1,0,0,0]
    v_cmp_lt_u32_sdwa s[42:43], v6, v51 src0_sel:WORD_1 src1_sel:WORD_1
    s_mov_b64 exec, s[40:41]
    buffer_load_dwordx3 v[46:48], v0, s[8:11], 0 offen
    s_mov_b64 exec, -1
    s_andn2_b64 s[40:41], s[40:41], s[32:33]
    v_mov_b32 v0, 0
    ds_read_b32 v50, v0 offset:1608
    s_waitcnt lgkmcnt(1)
    v_mfma_f32_16x16x32_bf16 v[240:243], v[38:41], v[30:33], v[240:243]
    v_mfma_f32_16x16x32_bf16 v[244:247], v[38:41], v[34:37], v[244:247]
    v_lshrrev_b32 v0, 7, v28
    v_and_or_b32 v0, v0, s18, v3
    v_cmpx_eq_u32_sdwa s[64:65], s16, v28 src0_sel:DWORD src1_sel:BYTE_0
    v_bfe_u32 v1, v28, 8, 4
    v_lshl_add_u32 v53, v1, 4, v4
    v_lshrrev_b32_sdwa v53, v3, v29 dst_sel:WORD_1 dst_unused:UNUSED_PRESERVE src0_sel:DWORD src1_sel:DWORD
    s_waitcnt vmcnt(3)
    v_mfma_f32_16x16x32_bf16 v[30:33], v[42:45], v[8:11], 0
    v_mfma_f32_16x16x32_bf16 v[34:37], v[42:45], v[12:15], 0
    buffer_load_dwordx4 v[24:27], v0, s[4:7], 0 offen
    s_mov_b64 exec, s[66:67]
    v_and_b32 v0, s22, v54
    ds_write_b16_d16_hi v0, v3 offset:65280
    s_mov_b64 exec, s[68:69]
    v_and_b32 v1, s22, v55
    ds_write_b16_d16_hi v1, v55 offset:65280
    s_mov_b64 exec, -1
    ds_read_b64 v[28:29], v2 offset:52608
    v_cvt_pk_bf16_f32 v38, v30, v31
    v_cvt_pk_bf16_f32 v39, v32, v33
    v_cvt_pk_bf16_f32 v40, v34, v35
    v_cvt_pk_bf16_f32 v41, v36, v37
    ds_read_b128 v[30:33], v5
    ds_read_b128 v[34:37], v5 offset:1024
    s_waitcnt lgkmcnt(5)
    v_readfirstlane_b32 s36, v50
    s_cmp_lt_u32 s36, s72
    s_cbranch_scc1 B_sy56
B_syb56:
    s_cmp_lg_u32 s27, 0
    s_cbranch_scc1 B_ra57
B_rab57:
    s_add_u32 s36, s25, 32
    s_cmp_ge_u32 s36, s49
    s_cbranch_scc1 B_far61
B_farb61:
    v_add_u32_sdwa v0, s36, v6 dst_sel:DWORD dst_unused:UNUSED_PAD src0_sel:DWORD src1_sel:WORD_0
    ds_read_b64 v[50:51], v0
    s_waitcnt lgkmcnt(1)
    v_mfma_f32_16x16x32_bf16 v[248:251], v[38:41], v[30:33], v[248:251]
    v_mfma_f32_16x16x32_bf16 v[252:255], v[38:41], v[34:37], v[252:255]
    v_lshrrev_b32 v0, 7, v28
    v_and_or_b32 v0, v0, s18, v3
    v_cmpx_eq_u32_sdwa s[66:67], s16, v28 src0_sel:DWORD src1_sel:BYTE_0
    v_bfe_u32 v1, v28, 8, 4
    v_lshl_add_u32 v54, v1, 4, v4
    v_lshrrev_b32_sdwa v54, v3, v29 dst_sel:WORD_1 dst_unused:UNUSED_PRESERVE src0_sel:DWORD src1_sel:DWORD
    s_waitcnt vmcnt(3)
    v_mfma_f32_16x16x32_bf16 v[30:33], v[16:19], v[8:11], 0
    v_mfma_f32_16x16x32_bf16 v[34:37], v[16:19], v[12:15], 0
    buffer_load_dwordx4 v[16:19], v0, s[4:7], 0 offen
    s_mov_b64 exec, s[68:69]
    v_and_b32 v0, s22, v55
    ds_write_b16_d16_hi v0, v3 offset:65280
    s_mov_b64 exec, s[60:61]
    v_and_b32 v1, s22, v7
    ds_write_b16_d16_hi v1, v7 offset:65280
    s_mov_b64 exec, -1
    ds_read_b64 v[28:29], v2 offset:52864
    v_cvt_pk_bf16_f32 v38, v30, v31
    v_cvt_pk_bf16_f32 v39, v32, v33
    v_cvt_pk_bf16_f32 v40, v34, v35
    v_cvt_pk_bf16_f32 v41, v36, v37
    ds_read_b128 v[30:33], v5
    ds_read_b128 v[34:37], v5 offset:1024
    s_waitcnt lgkmcnt(5)
    v_cmp_lt_u32_sdwa s[44:45], v6, v51 src0_sel:WORD_1 src1_sel:WORD_0
    v_mad_u32_u16 v0, v6, 6, v50 op_sel:[1,0,0,0]
    v_cmp_lt_u32_sdwa s[46:47], v6, v51 src0_sel:WORD_1 src1_sel:WORD_1
    s_mov_b64 exec, s[44:45]
    buffer_load_dwordx3 v[42:44], v0, s[8:11], 0 offen
    s_mov_b64 exec, -1
    s_waitcnt vmcnt(3)
    v_cvt_f32_bf16_sdwa v0, v47 dst_sel:DWORD dst_unused:UNUSED_PAD src0_sel:WORD_1
    v_pk_mul_f32 v[0:1], v[0:1], s[70:71] op_sel_hi:[0,1]
    v_cos_f32 v0, v0
    v_cos_f32 v1, v1
    v_mov_b32 v51, 65544
    v_cvt_pk_bf16_f32 v49, v0, v1
    v_cvt_f32_bf16_sdwa v0, v47 dst_sel:DWORD dst_unused:UNUSED_PAD src0_sel:WORD_0
    v_pk_mul_f32 v[0:1], v[0:1], s[70:71] op_sel_hi:[0,1]
    v_cos_f32 v0, v0
    v_cos_f32 v1, v1
    s_and_b64 exec, s[40:41], s[30:31]
    v_cvt_pk_bf16_f32 v47, v0, v1
    v_lshlrev_b32_sdwa v0, 2, v46 dst_sel:DWORD dst_unused:UNUSED_PAD src0_sel:DWORD src1_sel:BYTE_0
    ds_add_rtn_u32 v50, v0, v51 offset:0
    s_and_b64 exec, s[42:43], s[30:31]
    v_lshlrev_b32_sdwa v0, 2, v48 dst_sel:DWORD dst_unused:UNUSED_PAD src0_sel:DWORD src1_sel:BYTE_0
    ds_add_rtn_u32 v51, v0, v51 offset:0
    s_mov_b64 exec, -1
    s_waitcnt lgkmcnt(2)
    v_mfma_f32_16x16x32_bf16 v[56:59], v[38:41], v[30:33], v[56:59]
    v_mfma_f32_16x16x32_bf16 v[60:63], v[38:41], v[34:37], v[60:63]
    v_lshrrev_b32 v0, 7, v28
    v_and_or_b32 v0, v0, s18, v3
    v_cmpx_eq_u32_sdwa s[68:69], s16, v28 src0_sel:DWORD src1_sel:BYTE_0
    v_bfe_u32 v1, v28, 8, 4
    v_lshl_add_u32 v55, v1, 4, v4
    v_lshrrev_b32_sdwa v55, v3, v29 dst_sel:WORD_1 dst_unused:UNUSED_PRESERVE src0_sel:DWORD src1_sel:DWORD
    s_waitcnt vmcnt(4)
    v_mfma_f32_16x16x32_bf16 v[30:33], v[20:23], v[8:11], 0
    v_mfma_f32_16x16x32_bf16 v[34:37], v[20:23], v[12:15], 0
    buffer_load_dwordx4 v[20:23], v0, s[4:7], 0 offen
    s_mov_b64 exec, s[60:61]
    v_and_b32 v0, s22, v7
    ds_write_b16_d16_hi v0, v3 offset:65280
    s_mov_b64 exec, s[62:63]
    v_and_b32 v1, s22, v52
    ds_write_b16_d16_hi v1, v52 offset:65280
    s_mov_b64 exec, -1
    ds_read_b64 v[28:29], v2 offset:53120
    v_cvt_pk_bf16_f32 v38, v30, v31
    v_cvt_pk_bf16_f32 v39, v32, v33
    v_cvt_pk_bf16_f32 v40, v34, v35
    v_cvt_pk_bf16_f32 v41, v36, v37
    ds_read_b128 v[30:33], v5
    ds_read_b128 v[34:37], v5 offset:1024
    s_waitcnt lgkmcnt(5)
    s_and_b64 exec, s[40:41], s[30:31]
    v_lshlrev_b32_sdwa v0, 8, v46 dst_sel:DWORD dst_unused:UNUSED_PAD src0_sel:DWORD src1_sel:BYTE_0
    v_cmp_le_u32 vcc, s19, v50
    v_and_or_b32 v0, v50, s20, v0
    s_cbranch_vccnz B_sp62
B_spb62:
    v_mov_b32_sdwa v46, s21 dst_sel:BYTE_0 dst_unused:UNUSED_PRESERVE src0_sel:BYTE_0
    ds_write_b64 v0, v[46:47] offset:1664
    s_and_b64 exec, s[42:43], s[30:31]
    v_lshlrev_b32_sdwa v0, 8, v48 dst_sel:DWORD dst_unused:UNUSED_PAD src0_sel:DWORD src1_sel:BYTE_0
    v_cmp_le_u32 vcc, s19, v51
    v_and_or_b32 v0, v51, s20, v0
    s_cbranch_vccnz B_sp63
B_spb63:
    v_mov_b32_sdwa v48, s21 dst_sel:BYTE_0 dst_unused:UNUSED_PRESERVE src0_sel:BYTE_0
    ds_write_b64 v0, v[48:49] offset:1664
    s_mov_b64 exec, -1
    s_add_u32 s36, s25, 64
    s_cmp_ge_u32 s36, s49
    s_cbranch_scc1 B_far64
B_farb64:
    v_add_u32_sdwa v0, s36, v6 dst_sel:DWORD dst_unused:UNUSED_PAD src0_sel:DWORD src1_sel:WORD_0
    ds_read_b64 v[50:51], v0
    s_waitcnt lgkmcnt(3)
    v_mfma_f32_16x16x32_bf16 v[64:67], v[38:41], v[30:33], v[64:67]
    v_mfma_f32_16x16x32_bf16 v[68:71], v[38:41], v[34:37], v[68:71]
    v_lshrrev_b32 v0, 7, v28
    v_and_or_b32 v0, v0, s18, v3
    v_cmpx_eq_u32_sdwa s[60:61], s16, v28 src0_sel:DWORD src1_sel:BYTE_0
    v_bfe_u32 v1, v28, 8, 4
    v_lshl_add_u32 v7, v1, 4, v4
    v_lshrrev_b32_sdwa v7, v3, v29 dst_sel:WORD_1 dst_unused:UNUSED_PRESERVE src0_sel:DWORD src1_sel:DWORD
    s_waitcnt vmcnt(3)
    v_mfma_f32_16x16x32_bf16 v[30:33], v[24:27], v[8:11], 0
    v_mfma_f32_16x16x32_bf16 v[34:37], v[24:27], v[12:15], 0
    buffer_load_dwordx4 v[24:27], v0, s[4:7], 0 offen
    s_mov_b64 exec, s[62:63]
    v_and_b32 v0, s22, v52
    ds_write_b16_d16_hi v0, v3 offset:65280
    s_mov_b64 exec, s[64:65]
    v_and_b32 v1, s22, v53
    ds_write_b16_d16_hi v1, v53 offset:65280
    s_mov_b64 exec, -1
    ds_read_b64 v[28:29], v2 offset:53376
    v_cvt_pk_bf16_f32 v38, v30, v31
    v_cvt_pk_bf16_f32 v39, v32, v33
    v_cvt_pk_bf16_f32 v40, v34, v35
    v_cvt_pk_bf16_f32 v41, v36, v37
    ds_read_b128 v[30:33], v5
    ds_read_b128 v[34:37], v5 offset:1024
    s_waitcnt lgkmcnt(5)
    v_cmp_lt_u32_sdwa s[40:41], v6, v51 src0_sel:WORD_1 src1_sel:WORD_0
    v_mad_u32_u16 v0, v6, 6, v50 op_sel:[1,0,0,0]
    v_cmp_lt_u32_sdwa s[42:43], v6, v51 src0_sel:WORD_1 src1_sel:WORD_1
    s_mov_b64 exec, s[40:41]
    buffer_load_dwordx3 v[46:48], v0, s[8:11], 0 offen
    s_mov_b64 exec, -1
    s_waitcnt vmcnt(3)
    v_cvt_f32_bf16_sdwa v0, v43 dst_sel:DWORD dst_unused:UNUSED_PAD src0_sel:WORD_1
    v_pk_mul_f32 v[0:1], v[0:1], s[70:71] op_sel_hi:[0,1]
    v_cos_f32 v0, v0
    v_cos_f32 v1, v1
    v_mov_b32 v51, 65544
    v_cvt_pk_bf16_f32 v45, v0, v1
    v_cvt_f32_bf16_sdwa v0, v43 dst_sel:DWORD dst_unused:UNUSED_PAD src0_sel:WORD_0
    v_pk_mul_f32 v[0:1], v[0:1], s[70:71] op_sel_hi:[0,1]
    v_cos_f32 v0, v0
    v_cos_f32 v1, v1
    s_and_b64 exec, s[44:45], s[30:31]
    v_cvt_pk_bf16_f32 v43, v0, v1
    v_lshlrev_b32_sdwa v0, 2, v42 dst_sel:DWORD dst_unused:UNUSED_PAD src0_sel:DWORD src1_sel:BYTE_0
    ds_add_rtn_u32 v50, v0, v51 offset:0
    s_and_b64 exec, s[46:47], s[30:31]
    v_lshlrev_b32_sdwa v0, 2, v44 dst_sel:DWORD dst_unused:UNUSED_PAD src0_sel:DWORD src1_sel:BYTE_0
    ds_add_rtn_u32 v51, v0, v51 offset:0
    s_mov_b64 exec, -1
    s_waitcnt lgkmcnt(2)
    v_mfma_f32_16x16x32_bf16 v[72:75], v[38:41], v[30:33], v[72:75]
    v_mfma_f32_16x16x32_bf16 v[76:79], v[38:41], v[34:37], v[76:79]
    v_lshrrev_b32 v0, 7, v28
    v_and_or_b32 v0, v0, s18, v3
    v_cmpx_eq_u32_sdwa s[62:63], s16, v28 src0_sel:DWORD src1_sel:BYTE_0
    v_bfe_u32 v1, v28, 8, 4
    v_lshl_add_u32 v52, v1, 4, v4
    v_lshrrev_b32_sdwa v52, v3, v29 dst_sel:WORD_1 dst_unused:UNUSED_PRESERVE src0_sel:DWORD src1_sel:DWORD
    s_waitcnt vmcnt(4)
    v_mfma_f32_16x16x32_bf16 v[30:33], v[16:19], v[8:11], 0
    v_mfma_f32_16x16x32_bf16 v[34:37], v[16:19], v[12:15], 0
    buffer_load_dwordx4 v[16:19], v0, s[4:7], 0 offen
    s_mov_b64 exec, s[64:65]
    v_and_b32 v0, s22, v53
    ds_write_b16_d16_hi v0, v3 offset:65280
    s_mov_b64 exec, s[66:67]
    v_and_b32 v1, s22, v54
    ds_write_b16_d16_hi v1, v54 offset:65280
    s_mov_b64 exec, -1
    ds_read_b64 v[28:29], v2 offset:53632
    v_cvt_pk_bf16_f32 v38, v30, v31
    v_cvt_pk_bf16_f32 v39, v32, v33
    v_cvt_pk_bf16_f32 v40, v34, v35
    v_cvt_pk_bf16_f32 v41, v36, v37
    ds_read_b128 v[30:33], v5
    ds_read_b128 v[34:37], v5 offset:1024
    s_waitcnt lgkmcnt(5)
    s_and_b64 exec, s[44:45], s[30:31]
    v_lshlrev_b32_sdwa v0, 8, v42 dst_sel:DWORD dst_unused:UNUSED_PAD src0_sel:DWORD src1_sel:BYTE_0
    v_cmp_le_u32 vcc, s19, v50
    v_and_or_b32 v0, v50, s20, v0
    s_cbranch_vccnz B_sp65
B_spb65:
    v_mov_b32_sdwa v42, s21 dst_sel:BYTE_0 dst_unused:UNUSED_PRESERVE src0_sel:BYTE_0
    ds_write_b64 v0, v[42:43] offset:1664
    s_and_b64 exec, s[46:47], s[30:31]
    v_lshlrev_b32_sdwa v0, 8, v44 dst_sel:DWORD dst_unused:UNUSED_PAD src0_sel:DWORD src1_sel:BYTE_0
    v_cmp_le_u32 vcc, s19, v51
    v_and_or_b32 v0, v51, s20, v0
    s_cbranch_vccnz B_sp66
B_spb66:
    v_mov_b32_sdwa v44, s21 dst_sel:BYTE_0 dst_unused:UNUSED_PRESERVE src0_sel:BYTE_0
    ds_write_b64 v0, v[44:45] offset:1664
    s_mov_b64 exec, -1
    s_add_u32 s36, s25, 96
    s_cmp_ge_u32 s36, s49
    s_cbranch_scc1 B_far67
B_farb67:
    v_add_u32_sdwa v0, s36, v6 dst_sel:DWORD dst_unused:UNUSED_PAD src0_sel:DWORD src1_sel:WORD_0
    ds_read_b64 v[50:51], v0
    s_waitcnt lgkmcnt(3)
    v_mfma_f32_16x16x32_bf16 v[80:83], v[38:41], v[30:33], v[80:83]
    v_mfma_f32_16x16x32_bf16 v[84:87], v[38:41], v[34:37], v[84:87]
    v_lshrrev_b32 v0, 7, v28
    v_and_or_b32 v0, v0, s18, v3
    v_cmpx_eq_u32_sdwa s[64:65], s16, v28 src0_sel:DWORD src1_sel:BYTE_0
    v_bfe_u32 v1, v28, 8, 4
    v_lshl_add_u32 v53, v1, 4, v4
    v_lshrrev_b32_sdwa v53, v3, v29 dst_sel:WORD_1 dst_unused:UNUSED_PRESERVE src0_sel:DWORD src1_sel:DWORD
    s_waitcnt vmcnt(3)
    v_mfma_f32_16x16x32_bf16 v[30:33], v[20:23], v[8:11], 0
    v_mfma_f32_16x16x32_bf16 v[34:37], v[20:23], v[12:15], 0
    buffer_load_dwordx4 v[20:23], v0, s[4:7], 0 offen
    s_mov_b64 exec, s[66:67]
    v_and_b32 v0, s22, v54
    ds_write_b16_d16_hi v0, v3 offset:65280
    s_mov_b64 exec, s[68:69]
    v_and_b32 v1, s22, v55
    ds_write_b16_d16_hi v1, v55 offset:65280
    s_mov_b64 exec, -1
    ds_read_b64 v[28:29], v2 offset:53888
    v_cvt_pk_bf16_f32 v38, v30, v31
    v_cvt_pk_bf16_f32 v39, v32, v33
    v_cvt_pk_bf16_f32 v40, v34, v35
    v_cvt_pk_bf16_f32 v41, v36, v37
    ds_read_b128 v[30:33], v5
    ds_read_b128 v[34:37], v5 offset:1024
    s_waitcnt lgkmcnt(5)
    v_cmp_lt_u32_sdwa s[44:45], v6, v51 src0_sel:WORD_1 src1_sel:WORD_0
    v_mad_u32_u16 v0, v6, 6, v50 op_sel:[1,0,0,0]
    v_cmp_lt_u32_sdwa s[46:47], v6, v51 src0_sel:WORD_1 src1_sel:WORD_1
    s_mov_b64 exec, s[44:45]
    buffer_load_dwordx3 v[42:44], v0, s[8:11], 0 offen
    s_mov_b64 exec, -1
    s_waitcnt vmcnt(3)
    v_cvt_f32_bf16_sdwa v0, v47 dst_sel:DWORD dst_unused:UNUSED_PAD src0_sel:WORD_1
    v_pk_mul_f32 v[0:1], v[0:1], s[70:71] op_sel_hi:[0,1]
    v_cos_f32 v0, v0
    v_cos_f32 v1, v1
    v_mov_b32 v51, 65544
    v_cvt_pk_bf16_f32 v49, v0, v1
    v_cvt_f32_bf16_sdwa v0, v47 dst_sel:DWORD dst_unused:UNUSED_PAD src0_sel:WORD_0
    v_pk_mul_f32 v[0:1], v[0:1], s[70:71] op_sel_hi:[0,1]
    v_cos_f32 v0, v0
    v_cos_f32 v1, v1
    s_and_b64 exec, s[40:41], s[30:31]
    v_cvt_pk_bf16_f32 v47, v0, v1
    v_lshlrev_b32_sdwa v0, 2, v46 dst_sel:DWORD dst_unused:UNUSED_PAD src0_sel:DWORD src1_sel:BYTE_0
    ds_add_rtn_u32 v50, v0, v51 offset:0
    s_and_b64 exec, s[42:43], s[30:31]
    v_lshlrev_b32_sdwa v0, 2, v48 dst_sel:DWORD dst_unused:UNUSED_PAD src0_sel:DWORD src1_sel:BYTE_0
    ds_add_rtn_u32 v51, v0, v51 offset:0
    s_mov_b64 exec, -1
    s_waitcnt lgkmcnt(2)
    v_mfma_f32_16x16x32_bf16 v[88:91], v[38:41], v[30:33], v[88:91]
    v_mfma_f32_16x16x32_bf16 v[92:95], v[38:41], v[34:37], v[92:95]
    v_lshrrev_b32 v0, 7, v28
    v_and_or_b32 v0, v0, s18, v3
    v_cmpx_eq_u32_sdwa s[66:67], s16, v28 src0_sel:DWORD src1_sel:BYTE_0
    v_bfe_u32 v1, v28, 8, 4
    v_lshl_add_u32 v54, v1, 4, v4
    v_lshrrev_b32_sdwa v54, v3, v29 dst_sel:WORD_1 dst_unused:UNUSED_PRESERVE src0_sel:DWORD src1_sel:DWORD
    s_waitcnt vmcnt(4)
    v_mfma_f32_16x16x32_bf16 v[30:33], v[24:27], v[8:11], 0
    v_mfma_f32_16x16x32_bf16 v[34:37], v[24:27], v[12:15], 0
    buffer_load_dwordx4 v[24:27], v0, s[4:7], 0 offen
    s_mov_b64 exec, s[68:69]
    v_and_b32 v0, s22, v55
    ds_write_b16_d16_hi v0, v3 offset:65280
    s_mov_b64 exec, s[60:61]
    v_and_b32 v1, s22, v7
    ds_write_b16_d16_hi v1, v7 offset:65280
    s_mov_b64 exec, -1
    ds_read_b64 v[28:29], v2 offset:54144
    v_cvt_pk_bf16_f32 v38, v30, v31
    v_cvt_pk_bf16_f32 v39, v32, v33
    v_cvt_pk_bf16_f32 v40, v34, v35
    v_cvt_pk_bf16_f32 v41, v36, v37
    ds_read_b128 v[30:33], v5
    ds_read_b128 v[34:37], v5 offset:1024
    s_waitcnt lgkmcnt(5)
    s_and_b64 exec, s[40:41], s[30:31]
    v_lshlrev_b32_sdwa v0, 8, v46 dst_sel:DWORD dst_unused:UNUSED_PAD src0_sel:DWORD src1_sel:BYTE_0
    v_cmp_le_u32 vcc, s19, v50
    v_and_or_b32 v0, v50, s20, v0
    s_cbranch_vccnz B_sp68
B_spb68:
    v_mov_b32_sdwa v46, s21 dst_sel:BYTE_0 dst_unused:UNUSED_PRESERVE src0_sel:BYTE_0
    ds_write_b64 v0, v[46:47] offset:1664
    s_and_b64 exec, s[42:43], s[30:31]
    v_lshlrev_b32_sdwa v0, 8, v48 dst_sel:DWORD dst_unused:UNUSED_PAD src0_sel:DWORD src1_sel:BYTE_0
    v_cmp_le_u32 vcc, s19, v51
    v_and_or_b32 v0, v51, s20, v0
    s_cbranch_vccnz B_sp69
B_spb69:
    v_mov_b32_sdwa v48, s21 dst_sel:BYTE_0 dst_unused:UNUSED_PRESERVE src0_sel:BYTE_0
    ds_write_b64 v0, v[48:49] offset:1664
    s_mov_b64 exec, -1
    s_add_u32 s36, s25, 128
    s_cmp_ge_u32 s36, s49
    s_cbranch_scc1 B_far70
B_farb70:
    v_add_u32_sdwa v0, s36, v6 dst_sel:DWORD dst_unused:UNUSED_PAD src0_sel:DWORD src1_sel:WORD_0
    ds_read_b64 v[50:51], v0
    s_waitcnt lgkmcnt(3)
    v_mfma_f32_16x16x32_bf16 v[96:99], v[38:41], v[30:33], v[96:99]
    v_mfma_f32_16x16x32_bf16 v[100:103], v[38:41], v[34:37], v[100:103]
    v_lshrrev_b32 v0, 7, v28
    v_and_or_b32 v0, v0, s18, v3
    v_cmpx_eq_u32_sdwa s[68:69], s16, v28 src0_sel:DWORD src1_sel:BYTE_0
    v_bfe_u32 v1, v28, 8, 4
    v_lshl_add_u32 v55, v1, 4, v4
    v_lshrrev_b32_sdwa v55, v3, v29 dst_sel:WORD_1 dst_unused:UNUSED_PRESERVE src0_sel:DWORD src1_sel:DWORD
    s_waitcnt vmcnt(3)
    v_mfma_f32_16x16x32_bf16 v[30:33], v[16:19], v[8:11], 0
    v_mfma_f32_16x16x32_bf16 v[34:37], v[16:19], v[12:15], 0
    buffer_load_dwordx4 v[16:19], v0, s[4:7], 0 offen
    s_mov_b64 exec, s[60:61]
    v_and_b32 v0, s22, v7
    ds_write_b16_d16_hi v0, v3 offset:65280
    s_mov_b64 exec, s[62:63]
    v_and_b32 v1, s22, v52
    ds_write_b16_d16_hi v1, v52 offset:65280
    s_mov_b64 exec, -1
    ds_read_b64 v[28:29], v2 offset:54400
    v_cvt_pk_bf16_f32 v38, v30, v31
    v_cvt_pk_bf16_f32 v39, v32, v33
    v_cvt_pk_bf16_f32 v40, v34, v35
    v_cvt_pk_bf16_f32 v41, v36, v37
    ds_read_b128 v[30:33], v5
    ds_read_b128 v[34:37], v5 offset:1024
    s_waitcnt lgkmcnt(5)
    v_cmp_lt_u32_sdwa s[40:41], v6, v51 src0_sel:WORD_1 src1_sel:WORD_0
    v_mad_u32_u16 v0, v6, 6, v50 op_sel:[1,0,0,0]
    v_cmp_lt_u32_sdwa s[42:43], v6, v51 src0_sel:WORD_1 src1_sel:WORD_1
    s_mov_b64 exec, s[40:41]
    buffer_load_dwordx3 v[46:48], v0, s[8:11], 0 offen
    s_mov_b64 exec, -1
    s_waitcnt vmcnt(3)
    v_cvt_f32_bf16_sdwa v0, v43 dst_sel:DWORD dst_unused:UNUSED_PAD src0_sel:WORD_1
    v_pk_mul_f32 v[0:1], v[0:1], s[70:71] op_sel_hi:[0,1]
    v_cos_f32 v0, v0
    v_cos_f32 v1, v1
    v_mov_b32 v51, 65544
    v_cvt_pk_bf16_f32 v45, v0, v1
    v_cvt_f32_bf16_sdwa v0, v43 dst_sel:DWORD dst_unused:UNUSED_PAD src0_sel:WORD_0
    v_pk_mul_f32 v[0:1], v[0:1], s[70:71] op_sel_hi:[0,1]
    v_cos_f32 v0, v0
    v_cos_f32 v1, v1
    s_and_b64 exec, s[44:45], s[30:31]
    v_cvt_pk_bf16_f32 v43, v0, v1
    v_lshlrev_b32_sdwa v0, 2, v42 dst_sel:DWORD dst_unused:UNUSED_PAD src0_sel:DWORD src1_sel:BYTE_0
    ds_add_rtn_u32 v50, v0, v51 offset:0
    s_and_b64 exec, s[46:47], s[30:31]
    v_lshlrev_b32_sdwa v0, 2, v44 dst_sel:DWORD dst_unused:UNUSED_PAD src0_sel:DWORD src1_sel:BYTE_0
    ds_add_rtn_u32 v51, v0, v51 offset:0
    s_mov_b64 exec, -1
    s_waitcnt lgkmcnt(2)
    v_mfma_f32_16x16x32_bf16 v[104:107], v[38:41], v[30:33], v[104:107]
    v_mfma_f32_16x16x32_bf16 v[108:111], v[38:41], v[34:37], v[108:111]
    v_lshrrev_b32 v0, 7, v28
    v_and_or_b32 v0, v0, s18, v3
    v_cmpx_eq_u32_sdwa s[60:61], s16, v28 src0_sel:DWORD src1_sel:BYTE_0
    v_bfe_u32 v1, v28, 8, 4
    v_lshl_add_u32 v7, v1, 4, v4
    v_lshrrev_b32_sdwa v7, v3, v29 dst_sel:WORD_1 dst_unused:UNUSED_PRESERVE src0_sel:DWORD src1_sel:DWORD
    s_waitcnt vmcnt(4)
    v_mfma_f32_16x16x32_bf16 v[30:33], v[20:23], v[8:11], 0
    v_mfma_f32_16x16x32_bf16 v[34:37], v[20:23], v[12:15], 0
    buffer_load_dwordx4 v[20:23], v0, s[4:7], 0 offen
    s_mov_b64 exec, s[62:63]
    v_and_b32 v0, s22, v52
    ds_write_b16_d16_hi v0, v3 offset:65280
    s_mov_b64 exec, s[64:65]
    v_and_b32 v1, s22, v53
    ds_write_b16_d16_hi v1, v53 offset:65280
    s_mov_b64 exec, -1
    ds_read_b64 v[28:29], v2 offset:54656
    v_cvt_pk_bf16_f32 v38, v30, v31
    v_cvt_pk_bf16_f32 v39, v32, v33
    v_cvt_pk_bf16_f32 v40, v34, v35
    v_cvt_pk_bf16_f32 v41, v36, v37
    ds_read_b128 v[30:33], v5
    ds_read_b128 v[34:37], v5 offset:1024
    s_waitcnt lgkmcnt(5)
    s_and_b64 exec, s[44:45], s[30:31]
    v_lshlrev_b32_sdwa v0, 8, v42 dst_sel:DWORD dst_unused:UNUSED_PAD src0_sel:DWORD src1_sel:BYTE_0
    v_cmp_le_u32 vcc, s19, v50
    v_and_or_b32 v0, v50, s20, v0
    s_cbranch_vccnz B_sp71
B_spb71:
    v_mov_b32_sdwa v42, s21 dst_sel:BYTE_0 dst_unused:UNUSED_PRESERVE src0_sel:BYTE_0
    ds_write_b64 v0, v[42:43] offset:1664
    s_and_b64 exec, s[46:47], s[30:31]
    v_lshlrev_b32_sdwa v0, 8, v44 dst_sel:DWORD dst_unused:UNUSED_PAD src0_sel:DWORD src1_sel:BYTE_0
    v_cmp_le_u32 vcc, s19, v51
    v_and_or_b32 v0, v51, s20, v0
    s_cbranch_vccnz B_sp72
B_spb72:
    v_mov_b32_sdwa v44, s21 dst_sel:BYTE_0 dst_unused:UNUSED_PRESERVE src0_sel:BYTE_0
    ds_write_b64 v0, v[44:45] offset:1664
    s_mov_b64 exec, -1
    s_add_u32 s36, s25, 160
    s_cmp_ge_u32 s36, s49
    s_cbranch_scc1 B_far73
B_farb73:
    v_add_u32_sdwa v0, s36, v6 dst_sel:DWORD dst_unused:UNUSED_PAD src0_sel:DWORD src1_sel:WORD_0
    ds_read_b64 v[50:51], v0
    s_waitcnt lgkmcnt(3)
    v_mfma_f32_16x16x32_bf16 v[112:115], v[38:41], v[30:33], v[112:115]
    v_mfma_f32_16x16x32_bf16 v[116:119], v[38:41], v[34:37], v[116:119]
    v_lshrrev_b32 v0, 7, v28
    v_and_or_b32 v0, v0, s18, v3
    v_cmpx_eq_u32_sdwa s[62:63], s16, v28 src0_sel:DWORD src1_sel:BYTE_0
    v_bfe_u32 v1, v28, 8, 4
    v_lshl_add_u32 v52, v1, 4, v4
    v_lshrrev_b32_sdwa v52, v3, v29 dst_sel:WORD_1 dst_unused:UNUSED_PRESERVE src0_sel:DWORD src1_sel:DWORD
    s_waitcnt vmcnt(3)
    v_mfma_f32_16x16x32_bf16 v[30:33], v[24:27], v[8:11], 0
    v_mfma_f32_16x16x32_bf16 v[34:37], v[24:27], v[12:15], 0
    buffer_load_dwordx4 v[24:27], v0, s[4:7], 0 offen
    s_mov_b64 exec, s[64:65]
    v_and_b32 v0, s22, v53
    ds_write_b16_d16_hi v0, v3 offset:65280
    s_mov_b64 exec, s[66:67]
    v_and_b32 v1, s22, v54
    ds_write_b16_d16_hi v1, v54 offset:65280
    s_mov_b64 exec, -1
    ds_read_b64 v[28:29], v2 offset:54912
    v_cvt_pk_bf16_f32 v38, v30, v31
    v_cvt_pk_bf16_f32 v39, v32, v33
    v_cvt_pk_bf16_f32 v40, v34, v35
    v_cvt_pk_bf16_f32 v41, v36, v37
    ds_read_b128 v[30:33], v5
    ds_read_b128 v[34:37], v5 offset:1024
    s_waitcnt lgkmcnt(5)
    v_cmp_lt_u32_sdwa s[44:45], v6, v51 src0_sel:WORD_1 src1_sel:WORD_0
    v_mad_u32_u16 v0, v6, 6, v50 op_sel:[1,0,0,0]
    v_cmp_lt_u32_sdwa s[46:47], v6, v51 src0_sel:WORD_1 src1_sel:WORD_1
    s_mov_b64 exec, s[44:45]
    buffer_load_dwordx3 v[42:44], v0, s[8:11], 0 offen
    s_mov_b64 exec, -1
    s_waitcnt vmcnt(3)
    v_cvt_f32_bf16_sdwa v0, v47 dst_sel:DWORD dst_unused:UNUSED_PAD src0_sel:WORD_1
    v_pk_mul_f32 v[0:1], v[0:1], s[70:71] op_sel_hi:[0,1]
    v_cos_f32 v0, v0
    v_cos_f32 v1, v1
    v_mov_b32 v51, 65544
    v_cvt_pk_bf16_f32 v49, v0, v1
    v_cvt_f32_bf16_sdwa v0, v47 dst_sel:DWORD dst_unused:UNUSED_PAD src0_sel:WORD_0
    v_pk_mul_f32 v[0:1], v[0:1], s[70:71] op_sel_hi:[0,1]
    v_cos_f32 v0, v0
    v_cos_f32 v1, v1
    s_and_b64 exec, s[40:41], s[30:31]
    v_cvt_pk_bf16_f32 v47, v0, v1
    v_lshlrev_b32_sdwa v0, 2, v46 dst_sel:DWORD dst_unused:UNUSED_PAD src0_sel:DWORD src1_sel:BYTE_0
    ds_add_rtn_u32 v50, v0, v51 offset:0
    s_and_b64 exec, s[42:43], s[30:31]
    v_lshlrev_b32_sdwa v0, 2, v48 dst_sel:DWORD dst_unused:UNUSED_PAD src0_sel:DWORD src1_sel:BYTE_0
    ds_add_rtn_u32 v51, v0, v51 offset:0
    s_mov_b64 exec, -1
    s_setprio 0
    s_waitcnt lgkmcnt(2)
    v_mfma_f32_16x16x32_bf16 v[120:123], v[38:41], v[30:33], v[120:123]
    v_mfma_f32_16x16x32_bf16 v[124:127], v[38:41], v[34:37], v[124:127]
    v_lshrrev_b32 v0, 7, v28
    v_and_or_b32 v0, v0, s18, v3
    v_cmpx_eq_u32_sdwa s[64:65], s16, v28 src0_sel:DWORD src1_sel:BYTE_0
    v_bfe_u32 v1, v28, 8, 4
    v_lshl_add_u32 v53, v1, 4, v4
    v_lshrrev_b32_sdwa v53, v3, v29 dst_sel:WORD_1 dst_unused:UNUSED_PRESERVE src0_sel:DWORD src1_sel:DWORD
    s_waitcnt vmcnt(4)
    v_mfma_f32_16x16x32_bf16 v[30:33], v[16:19], v[8:11], 0
    v_mfma_f32_16x16x32_bf16 v[34:37], v[16:19], v[12:15], 0
    buffer_load_dwordx4 v[16:19], v0, s[4:7], 0 offen
    s_mov_b64 exec, s[66:67]
    v_and_b32 v0, s22, v54
    ds_write_b16_d16_hi v0, v3 offset:65280
    s_mov_b64 exec, s[68:69]
    v_and_b32 v1, s22, v55
    ds_write_b16_d16_hi v1, v55 offset:65280
    s_mov_b64 exec, -1
    ds_read_b64 v[28:29], v2 offset:55168
    v_cvt_pk_bf16_f32 v38, v30, v31
    v_cvt_pk_bf16_f32 v39, v32, v33
    v_cvt_pk_bf16_f32 v40, v34, v35
    v_cvt_pk_bf16_f32 v41, v36, v37
    ds_read_b128 v[30:33], v5
    ds_read_b128 v[34:37], v5 offset:1024
    s_waitcnt lgkmcnt(5)
    s_and_b64 exec, s[40:41], s[30:31]
    v_lshlrev_b32_sdwa v0, 8, v46 dst_sel:DWORD dst_unused:UNUSED_PAD src0_sel:DWORD src1_sel:BYTE_0
    v_cmp_le_u32 vcc, s19, v50
    v_and_or_b32 v0, v50, s20, v0
    s_cbranch_vccnz B_sp74
B_spb74:
    v_mov_b32_sdwa v46, s21 dst_sel:BYTE_0 dst_unused:UNUSED_PRESERVE src0_sel:BYTE_0
    ds_write_b64 v0, v[46:47] offset:1664
    s_and_b64 exec, s[42:43], s[30:31]
    v_lshlrev_b32_sdwa v0, 8, v48 dst_sel:DWORD dst_unused:UNUSED_PAD src0_sel:DWORD src1_sel:BYTE_0
    v_cmp_le_u32 vcc, s19, v51
    v_and_or_b32 v0, v51, s20, v0
    s_cbranch_vccnz B_sp75
B_spb75:
    v_mov_b32_sdwa v48, s21 dst_sel:BYTE_0 dst_unused:UNUSED_PRESERVE src0_sel:BYTE_0
    ds_write_b64 v0, v[48:49] offset:1664
    s_mov_b64 exec, -1
    s_add_u32 s36, s25, 192
    s_cmp_ge_u32 s36, s49
    s_cbranch_scc1 B_far76
B_farb76:
    v_add_u32_sdwa v0, s36, v6 dst_sel:DWORD dst_unused:UNUSED_PAD src0_sel:DWORD src1_sel:WORD_0
    ds_read_b64 v[50:51], v0
    s_waitcnt lgkmcnt(3)
    v_mfma_f32_16x16x32_bf16 v[128:131], v[38:41], v[30:33], v[128:131]
    v_mfma_f32_16x16x32_bf16 v[132:135], v[38:41], v[34:37], v[132:135]
    v_lshrrev_b32 v0, 7, v28
    v_and_or_b32 v0, v0, s18, v3
    v_cmpx_eq_u32_sdwa s[66:67], s16, v28 src0_sel:DWORD src1_sel:BYTE_0
    v_bfe_u32 v1, v28, 8, 4
    v_lshl_add_u32 v54, v1, 4, v4
    v_lshrrev_b32_sdwa v54, v3, v29 dst_sel:WORD_1 dst_unused:UNUSED_PRESERVE src0_sel:DWORD src1_sel:DWORD
    s_waitcnt vmcnt(3)
    v_mfma_f32_16x16x32_bf16 v[30:33], v[20:23], v[8:11], 0
    v_mfma_f32_16x16x32_bf16 v[34:37], v[20:23], v[12:15], 0
    buffer_load_dwordx4 v[20:23], v0, s[4:7], 0 offen
    s_mov_b64 exec, s[68:69]
    v_and_b32 v0, s22, v55
    ds_write_b16_d16_hi v0, v3 offset:65280
    s_mov_b64 exec, s[60:61]
    v_and_b32 v1, s22, v7
    ds_write_b16_d16_hi v1, v7 offset:65280
    s_mov_b64 exec, -1
    ds_read_b64 v[28:29], v2 offset:55424
    v_cvt_pk_bf16_f32 v38, v30, v31
    v_cvt_pk_bf16_f32 v39, v32, v33
    v_cvt_pk_bf16_f32 v40, v34, v35
    v_cvt_pk_bf16_f32 v41, v36, v37
    ds_read_b128 v[30:33], v5
    ds_read_b128 v[34:37], v5 offset:1024
    s_waitcnt lgkmcnt(5)
    v_cmp_lt_u32_sdwa s[40:41], v6, v51 src0_sel:WORD_1 src1_sel:WORD_0
    v_mad_u32_u16 v0, v6, 6, v50 op_sel:[1,0,0,0]
    v_cmp_lt_u32_sdwa s[42:43], v6, v51 src0_sel:WORD_1 src1_sel:WORD_1
    s_mov_b64 exec, s[40:41]
    buffer_load_dwordx3 v[46:48], v0, s[8:11], 0 offen
    s_mov_b64 exec, -1
    s_waitcnt vmcnt(3)
    v_cvt_f32_bf16_sdwa v0, v43 dst_sel:DWORD dst_unused:UNUSED_PAD src0_sel:WORD_1
    v_pk_mul_f32 v[0:1], v[0:1], s[70:71] op_sel_hi:[0,1]
    v_cos_f32 v0, v0
    v_cos_f32 v1, v1
    v_mov_b32 v51, 65544
    v_cvt_pk_bf16_f32 v45, v0, v1
    v_cvt_f32_bf16_sdwa v0, v43 dst_sel:DWORD dst_unused:UNUSED_PAD src0_sel:WORD_0
    v_pk_mul_f32 v[0:1], v[0:1], s[70:71] op_sel_hi:[0,1]
    v_cos_f32 v0, v0
    v_cos_f32 v1, v1
    s_and_b64 exec, s[44:45], s[30:31]
    v_cvt_pk_bf16_f32 v43, v0, v1
    v_lshlrev_b32_sdwa v0, 2, v42 dst_sel:DWORD dst_unused:UNUSED_PAD src0_sel:DWORD src1_sel:BYTE_0
    ds_add_rtn_u32 v50, v0, v51 offset:0
    s_and_b64 exec, s[46:47], s[30:31]
    v_lshlrev_b32_sdwa v0, 2, v44 dst_sel:DWORD dst_unused:UNUSED_PAD src0_sel:DWORD src1_sel:BYTE_0
    ds_add_rtn_u32 v51, v0, v51 offset:0
    s_mov_b64 exec, -1
    s_waitcnt lgkmcnt(2)
    v_mfma_f32_16x16x32_bf16 v[136:139], v[38:41], v[30:33], v[136:139]
    v_mfma_f32_16x16x32_bf16 v[140:143], v[38:41], v[34:37], v[140:143]
    v_lshrrev_b32 v0, 7, v28
    v_and_or_b32 v0, v0, s18, v3
    v_cmpx_eq_u32_sdwa s[68:69], s16, v28 src0_sel:DWORD src1_sel:BYTE_0
    v_bfe_u32 v1, v28, 8, 4
    v_lshl_add_u32 v55, v1, 4, v4
    v_lshrrev_b32_sdwa v55, v3, v29 dst_sel:WORD_1 dst_unused:UNUSED_PRESERVE src0_sel:DWORD src1_sel:DWORD
    s_waitcnt vmcnt(4)
    v_mfma_f32_16x16x32_bf16 v[30:33], v[24:27], v[8:11], 0
    v_mfma_f32_16x16x32_bf16 v[34:37], v[24:27], v[12:15], 0
    buffer_load_dwordx4 v[24:27], v0, s[4:7], 0 offen
    s_mov_b64 exec, s[60:61]
    v_and_b32 v0, s22, v7
    ds_write_b16_d16_hi v0, v3 offset:65280
    s_mov_b64 exec, s[62:63]
    v_and_b32 v1, s22, v52
    ds_write_b16_d16_hi v1, v52 offset:65280
    s_mov_b64 exec, -1
    ds_read_b64 v[28:29], v2 offset:55680
    v_cvt_pk_bf16_f32 v38, v30, v31
    v_cvt_pk_bf16_f32 v39, v32, v33
    v_cvt_pk_bf16_f32 v40, v34, v35
    v_cvt_pk_bf16_f32 v41, v36, v37
    ds_read_b128 v[30:33], v5
    ds_read_b128 v[34:37], v5 offset:1024
    s_waitcnt lgkmcnt(5)
    s_and_b64 exec, s[44:45], s[30:31]
    v_lshlrev_b32_sdwa v0, 8, v42 dst_sel:DWORD dst_unused:UNUSED_PAD src0_sel:DWORD src1_sel:BYTE_0
    v_cmp_le_u32 vcc, s19, v50
    v_and_or_b32 v0, v50, s20, v0
    s_cbranch_vccnz B_sp77
B_spb77:
    v_mov_b32_sdwa v42, s21 dst_sel:BYTE_0 dst_unused:UNUSED_PRESERVE src0_sel:BYTE_0
    ds_write_b64 v0, v[42:43] offset:1664
    s_and_b64 exec, s[46:47], s[30:31]
    v_lshlrev_b32_sdwa v0, 8, v44 dst_sel:DWORD dst_unused:UNUSED_PAD src0_sel:DWORD src1_sel:BYTE_0
    v_cmp_le_u32 vcc, s19, v51
    v_and_or_b32 v0, v51, s20, v0
    s_cbranch_vccnz B_sp78
B_spb78:
    v_mov_b32_sdwa v44, s21 dst_sel:BYTE_0 dst_unused:UNUSED_PRESERVE src0_sel:BYTE_0
    ds_write_b64 v0, v[44:45] offset:1664
    s_mov_b64 exec, -1
    s_add_u32 s36, s25, 224
    s_cmp_ge_u32 s36, s49
    s_cbranch_scc1 B_far79
B_farb79:
    v_add_u32_sdwa v0, s36, v6 dst_sel:DWORD dst_unused:UNUSED_PAD src0_sel:DWORD src1_sel:WORD_0
    ds_read_b64 v[50:51], v0
    s_waitcnt lgkmcnt(3)
    v_mfma_f32_16x16x32_bf16 v[144:147], v[38:41], v[30:33], v[144:147]
    v_mfma_f32_16x16x32_bf16 v[148:151], v[38:41], v[34:37], v[148:151]
    v_lshrrev_b32 v0, 7, v28
    v_and_or_b32 v0, v0, s18, v3
    v_cmpx_eq_u32_sdwa s[60:61], s16, v28 src0_sel:DWORD src1_sel:BYTE_0
    v_bfe_u32 v1, v28, 8, 4
    v_lshl_add_u32 v7, v1, 4, v4
    v_lshrrev_b32_sdwa v7, v3, v29 dst_sel:WORD_1 dst_unused:UNUSED_PRESERVE src0_sel:DWORD src1_sel:DWORD
    s_waitcnt vmcnt(3)
    v_mfma_f32_16x16x32_bf16 v[30:33], v[16:19], v[8:11], 0
    v_mfma_f32_16x16x32_bf16 v[34:37], v[16:19], v[12:15], 0
    buffer_load_dwordx4 v[16:19], v0, s[4:7], 0 offen
    s_mov_b64 exec, s[62:63]
    v_and_b32 v0, s22, v52
    ds_write_b16_d16_hi v0, v3 offset:65280
    s_mov_b64 exec, s[64:65]
    v_and_b32 v1, s22, v53
    ds_write_b16_d16_hi v1, v53 offset:65280
    s_mov_b64 exec, -1
    ds_read_b64 v[28:29], v2 offset:55936
    v_cvt_pk_bf16_f32 v38, v30, v31
    v_cvt_pk_bf16_f32 v39, v32, v33
    v_cvt_pk_bf16_f32 v40, v34, v35
    v_cvt_pk_bf16_f32 v41, v36, v37
    ds_read_b128 v[30:33], v5
    ds_read_b128 v[34:37], v5 offset:1024
    s_waitcnt lgkmcnt(5)
    v_cmp_lt_u32_sdwa s[44:45], v6, v51 src0_sel:WORD_1 src1_sel:WORD_0
    v_mad_u32_u16 v0, v6, 6, v50 op_sel:[1,0,0,0]
    v_cmp_lt_u32_sdwa s[46:47], v6, v51 src0_sel:WORD_1 src1_sel:WORD_1
    s_mov_b64 exec, s[44:45]
    buffer_load_dwordx3 v[42:44], v0, s[8:11], 0 offen
    s_mov_b64 exec, -1
    s_waitcnt vmcnt(3)
    v_cvt_f32_bf16_sdwa v0, v47 dst_sel:DWORD dst_unused:UNUSED_PAD src0_sel:WORD_1
    v_pk_mul_f32 v[0:1], v[0:1], s[70:71] op_sel_hi:[0,1]
    v_cos_f32 v0, v0
    v_cos_f32 v1, v1
    v_mov_b32 v51, 65544
    v_cvt_pk_bf16_f32 v49, v0, v1
    v_cvt_f32_bf16_sdwa v0, v47 dst_sel:DWORD dst_unused:UNUSED_PAD src0_sel:WORD_0
    v_pk_mul_f32 v[0:1], v[0:1], s[70:71] op_sel_hi:[0,1]
    v_cos_f32 v0, v0
    v_cos_f32 v1, v1
    s_and_b64 exec, s[40:41], s[30:31]
    v_cvt_pk_bf16_f32 v47, v0, v1
    v_lshlrev_b32_sdwa v0, 2, v46 dst_sel:DWORD dst_unused:UNUSED_PAD src0_sel:DWORD src1_sel:BYTE_0
    ds_add_rtn_u32 v50, v0, v51 offset:0
    s_and_b64 exec, s[42:43], s[30:31]
    v_lshlrev_b32_sdwa v0, 2, v48 dst_sel:DWORD dst_unused:UNUSED_PAD src0_sel:DWORD src1_sel:BYTE_0
    ds_add_rtn_u32 v51, v0, v51 offset:0
    s_mov_b64 exec, -1
    s_waitcnt lgkmcnt(2)
    v_mfma_f32_16x16x32_bf16 v[152:155], v[38:41], v[30:33], v[152:155]
    v_mfma_f32_16x16x32_bf16 v[156:159], v[38:41], v[34:37], v[156:159]
    v_lshrrev_b32 v0, 7, v28
    v_and_or_b32 v0, v0, s18, v3
    v_cmpx_eq_u32_sdwa s[62:63], s16, v28 src0_sel:DWORD src1_sel:BYTE_0
    v_bfe_u32 v1, v28, 8, 4
    v_lshl_add_u32 v52, v1, 4, v4
    v_lshrrev_b32_sdwa v52, v3, v29 dst_sel:WORD_1 dst_unused:UNUSED_PRESERVE src0_sel:DWORD src1_sel:DWORD
    s_waitcnt vmcnt(4)
    v_mfma_f32_16x16x32_bf16 v[30:33], v[20:23], v[8:11], 0
    v_mfma_f32_16x16x32_bf16 v[34:37], v[20:23], v[12:15], 0
    buffer_load_dwordx4 v[20:23], v0, s[4:7], 0 offen
    s_mov_b64 exec, s[64:65]
    v_and_b32 v0, s22, v53
    ds_write_b16_d16_hi v0, v3 offset:65280
    s_mov_b64 exec, s[66:67]
    v_and_b32 v1, s22, v54
    ds_write_b16_d16_hi v1, v54 offset:65280
    s_mov_b64 exec, -1
    ds_read_b64 v[28:29], v2 offset:56192
    v_cvt_pk_bf16_f32 v38, v30, v31
    v_cvt_pk_bf16_f32 v39, v32, v33
    v_cvt_pk_bf16_f32 v40, v34, v35
    v_cvt_pk_bf16_f32 v41, v36, v37
    ds_read_b128 v[30:33], v5
    ds_read_b128 v[34:37], v5 offset:1024
    s_waitcnt lgkmcnt(5)
    s_and_b64 exec, s[40:41], s[30:31]
    v_lshlrev_b32_sdwa v0, 8, v46 dst_sel:DWORD dst_unused:UNUSED_PAD src0_sel:DWORD src1_sel:BYTE_0
    v_cmp_le_u32 vcc, s19, v50
    v_and_or_b32 v0, v50, s20, v0
    s_cbranch_vccnz B_sp80
B_spb80:
    v_mov_b32_sdwa v46, s21 dst_sel:BYTE_0 dst_unused:UNUSED_PRESERVE src0_sel:BYTE_0
    ds_write_b64 v0, v[46:47] offset:1664
    s_and_b64 exec, s[42:43], s[30:31]
    v_lshlrev_b32_sdwa v0, 8, v48 dst_sel:DWORD dst_unused:UNUSED_PAD src0_sel:DWORD src1_sel:BYTE_0
    v_cmp_le_u32 vcc, s19, v51
    v_and_or_b32 v0, v51, s20, v0
    s_cbranch_vccnz B_sp81
B_spb81:
    v_mov_b32_sdwa v48, s21 dst_sel:BYTE_0 dst_unused:UNUSED_PRESERVE src0_sel:BYTE_0
    ds_write_b64 v0, v[48:49] offset:1664
    s_mov_b64 exec, -1
    s_waitcnt lgkmcnt(2)
    v_mfma_f32_16x16x32_bf16 v[160:163], v[38:41], v[30:33], v[160:163]
    v_mfma_f32_16x16x32_bf16 v[164:167], v[38:41], v[34:37], v[164:167]
    v_lshrrev_b32 v0, 7, v28
    v_and_or_b32 v0, v0, s18, v3
    v_cmpx_eq_u32_sdwa s[64:65], s16, v28 src0_sel:DWORD src1_sel:BYTE_0
    v_bfe_u32 v1, v28, 8, 4
    v_lshl_add_u32 v53, v1, 4, v4
    v_lshrrev_b32_sdwa v53, v3, v29 dst_sel:WORD_1 dst_unused:UNUSED_PRESERVE src0_sel:DWORD src1_sel:DWORD
    s_waitcnt vmcnt(3)
    v_mfma_f32_16x16x32_bf16 v[30:33], v[24:27], v[8:11], 0
    v_mfma_f32_16x16x32_bf16 v[34:37], v[24:27], v[12:15], 0
    buffer_load_dwordx4 v[24:27], v0, s[4:7], 0 offen
    s_mov_b64 exec, s[66:67]
    v_and_b32 v0, s22, v54
    ds_write_b16_d16_hi v0, v3 offset:65280
    s_mov_b64 exec, s[68:69]
    v_and_b32 v1, s22, v55
    ds_write_b16_d16_hi v1, v55 offset:65280
    s_mov_b64 exec, -1
    ds_read_b64 v[28:29], v2 offset:56448
    v_cvt_pk_bf16_f32 v38, v30, v31
    v_cvt_pk_bf16_f32 v39, v32, v33
    v_cvt_pk_bf16_f32 v40, v34, v35
    v_cvt_pk_bf16_f32 v41, v36, v37
    ds_read_b128 v[30:33], v5
    ds_read_b128 v[34:37], v5 offset:1024
    s_waitcnt vmcnt(2)
    v_cvt_f32_bf16_sdwa v0, v43 dst_sel:DWORD dst_unused:UNUSED_PAD src0_sel:WORD_1
    v_pk_mul_f32 v[0:1], v[0:1], s[70:71] op_sel_hi:[0,1]
    v_cos_f32 v0, v0
    v_cos_f32 v1, v1
    v_mov_b32 v51, 65544
    v_cvt_pk_bf16_f32 v45, v0, v1
    v_cvt_f32_bf16_sdwa v0, v43 dst_sel:DWORD dst_unused:UNUSED_PAD src0_sel:WORD_0
    v_pk_mul_f32 v[0:1], v[0:1], s[70:71] op_sel_hi:[0,1]
    v_cos_f32 v0, v0
    v_cos_f32 v1, v1
    s_and_b64 exec, s[44:45], s[30:31]
    v_cvt_pk_bf16_f32 v43, v0, v1
    v_lshlrev_b32_sdwa v0, 2, v42 dst_sel:DWORD dst_unused:UNUSED_PAD src0_sel:DWORD src1_sel:BYTE_0
    ds_add_rtn_u32 v50, v0, v51 offset:0
    s_and_b64 exec, s[46:47], s[30:31]
    v_lshlrev_b32_sdwa v0, 2, v44 dst_sel:DWORD dst_unused:UNUSED_PAD src0_sel:DWORD src1_sel:BYTE_0
    ds_add_rtn_u32 v51, v0, v51 offset:0
    s_mov_b64 exec, -1
    s_waitcnt lgkmcnt(2)
    v_mfma_f32_16x16x32_bf16 v[168:171], v[38:41], v[30:33], v[168:171]
    v_mfma_f32_16x16x32_bf16 v[172:175], v[38:41], v[34:37], v[172:175]
    v_lshrrev_b32 v0, 7, v28
    v_and_or_b32 v0, v0, s18, v3
    v_cmpx_eq_u32_sdwa s[66:67], s16, v28 src0_sel:DWORD src1_sel:BYTE_0
    v_bfe_u32 v1, v28, 8, 4
    v_lshl_add_u32 v54, v1, 4, v4
    v_lshrrev_b32_sdwa v54, v3, v29 dst_sel:WORD_1 dst_unused:UNUSED_PRESERVE src0_sel:DWORD src1_sel:DWORD
    s_waitcnt vmcnt(3)
    v_mfma_f32_16x16x32_bf16 v[30:33], v[16:19], v[8:11], 0
    v_mfma_f32_16x16x32_bf16 v[34:37], v[16:19], v[12:15], 0
    buffer_load_dwordx4 v[16:19], v0, s[4:7], 0 offen
    s_mov_b64 exec, s[68:69]
    v_and_b32 v0, s22, v55
    ds_write_b16_d16_hi v0, v3 offset:65280
    s_mov_b64 exec, s[60:61]
    v_and_b32 v1, s22, v7
    ds_write_b16_d16_hi v1, v7 offset:65280
    s_mov_b64 exec, -1
    ds_read_b64 v[28:29], v2 offset:56704
    v_cvt_pk_bf16_f32 v38, v30, v31
    v_cvt_pk_bf16_f32 v39, v32, v33
    v_cvt_pk_bf16_f32 v40, v34, v35
    v_cvt_pk_bf16_f32 v41, v36, v37
    ds_read_b128 v[30:33], v5
    ds_read_b128 v[34:37], v5 offset:1024
    s_waitcnt lgkmcnt(5)
    s_and_b64 exec, s[44:45], s[30:31]
    v_lshlrev_b32_sdwa v0, 8, v42 dst_sel:DWORD dst_unused:UNUSED_PAD src0_sel:DWORD src1_sel:BYTE_0
    v_cmp_le_u32 vcc, s19, v50
    v_and_or_b32 v0, v50, s20, v0
    s_cbranch_vccnz B_sp82
B_spb82:
    v_mov_b32_sdwa v42, s21 dst_sel:BYTE_0 dst_unused:UNUSED_PRESERVE src0_sel:BYTE_0
    ds_write_b64 v0, v[42:43] offset:1664
    s_and_b64 exec, s[46:47], s[30:31]
    v_lshlrev_b32_sdwa v0, 8, v44 dst_sel:DWORD dst_unused:UNUSED_PAD src0_sel:DWORD src1_sel:BYTE_0
    v_cmp_le_u32 vcc, s19, v51
    v_and_or_b32 v0, v51, s20, v0
    s_cbranch_vccnz B_sp83
B_spb83:
    v_mov_b32_sdwa v44, s21 dst_sel:BYTE_0 dst_unused:UNUSED_PRESERVE src0_sel:BYTE_0
    ds_write_b64 v0, v[44:45] offset:1664
    s_mov_b64 exec, -1
    s_mov_b64 exec, 1
    v_mov_b32 v0, 0
    v_mov_b32 v1, 1
    ds_add_u32 v0, v1 offset:1604
    s_mov_b64 exec, -1
    s_waitcnt lgkmcnt(3)
    v_mfma_f32_16x16x32_bf16 v[176:179], v[38:41], v[30:33], v[176:179]
    v_mfma_f32_16x16x32_bf16 v[180:183], v[38:41], v[34:37], v[180:183]
    v_lshrrev_b32 v0, 7, v28
    v_and_or_b32 v0, v0, s18, v3
    v_cmpx_eq_u32_sdwa s[68:69], s16, v28 src0_sel:DWORD src1_sel:BYTE_0
    v_bfe_u32 v1, v28, 8, 4
    v_lshl_add_u32 v55, v1, 4, v4
    v_lshrrev_b32_sdwa v55, v3, v29 dst_sel:WORD_1 dst_unused:UNUSED_PRESERVE src0_sel:DWORD src1_sel:DWORD
    s_waitcnt vmcnt(2)
    v_mfma_f32_16x16x32_bf16 v[30:33], v[20:23], v[8:11], 0
    v_mfma_f32_16x16x32_bf16 v[34:37], v[20:23], v[12:15], 0
    buffer_load_dwordx4 v[20:23], v0, s[4:7], 0 offen
    s_mov_b64 exec, s[60:61]
    v_and_b32 v0, s22, v7
    ds_write_b16_d16_hi v0, v3 offset:65280
    s_mov_b64 exec, s[62:63]
    v_and_b32 v1, s22, v52
    ds_write_b16_d16_hi v1, v52 offset:65280
    s_mov_b64 exec, -1
    ds_read_b64 v[28:29], v2 offset:56960
    v_cvt_pk_bf16_f32 v38, v30, v31
    v_cvt_pk_bf16_f32 v39, v32, v33
    v_cvt_pk_bf16_f32 v40, v34, v35
    v_cvt_pk_bf16_f32 v41, v36, v37
    ds_read_b128 v[30:33], v5
    ds_read_b128 v[34:37], v5 offset:1024
    s_waitcnt lgkmcnt(0)
    v_mfma_f32_16x16x32_bf16 v[184:187], v[38:41], v[30:33], v[184:187]
    v_mfma_f32_16x16x32_bf16 v[188:191], v[38:41], v[34:37], v[188:191]
    v_lshrrev_b32 v0, 7, v28
    v_and_or_b32 v0, v0, s18, v3
    v_cmpx_eq_u32_sdwa s[60:61], s16, v28 src0_sel:DWORD src1_sel:BYTE_0
    v_bfe_u32 v1, v28, 8, 4
    v_lshl_add_u32 v7, v1, 4, v4
    v_lshrrev_b32_sdwa v7, v3, v29 dst_sel:WORD_1 dst_unused:UNUSED_PRESERVE src0_sel:DWORD src1_sel:DWORD
    s_waitcnt vmcnt(2)
    v_mfma_f32_16x16x32_bf16 v[30:33], v[24:27], v[8:11], 0
    v_mfma_f32_16x16x32_bf16 v[34:37], v[24:27], v[12:15], 0
    buffer_load_dwordx4 v[24:27], v0, s[4:7], 0 offen
    s_mov_b64 exec, s[62:63]
    v_and_b32 v0, s22, v52
    ds_write_b16_d16_hi v0, v3 offset:65280
    s_mov_b64 exec, s[64:65]
    v_and_b32 v1, s22, v53
    ds_write_b16_d16_hi v1, v53 offset:65280
    s_mov_b64 exec, -1
    ds_read_b64 v[28:29], v2 offset:57216
    v_cvt_pk_bf16_f32 v38, v30, v31
    v_cvt_pk_bf16_f32 v39, v32, v33
    v_cvt_pk_bf16_f32 v40, v34, v35
    v_cvt_pk_bf16_f32 v41, v36, v37
    ds_read_b128 v[30:33], v5
    ds_read_b128 v[34:37], v5 offset:1024
    s_waitcnt lgkmcnt(0)
    v_mfma_f32_16x16x32_bf16 v[192:195], v[38:41], v[30:33], v[192:195]
    v_mfma_f32_16x16x32_bf16 v[196:199], v[38:41], v[34:37], v[196:199]
    v_lshrrev_b32 v0, 7, v28
    v_and_or_b32 v0, v0, s18, v3
    v_cmpx_eq_u32_sdwa s[62:63], s16, v28 src0_sel:DWORD src1_sel:BYTE_0
    v_bfe_u32 v1, v28, 8, 4
    v_lshl_add_u32 v52, v1, 4, v4
    v_lshrrev_b32_sdwa v52, v3, v29 dst_sel:WORD_1 dst_unused:UNUSED_PRESERVE src0_sel:DWORD src1_sel:DWORD
    s_waitcnt vmcnt(2)
    v_mfma_f32_16x16x32_bf16 v[30:33], v[16:19], v[8:11], 0
    v_mfma_f32_16x16x32_bf16 v[34:37], v[16:19], v[12:15], 0
    buffer_load_dwordx4 v[16:19], v0, s[4:7], 0 offen
    s_mov_b64 exec, s[64:65]
    v_and_b32 v0, s22, v53
    ds_write_b16_d16_hi v0, v3 offset:65280
    s_mov_b64 exec, s[66:67]
    v_and_b32 v1, s22, v54
    ds_write_b16_d16_hi v1, v54 offset:65280
    s_mov_b64 exec, -1
    ds_read_b64 v[28:29], v2 offset:57472
    v_cvt_pk_bf16_f32 v38, v30, v31
    v_cvt_pk_bf16_f32 v39, v32, v33
    v_cvt_pk_bf16_f32 v40, v34, v35
    v_cvt_pk_bf16_f32 v41, v36, v37
    ds_read_b128 v[30:33], v5
    ds_read_b128 v[34:37], v5 offset:1024
    s_waitcnt lgkmcnt(0)
    v_mfma_f32_16x16x32_bf16 v[200:203], v[38:41], v[30:33], v[200:203]
    v_mfma_f32_16x16x32_bf16 v[204:207], v[38:41], v[34:37], v[204:207]
    v_lshrrev_b32 v0, 7, v28
    v_and_or_b32 v0, v0, s18, v3
    v_cmpx_eq_u32_sdwa s[64:65], s16, v28 src0_sel:DWORD src1_sel:BYTE_0
    v_bfe_u32 v1, v28, 8, 4
    v_lshl_add_u32 v53, v1, 4, v4
    v_lshrrev_b32_sdwa v53, v3, v29 dst_sel:WORD_1 dst_unused:UNUSED_PRESERVE src0_sel:DWORD src1_sel:DWORD
    s_waitcnt vmcnt(2)
    v_mfma_f32_16x16x32_bf16 v[30:33], v[20:23], v[8:11], 0
    v_mfma_f32_16x16x32_bf16 v[34:37], v[20:23], v[12:15], 0
    buffer_load_dwordx4 v[20:23], v0, s[4:7], 0 offen
    s_mov_b64 exec, s[66:67]
    v_and_b32 v0, s22, v54
    ds_write_b16_d16_hi v0, v3 offset:65280
    s_mov_b64 exec, s[68:69]
    v_and_b32 v1, s22, v55
    ds_write_b16_d16_hi v1, v55 offset:65280
    s_mov_b64 exec, -1
    ds_read_b64 v[28:29], v2 offset:57728
    v_cvt_pk_bf16_f32 v38, v30, v31
    v_cvt_pk_bf16_f32 v39, v32, v33
    v_cvt_pk_bf16_f32 v40, v34, v35
    v_cvt_pk_bf16_f32 v41, v36, v37
    ds_read_b128 v[30:33], v5
    ds_read_b128 v[34:37], v5 offset:1024
    s_waitcnt lgkmcnt(0)
    v_mfma_f32_16x16x32_bf16 v[208:211], v[38:41], v[30:33], v[208:211]
    v_mfma_f32_16x16x32_bf16 v[212:215], v[38:41], v[34:37], v[212:215]
    v_lshrrev_b32 v0, 7, v28
    v_and_or_b32 v0, v0, s18, v3
    v_cmpx_eq_u32_sdwa s[66:67], s16, v28 src0_sel:DWORD src1_sel:BYTE_0
    v_bfe_u32 v1, v28, 8, 4
    v_lshl_add_u32 v54, v1, 4, v4
    v_lshrrev_b32_sdwa v54, v3, v29 dst_sel:WORD_1 dst_unused:UNUSED_PRESERVE src0_sel:DWORD src1_sel:DWORD
    s_waitcnt vmcnt(2)
    v_mfma_f32_16x16x32_bf16 v[30:33], v[24:27], v[8:11], 0
    v_mfma_f32_16x16x32_bf16 v[34:37], v[24:27], v[12:15], 0
    buffer_load_dwordx4 v[24:27], v0, s[4:7], 0 offen
    s_mov_b64 exec, s[68:69]
    v_and_b32 v0, s22, v55
    ds_write_b16_d16_hi v0, v3 offset:65280
    s_mov_b64 exec, s[60:61]
    v_and_b32 v1, s22, v7
    ds_write_b16_d16_hi v1, v7 offset:65280
    s_mov_b64 exec, -1
    ds_read_b64 v[28:29], v2 offset:57984
    v_cvt_pk_bf16_f32 v38, v30, v31
    v_cvt_pk_bf16_f32 v39, v32, v33
    v_cvt_pk_bf16_f32 v40, v34, v35
    v_cvt_pk_bf16_f32 v41, v36, v37
    ds_read_b128 v[30:33], v5
    ds_read_b128 v[34:37], v5 offset:1024
    v_mov_b32 v42, 0
    v_mov_b32 v43, 0
    v_mov_b32 v44, 0
    v_mov_b32 v45, 0
    s_add_u32 s36, s34, 1
    s_and_b32 s36, s36, 126
    s_cbranch_scc0 B_cl84
B_clb84:
    s_mov_b64 exec, 1
    v_mov_b32 v0, 0
    v_mov_b32 v1, 1
    ds_add_u32 v0, v1 offset:1608
    s_mov_b64 exec, -1
    s_waitcnt lgkmcnt(1)
    v_mfma_f32_16x16x32_bf16 v[216:219], v[38:41], v[30:33], v[216:219]
    v_mfma_f32_16x16x32_bf16 v[220:223], v[38:41], v[34:37], v[220:223]
    v_lshrrev_b32 v0, 7, v28
    v_and_or_b32 v0, v0, s18, v3
    v_cmpx_eq_u32_sdwa s[68:69], s17, v28 src0_sel:DWORD src1_sel:BYTE_0
    v_bfe_u32 v1, v28, 8, 4
    v_lshl_add_u32 v55, v1, 4, v4
    v_lshrrev_b32_sdwa v55, v3, v29 dst_sel:WORD_1 dst_unused:UNUSED_PRESERVE src0_sel:DWORD src1_sel:DWORD
    s_waitcnt vmcnt(2)
    v_mfma_f32_16x16x32_bf16 v[30:33], v[16:19], v[8:11], 0
    v_mfma_f32_16x16x32_bf16 v[34:37], v[16:19], v[12:15], 0
    buffer_load_dwordx4 v[42:45], v0, s[4:7], 0 offen
    s_mov_b64 exec, s[60:61]
    v_and_b32 v0, s22, v7
    ds_write_b16_d16_hi v0, v3 offset:65280
    s_mov_b64 exec, s[62:63]
    v_and_b32 v1, s22, v52
    ds_write_b16_d16_hi v1, v52 offset:65280
    s_mov_b64 exec, -1
    v_cvt_pk_bf16_f32 v38, v30, v31
    v_cvt_pk_bf16_f32 v39, v32, v33
    v_cvt_pk_bf16_f32 v40, v34, v35
    v_cvt_pk_bf16_f32 v41, v36, v37
    ds_read_b128 v[30:33], v5
    ds_read_b128 v[34:37], v5 offset:1024
    v_mov_b32 v0, 0
    ds_read_b32 v50, v0 offset:1604
    s_add_u32 s25, s25, 256
    s_mov_b64 s[32:33], 0
    s_cmp_eq_u32 s30, 0
    s_cbranch_scc1 B_st85
B_stb85:
    s_add_u32 s34, s34, 1
    s_add_u32 s72, s72, 8
    s_mov_b32 s16, s21
    s_add_u32 s21, s21, 1
    s_and_b32 s21, s21, 255
    s_or_b32 s17, s16, s50
    s_waitcnt lgkmcnt(0)
    v_readfirstlane_b32 s36, v50
    s_cmp_lt_u32 s36, s72
    s_cbranch_scc1 B_sy86
B_syb86:
    s_branch B_loop0
B_free1:
    s_mov_b32 s29, 50176
    s_branch B_free
B_free0:
    s_mov_b32 s29, 0
B_free:
    v_mov_b32 v0, 0
    v_add_u32 v2, s29, v2
    ds_read_b32 v46, v0 offset:1600
    ds_read_b64 v[28:29], v2 offset:1664
    s_waitcnt lgkmcnt(1)
    v_readfirstlane_b32 s36, v46
    s_add_u32 s36, s36, 1
    s_cmp_lt_u32 s36, s34
    s_cbranch_scc1 B_epi
    s_cmp_eq_u32 s50, 0
    s_cbranch_scc1 B_prf_0
    s_setprio 1
B_prf_0:
    v_mfma_f32_16x16x32_bf16 v[224:227], v[38:41], v[30:33], v[224:227]
    v_mfma_f32_16x16x32_bf16 v[228:231], v[38:41], v[34:37], v[228:231]
    s_waitcnt lgkmcnt(0)
    v_lshrrev_b32 v0, 7, v28
    v_and_or_b32 v0, v0, s18, v3
    v_cmpx_eq_u32_sdwa s[60:61], s16, v28 src0_sel:DWORD src1_sel:BYTE_0
    v_bfe_u32 v1, v28, 8, 4
    v_lshl_add_u32 v7, v1, 4, v4
    v_lshrrev_b32_sdwa v7, v3, v29 dst_sel:WORD_1 dst_unused:UNUSED_PRESERVE src0_sel:DWORD src1_sel:DWORD
    s_waitcnt vmcnt(2)
    v_mfma_f32_16x16x32_bf16 v[30:33], v[20:23], v[8:11], 0
    v_mfma_f32_16x16x32_bf16 v[34:37], v[20:23], v[12:15], 0
    buffer_load_dwordx4 v[16:19], v0, s[4:7], 0 offen
    s_mov_b64 exec, s[62:63]
    v_and_b32 v0, s22, v52
    ds_write_b16_d16_hi v0, v3 offset:65280
    s_mov_b64 exec, s[64:65]
    v_and_b32 v1, s22, v53
    ds_write_b16_d16_hi v1, v53 offset:65280
    s_mov_b64 exec, -1
    ds_read_b64 v[28:29], v2 offset:1920
    v_cvt_pk_bf16_f32 v38, v30, v31
    v_cvt_pk_bf16_f32 v39, v32, v33
    v_cvt_pk_bf16_f32 v40, v34, v35
    v_cvt_pk_bf16_f32 v41, v36, v37
    ds_read_b128 v[30:33], v5
    ds_read_b128 v[34:37], v5 offset:1024
    s_cmp_lg_u32 s29, 0
    s_cselect_b32 s36, 800, 0
    v_mbcnt_lo_u32_b32 v0, -1, 0
    v_mbcnt_hi_u32_b32 v0, -1, v0
    v_add_u32 v0, s51, v0
    v_and_b32 v1, 31, v0
    v_lshl_add_u32 v0, v0, 2, s36
    v_lshlrev_b32 v1, 3, v1
    s_mov_b64 exec, s[52:53]
    ds_write_b32 v0, v1 offset:0
    s_mov_b64 exec, 1
    v_mov_b32 v0, 0
    v_mov_b32 v1, 1
    ds_add_u32 v0, v1 offset:1604
    s_mov_b64 exec, -1
    s_waitcnt lgkmcnt(2)
    v_mfma_f32_16x16x32_bf16 v[232:235], v[38:41], v[30:33], v[232:235]
    v_mfma_f32_16x16x32_bf16 v[236:239], v[38:41], v[34:37], v[236:239]
    v_lshrrev_b32 v0, 7, v28
    v_and_or_b32 v0, v0, s18, v3
    v_cmpx_eq_u32_sdwa s[62:63], s16, v28 src0_sel:DWORD src1_sel:BYTE_0
    v_bfe_u32 v1, v28, 8, 4
    v_lshl_add_u32 v52, v1, 4, v4
    v_lshrrev_b32_sdwa v52, v3, v29 dst_sel:WORD_1 dst_unused:UNUSED_PRESERVE src0_sel:DWORD src1_sel:DWORD
    s_waitcnt vmcnt(2)
    v_mfma_f32_16x16x32_bf16 v[30:33], v[24:27], v[8:11], 0
    v_mfma_f32_16x16x32_bf16 v[34:37], v[24:27], v[12:15], 0
    buffer_load_dwordx4 v[20:23], v0, s[4:7], 0 offen
    s_mov_b64 exec, s[64:65]
    v_and_b32 v0, s22, v53
    ds_write_b16_d16_hi v0, v3 offset:65280
    s_mov_b64 exec, s[66:67]
    v_and_b32 v1, s22, v54
    ds_write_b16_d16_hi v1, v54 offset:65280
    s_mov_b64 exec, -1
    ds_read_b64 v[28:29], v2 offset:2176
    v_cvt_pk_bf16_f32 v38, v30, v31
    v_cvt_pk_bf16_f32 v39, v32, v33
    v_cvt_pk_bf16_f32 v40, v34, v35
    v_cvt_pk_bf16_f32 v41, v36, v37
    ds_read_b128 v[30:33], v5
    ds_read_b128 v[34:37], v5 offset:1024
    s_waitcnt lgkmcnt(0)
    v_mfma_f32_16x16x32_bf16 v[240:243], v[38:41], v[30:33], v[240:243]
    v_mfma_f32_16x16x32_bf16 v[244:247], v[38:41], v[34:37], v[244:247]
    v_lshrrev_b32 v0, 7, v28
    v_and_or_b32 v0, v0, s18, v3
    v_cmpx_eq_u32_sdwa s[64:65], s16, v28 src0_sel:DWORD src1_sel:BYTE_0
    v_bfe_u32 v1, v28, 8, 4
    v_lshl_add_u32 v53, v1, 4, v4
    v_lshrrev_b32_sdwa v53, v3, v29 dst_sel:WORD_1 dst_unused:UNUSED_PRESERVE src0_sel:DWORD src1_sel:DWORD
    s_waitcnt vmcnt(2)
    v_mfma_f32_16x16x32_bf16 v[30:33], v[42:45], v[8:11], 0
    v_mfma_f32_16x16x32_bf16 v[34:37], v[42:45], v[12:15], 0
    buffer_load_dwordx4 v[24:27], v0, s[4:7], 0 offen
    s_mov_b64 exec, s[66:67]
    v_and_b32 v0, s22, v54
    ds_write_b16_d16_hi v0, v3 offset:65280
    s_mov_b64 exec, s[68:69]
    v_and_b32 v1, s22, v55
    ds_write_b16_d16_hi v1, v55 offset:65280
    s_mov_b64 exec, -1
    ds_read_b64 v[28:29], v2 offset:2432
    v_cvt_pk_bf16_f32 v38, v30, v31
    v_cvt_pk_bf16_f32 v39, v32, v33
    v_cvt_pk_bf16_f32 v40, v34, v35
    v_cvt_pk_bf16_f32 v41, v36, v37
    ds_read_b128 v[30:33], v5
    ds_read_b128 v[34:37], v5 offset:1024
    s_waitcnt lgkmcnt(0)
    v_mfma_f32_16x16x32_bf16 v[248:251], v[38:41], v[30:33], v[248:251]
    v_mfma_f32_16x16x32_bf16 v[252:255], v[38:41], v[34:37], v[252:255]
    v_lshrrev_b32 v0, 7, v28
    v_and_or_b32 v0, v0, s18, v3
    v_cmpx_eq_u32_sdwa s[66:67], s16, v28 src0_sel:DWORD src1_sel:BYTE_0
    v_bfe_u32 v1, v28, 8, 4
    v_lshl_add_u32 v54, v1, 4, v4
    v_lshrrev_b32_sdwa v54, v3, v29 dst_sel:WORD_1 dst_unused:UNUSED_PRESERVE src0_sel:DWORD src1_sel:DWORD
    s_waitcnt vmcnt(2)
    v_mfma_f32_16x16x32_bf16 v[30:33], v[16:19], v[8:11], 0
    v_mfma_f32_16x16x32_bf16 v[34:37], v[16:19], v[12:15], 0
    buffer_load_dwordx4 v[16:19], v0, s[4:7], 0 offen
    s_mov_b64 exec, s[68:69]
    v_and_b32 v0, s22, v55
    ds_write_b16_d16_hi v0, v3 offset:65280
    s_mov_b64 exec, s[60:61]
    v_and_b32 v1, s22, v7
    ds_write_b16_d16_hi v1, v7 offset:65280
    s_mov_b64 exec, -1
    ds_read_b64 v[28:29], v2 offset:2688
    v_cvt_pk_bf16_f32 v38, v30, v31
    v_cvt_pk_bf16_f32 v39, v32, v33
    v_cvt_pk_bf16_f32 v40, v34, v35
    v_cvt_pk_bf16_f32 v41, v36, v37
    ds_read_b128 v[30:33], v5
    ds_read_b128 v[34:37], v5 offset:1024
    s_waitcnt lgkmcnt(0)
    v_mfma_f32_16x16x32_bf16 v[56:59], v[38:41], v[30:33], v[56:59]
    v_mfma_f32_16x16x32_bf16 v[60:63], v[38:41], v[34:37], v[60:63]
    v_lshrrev_b32 v0, 7, v28
    v_and_or_b32 v0, v0, s18, v3
    v_cmpx_eq_u32_sdwa s[68:69], s16, v28 src0_sel:DWORD src1_sel:BYTE_0
    v_bfe_u32 v1, v28, 8, 4
    v_lshl_add_u32 v55, v1, 4, v4
    v_lshrrev_b32_sdwa v55, v3, v29 dst_sel:WORD_1 dst_unused:UNUSED_PRESERVE src0_sel:DWORD src1_sel:DWORD
    s_waitcnt vmcnt(2)
    v_mfma_f32_16x16x32_bf16 v[30:33], v[20:23], v[8:11], 0
    v_mfma_f32_16x16x32_bf16 v[34:37], v[20:23], v[12:15], 0
    buffer_load_dwordx4 v[20:23], v0, s[4:7], 0 offen
    s_mov_b64 exec, s[60:61]
    v_and_b32 v0, s22, v7
    ds_write_b16_d16_hi v0, v3 offset:65280
    s_mov_b64 exec, s[62:63]
    v_and_b32 v1, s22, v52
    ds_write_b16_d16_hi v1, v52 offset:65280
    s_mov_b64 exec, -1
    ds_read_b64 v[28:29], v2 offset:2944
    v_cvt_pk_bf16_f32 v38, v30, v31
    v_cvt_pk_bf16_f32 v39, v32, v33
    v_cvt_pk_bf16_f32 v40, v34, v35
    v_cvt_pk_bf16_f32 v41, v36, v37
    ds_read_b128 v[30:33], v5
    ds_read_b128 v[34:37], v5 offset:1024
    s_waitcnt lgkmcnt(0)
    v_mfma_f32_16x16x32_bf16 v[64:67], v[38:41], v[30:33], v[64:67]
    v_mfma_f32_16x16x32_bf16 v[68:71], v[38:41], v[34:37], v[68:71]
    v_lshrrev_b32 v0, 7, v28
    v_and_or_b32 v0, v0, s18, v3
    v_cmpx_eq_u32_sdwa s[60:61], s16, v28 src0_sel:DWORD src1_sel:BYTE_0
    v_bfe_u32 v1, v28, 8, 4
    v_lshl_add_u32 v7, v1, 4, v4
    v_lshrrev_b32_sdwa v7, v3, v29 dst_sel:WORD_1 dst_unused:UNUSED_PRESERVE src0_sel:DWORD src1_sel:DWORD
    s_waitcnt vmcnt(2)
    v_mfma_f32_16x16x32_bf16 v[30:33], v[24:27], v[8:11], 0
    v_mfma_f32_16x16x32_bf16 v[34:37], v[24:27], v[12:15], 0
    buffer_load_dwordx4 v[24:27], v0, s[4:7], 0 offen
    s_mov_b64 exec, s[62:63]
    v_and_b32 v0, s22, v52
    ds_write_b16_d16_hi v0, v3 offset:65280
    s_mov_b64 exec, s[64:65]
    v_and_b32 v1, s22, v53
    ds_write_b16_d16_hi v1, v53 offset:65280
    s_mov_b64 exec, -1
    ds_read_b64 v[28:29], v2 offset:3200
    v_cvt_pk_bf16_f32 v38, v30, v31
    v_cvt_pk_bf16_f32 v39, v32, v33
    v_cvt_pk_bf16_f32 v40, v34, v35
    v_cvt_pk_bf16_f32 v41, v36, v37
    ds_read_b128 v[30:33], v5
    ds_read_b128 v[34:37], v5 offset:1024
    s_waitcnt lgkmcnt(0)
    v_mfma_f32_16x16x32_bf16 v[72:75], v[38:41], v[30:33], v[72:75]
    v_mfma_f32_16x16x32_bf16 v[76:79], v[38:41], v[34:37], v[76:79]
    v_lshrrev_b32 v0, 7, v28
    v_and_or_b32 v0, v0, s18, v3
    v_cmpx_eq_u32_sdwa s[62:63], s16, v28 src0_sel:DWORD src1_sel:BYTE_0
    v_bfe_u32 v1, v28, 8, 4
    v_lshl_add_u32 v52, v1, 4, v4
    v_lshrrev_b32_sdwa v52, v3, v29 dst_sel:WORD_1 dst_unused:UNUSED_PRESERVE src0_sel:DWORD src1_sel:DWORD
    s_waitcnt vmcnt(2)
    v_mfma_f32_16x16x32_bf16 v[30:33], v[16:19], v[8:11], 0
    v_mfma_f32_16x16x32_bf16 v[34:37], v[16:19], v[12:15], 0
    buffer_load_dwordx4 v[16:19], v0, s[4:7], 0 offen
    s_mov_b64 exec, s[64:65]
    v_and_b32 v0, s22, v53
    ds_write_b16_d16_hi v0, v3 offset:65280
    s_mov_b64 exec, s[66:67]
    v_and_b32 v1, s22, v54
    ds_write_b16_d16_hi v1, v54 offset:65280
    s_mov_b64 exec, -1
    ds_read_b64 v[28:29], v2 offset:3456
    v_cvt_pk_bf16_f32 v38, v30, v31
    v_cvt_pk_bf16_f32 v39, v32, v33
    v_cvt_pk_bf16_f32 v40, v34, v35
    v_cvt_pk_bf16_f32 v41, v36, v37
    ds_read_b128 v[30:33], v5
    ds_read_b128 v[34:37], v5 offset:1024
    s_waitcnt lgkmcnt(0)
    v_mfma_f32_16x16x32_bf16 v[80:83], v[38:41], v[30:33], v[80:83]
    v_mfma_f32_16x16x32_bf16 v[84:87], v[38:41], v[34:37], v[84:87]
    v_lshrrev_b32 v0, 7, v28
    v_and_or_b32 v0, v0, s18, v3
    v_cmpx_eq_u32_sdwa s[64:65], s16, v28 src0_sel:DWORD src1_sel:BYTE_0
    v_bfe_u32 v1, v28, 8, 4
    v_lshl_add_u32 v53, v1, 4, v4
    v_lshrrev_b32_sdwa v53, v3, v29 dst_sel:WORD_1 dst_unused:UNUSED_PRESERVE src0_sel:DWORD src1_sel:DWORD
    s_waitcnt vmcnt(2)
    v_mfma_f32_16x16x32_bf16 v[30:33], v[20:23], v[8:11], 0
    v_mfma_f32_16x16x32_bf16 v[34:37], v[20:23], v[12:15], 0
    buffer_load_dwordx4 v[20:23], v0, s[4:7], 0 offen
    s_mov_b64 exec, s[66:67]
    v_and_b32 v0, s22, v54
    ds_write_b16_d16_hi v0, v3 offset:65280
    s_mov_b64 exec, s[68:69]
    v_and_b32 v1, s22, v55
    ds_write_b16_d16_hi v1, v55 offset:65280
    s_mov_b64 exec, -1
    ds_read_b64 v[28:29], v2 offset:3712
    v_cvt_pk_bf16_f32 v38, v30, v31
    v_cvt_pk_bf16_f32 v39, v32, v33
    v_cvt_pk_bf16_f32 v40, v34, v35
    v_cvt_pk_bf16_f32 v41, v36, v37
    ds_read_b128 v[30:33], v5
    ds_read_b128 v[34:37], v5 offset:1024
    s_waitcnt lgkmcnt(0)
    v_mfma_f32_16x16x32_bf16 v[88:91], v[38:41], v[30:33], v[88:91]
    v_mfma_f32_16x16x32_bf16 v[92:95], v[38:41], v[34:37], v[92:95]
    v_lshrrev_b32 v0, 7, v28
    v_and_or_b32 v0, v0, s18, v3
    v_cmpx_eq_u32_sdwa s[66:67], s16, v28 src0_sel:DWORD src1_sel:BYTE_0
    v_bfe_u32 v1, v28, 8, 4
    v_lshl_add_u32 v54, v1, 4, v4
    v_lshrrev_b32_sdwa v54, v3, v29 dst_sel:WORD_1 dst_unused:UNUSED_PRESERVE src0_sel:DWORD src1_sel:DWORD
    s_waitcnt vmcnt(2)
    v_mfma_f32_16x16x32_bf16 v[30:33], v[24:27], v[8:11], 0
    v_mfma_f32_16x16x32_bf16 v[34:37], v[24:27], v[12:15], 0
    buffer_load_dwordx4 v[24:27], v0, s[4:7], 0 offen
    s_mov_b64 exec, s[68:69]
    v_and_b32 v0, s22, v55
    ds_write_b16_d16_hi v0, v3 offset:65280
    s_mov_b64 exec, s[60:61]
    v_and_b32 v1, s22, v7
    ds_write_b16_d16_hi v1, v7 offset:65280
    s_mov_b64 exec, -1
    ds_read_b64 v[28:29], v2 offset:3968
    v_cvt_pk_bf16_f32 v38, v30, v31
    v_cvt_pk_bf16_f32 v39, v32, v33
    v_cvt_pk_bf16_f32 v40, v34, v35
    v_cvt_pk_bf16_f32 v41, v36, v37
    ds_read_b128 v[30:33], v5
    ds_read_b128 v[34:37], v5 offset:1024
    s_waitcnt lgkmcnt(0)
    v_mfma_f32_16x16x32_bf16 v[96:99], v[38:41], v[30:33], v[96:99]
    v_mfma_f32_16x16x32_bf16 v[100:103], v[38:41], v[34:37], v[100:103]
    v_lshrrev_b32 v0, 7, v28
    v_and_or_b32 v0, v0, s18, v3
    v_cmpx_eq_u32_sdwa s[68:69], s16, v28 src0_sel:DWORD src1_sel:BYTE_0
    v_bfe_u32 v1, v28, 8, 4
    v_lshl_add_u32 v55, v1, 4, v4
    v_lshrrev_b32_sdwa v55, v3, v29 dst_sel:WORD_1 dst_unused:UNUSED_PRESERVE src0_sel:DWORD src1_sel:DWORD
    s_waitcnt vmcnt(2)
    v_mfma_f32_16x16x32_bf16 v[30:33], v[16:19], v[8:11], 0
    v_mfma_f32_16x16x32_bf16 v[34:37], v[16:19], v[12:15], 0
    buffer_load_dwordx4 v[16:19], v0, s[4:7], 0 offen
    s_mov_b64 exec, s[60:61]
    v_and_b32 v0, s22, v7
    ds_write_b16_d16_hi v0, v3 offset:65280
    s_mov_b64 exec, s[62:63]
    v_and_b32 v1, s22, v52
    ds_write_b16_d16_hi v1, v52 offset:65280
    s_mov_b64 exec, -1
    ds_read_b64 v[28:29], v2 offset:4224
    v_cvt_pk_bf16_f32 v38, v30, v31
    v_cvt_pk_bf16_f32 v39, v32, v33
    v_cvt_pk_bf16_f32 v40, v34, v35
    v_cvt_pk_bf16_f32 v41, v36, v37
    ds_read_b128 v[30:33], v5
    ds_read_b128 v[34:37], v5 offset:1024
    s_waitcnt lgkmcnt(0)
    v_mfma_f32_16x16x32_bf16 v[104:107], v[38:41], v[30:33], v[104:107]
    v_mfma_f32_16x16x32_bf16 v[108:111], v[38:41], v[34:37], v[108:111]
    v_lshrrev_b32 v0, 7, v28
    v_and_or_b32 v0, v0, s18, v3
    v_cmpx_eq_u32_sdwa s[60:61], s16, v28 src0_sel:DWORD src1_sel:BYTE_0
    v_bfe_u32 v1, v28, 8, 4
    v_lshl_add_u32 v7, v1, 4, v4
    v_lshrrev_b32_sdwa v7, v3, v29 dst_sel:WORD_1 dst_unused:UNUSED_PRESERVE src0_sel:DWORD src1_sel:DWORD
    s_waitcnt vmcnt(2)
    v_mfma_f32_16x16x32_bf16 v[30:33], v[20:23], v[8:11], 0
    v_mfma_f32_16x16x32_bf16 v[34:37], v[20:23], v[12:15], 0
    buffer_load_dwordx4 v[20:23], v0, s[4:7], 0 offen
    s_mov_b64 exec, s[62:63]
    v_and_b32 v0, s22, v52
    ds_write_b16_d16_hi v0, v3 offset:65280
    s_mov_b64 exec, s[64:65]
    v_and_b32 v1, s22, v53
    ds_write_b16_d16_hi v1, v53 offset:65280
    s_mov_b64 exec, -1
    ds_read_b64 v[28:29], v2 offset:4480
    v_cvt_pk_bf16_f32 v38, v30, v31
    v_cvt_pk_bf16_f32 v39, v32, v33
    v_cvt_pk_bf16_f32 v40, v34, v35
    v_cvt_pk_bf16_f32 v41, v36, v37
    ds_read_b128 v[30:33], v5
    ds_read_b128 v[34:37], v5 offset:1024
    s_waitcnt lgkmcnt(0)
    v_mfma_f32_16x16x32_bf16 v[112:115], v[38:41], v[30:33], v[112:115]
    v_mfma_f32_16x16x32_bf16 v[116:119], v[38:41], v[34:37], v[116:119]
    v_lshrrev_b32 v0, 7, v28
    v_and_or_b32 v0, v0, s18, v3
    v_cmpx_eq_u32_sdwa s[62:63], s16, v28 src0_sel:DWORD src1_sel:BYTE_0
    v_bfe_u32 v1, v28, 8, 4
    v_lshl_add_u32 v52, v1, 4, v4
    v_lshrrev_b32_sdwa v52, v3, v29 dst_sel:WORD_1 dst_unused:UNUSED_PRESERVE src0_sel:DWORD src1_sel:DWORD
    s_waitcnt vmcnt(2)
    v_mfma_f32_16x16x32_bf16 v[30:33], v[24:27], v[8:11], 0
    v_mfma_f32_16x16x32_bf16 v[34:37], v[24:27], v[12:15], 0
    buffer_load_dwordx4 v[24:27], v0, s[4:7], 0 offen
    s_mov_b64 exec, s[64:65]
    v_and_b32 v0, s22, v53
    ds_write_b16_d16_hi v0, v3 offset:65280
    s_mov_b64 exec, s[66:67]
    v_and_b32 v1, s22, v54
    ds_write_b16_d16_hi v1, v54 offset:65280
    s_mov_b64 exec, -1
    ds_read_b64 v[28:29], v2 offset:4736
    v_cvt_pk_bf16_f32 v38, v30, v31
    v_cvt_pk_bf16_f32 v39, v32, v33
    v_cvt_pk_bf16_f32 v40, v34, v35
    v_cvt_pk_bf16_f32 v41, v36, v37
    ds_read_b128 v[30:33], v5
    ds_read_b128 v[34:37], v5 offset:1024
    s_setprio 0
    s_waitcnt lgkmcnt(0)
    v_mfma_f32_16x16x32_bf16 v[120:123], v[38:41], v[30:33], v[120:123]
    v_mfma_f32_16x16x32_bf16 v[124:127], v[38:41], v[34:37], v[124:127]
    v_lshrrev_b32 v0, 7, v28
    v_and_or_b32 v0, v0, s18, v3
    v_cmpx_eq_u32_sdwa s[64:65], s16, v28 src0_sel:DWORD src1_sel:BYTE_0
    v_bfe_u32 v1, v28, 8, 4
    v_lshl_add_u32 v53, v1, 4, v4
    v_lshrrev_b32_sdwa v53, v3, v29 dst_sel:WORD_1 dst_unused:UNUSED_PRESERVE src0_sel:DWORD src1_sel:DWORD
    s_waitcnt vmcnt(2)
    v_mfma_f32_16x16x32_bf16 v[30:33], v[16:19], v[8:11], 0
    v_mfma_f32_16x16x32_bf16 v[34:37], v[16:19], v[12:15], 0
    buffer_load_dwordx4 v[16:19], v0, s[4:7], 0 offen
    s_mov_b64 exec, s[66:67]
    v_and_b32 v0, s22, v54
    ds_write_b16_d16_hi v0, v3 offset:65280
    s_mov_b64 exec, s[68:69]
    v_and_b32 v1, s22, v55
    ds_write_b16_d16_hi v1, v55 offset:65280
    s_mov_b64 exec, -1
    ds_read_b64 v[28:29], v2 offset:4992
    v_cvt_pk_bf16_f32 v38, v30, v31
    v_cvt_pk_bf16_f32 v39, v32, v33
    v_cvt_pk_bf16_f32 v40, v34, v35
    v_cvt_pk_bf16_f32 v41, v36, v37
    ds_read_b128 v[30:33], v5
    ds_read_b128 v[34:37], v5 offset:1024
    s_waitcnt lgkmcnt(0)
    v_mfma_f32_16x16x32_bf16 v[128:131], v[38:41], v[30:33], v[128:131]
    v_mfma_f32_16x16x32_bf16 v[132:135], v[38:41], v[34:37], v[132:135]
    v_lshrrev_b32 v0, 7, v28
    v_and_or_b32 v0, v0, s18, v3
    v_cmpx_eq_u32_sdwa s[66:67], s16, v28 src0_sel:DWORD src1_sel:BYTE_0
    v_bfe_u32 v1, v28, 8, 4
    v_lshl_add_u32 v54, v1, 4, v4
    v_lshrrev_b32_sdwa v54, v3, v29 dst_sel:WORD_1 dst_unused:UNUSED_PRESERVE src0_sel:DWORD src1_sel:DWORD
    s_waitcnt vmcnt(2)
    v_mfma_f32_16x16x32_bf16 v[30:33], v[20:23], v[8:11], 0
    v_mfma_f32_16x16x32_bf16 v[34:37], v[20:23], v[12:15], 0
    buffer_load_dwordx4 v[20:23], v0, s[4:7], 0 offen
    s_mov_b64 exec, s[68:69]
    v_and_b32 v0, s22, v55
    ds_write_b16_d16_hi v0, v3 offset:65280
    s_mov_b64 exec, s[60:61]
    v_and_b32 v1, s22, v7
    ds_write_b16_d16_hi v1, v7 offset:65280
    s_mov_b64 exec, -1
    ds_read_b64 v[28:29], v2 offset:5248
    v_cvt_pk_bf16_f32 v38, v30, v31
    v_cvt_pk_bf16_f32 v39, v32, v33
    v_cvt_pk_bf16_f32 v40, v34, v35
    v_cvt_pk_bf16_f32 v41, v36, v37
    ds_read_b128 v[30:33], v5
    ds_read_b128 v[34:37], v5 offset:1024
    s_waitcnt lgkmcnt(0)
    v_mfma_f32_16x16x32_bf16 v[136:139], v[38:41], v[30:33], v[136:139]
    v_mfma_f32_16x16x32_bf16 v[140:143], v[38:41], v[34:37], v[140:143]
    v_lshrrev_b32 v0, 7, v28
    v_and_or_b32 v0, v0, s18, v3
    v_cmpx_eq_u32_sdwa s[68:69], s16, v28 src0_sel:DWORD src1_sel:BYTE_0
    v_bfe_u32 v1, v28, 8, 4
    v_lshl_add_u32 v55, v1, 4, v4
    v_lshrrev_b32_sdwa v55, v3, v29 dst_sel:WORD_1 dst_unused:UNUSED_PRESERVE src0_sel:DWORD src1_sel:DWORD
    s_waitcnt vmcnt(2)
    v_mfma_f32_16x16x32_bf16 v[30:33], v[24:27], v[8:11], 0
    v_mfma_f32_16x16x32_bf16 v[34:37], v[24:27], v[12:15], 0
    buffer_load_dwordx4 v[24:27], v0, s[4:7], 0 offen
    s_mov_b64 exec, s[60:61]
    v_and_b32 v0, s22, v7
    ds_write_b16_d16_hi v0, v3 offset:65280
    s_mov_b64 exec, s[62:63]
    v_and_b32 v1, s22, v52
    ds_write_b16_d16_hi v1, v52 offset:65280
    s_mov_b64 exec, -1
    ds_read_b64 v[28:29], v2 offset:5504
    v_cvt_pk_bf16_f32 v38, v30, v31
    v_cvt_pk_bf16_f32 v39, v32, v33
    v_cvt_pk_bf16_f32 v40, v34, v35
    v_cvt_pk_bf16_f32 v41, v36, v37
    ds_read_b128 v[30:33], v5
    ds_read_b128 v[34:37], v5 offset:1024
    s_waitcnt lgkmcnt(0)
    v_mfma_f32_16x16x32_bf16 v[144:147], v[38:41], v[30:33], v[144:147]
    v_mfma_f32_16x16x32_bf16 v[148:151], v[38:41], v[34:37], v[148:151]
    v_lshrrev_b32 v0, 7, v28
    v_and_or_b32 v0, v0, s18, v3
    v_cmpx_eq_u32_sdwa s[60:61], s16, v28 src0_sel:DWORD src1_sel:BYTE_0
    v_bfe_u32 v1, v28, 8, 4
    v_lshl_add_u32 v7, v1, 4, v4
    v_lshrrev_b32_sdwa v7, v3, v29 dst_sel:WORD_1 dst_unused:UNUSED_PRESERVE src0_sel:DWORD src1_sel:DWORD
    s_waitcnt vmcnt(2)
    v_mfma_f32_16x16x32_bf16 v[30:33], v[16:19], v[8:11], 0
    v_mfma_f32_16x16x32_bf16 v[34:37], v[16:19], v[12:15], 0
    buffer_load_dwordx4 v[16:19], v0, s[4:7], 0 offen
    s_mov_b64 exec, s[62:63]
    v_and_b32 v0, s22, v52
    ds_write_b16_d16_hi v0, v3 offset:65280
    s_mov_b64 exec, s[64:65]
    v_and_b32 v1, s22, v53
    ds_write_b16_d16_hi v1, v53 offset:65280
    s_mov_b64 exec, -1
    ds_read_b64 v[28:29], v2 offset:5760
    v_cvt_pk_bf16_f32 v38, v30, v31
    v_cvt_pk_bf16_f32 v39, v32, v33
    v_cvt_pk_bf16_f32 v40, v34, v35
    v_cvt_pk_bf16_f32 v41, v36, v37
    ds_read_b128 v[30:33], v5
    ds_read_b128 v[34:37], v5 offset:1024
    s_waitcnt lgkmcnt(0)
    v_mfma_f32_16x16x32_bf16 v[152:155], v[38:41], v[30:33], v[152:155]
    v_mfma_f32_16x16x32_bf16 v[156:159], v[38:41], v[34:37], v[156:159]
    v_lshrrev_b32 v0, 7, v28
    v_and_or_b32 v0, v0, s18, v3
    v_cmpx_eq_u32_sdwa s[62:63], s16, v28 src0_sel:DWORD src1_sel:BYTE_0
    v_bfe_u32 v1, v28, 8, 4
    v_lshl_add_u32 v52, v1, 4, v4
    v_lshrrev_b32_sdwa v52, v3, v29 dst_sel:WORD_1 dst_unused:UNUSED_PRESERVE src0_sel:DWORD src1_sel:DWORD
    s_waitcnt vmcnt(2)
    v_mfma_f32_16x16x32_bf16 v[30:33], v[20:23], v[8:11], 0
    v_mfma_f32_16x16x32_bf16 v[34:37], v[20:23], v[12:15], 0
    buffer_load_dwordx4 v[20:23], v0, s[4:7], 0 offen
    s_mov_b64 exec, s[64:65]
    v_and_b32 v0, s22, v53
    ds_write_b16_d16_hi v0, v3 offset:65280
    s_mov_b64 exec, s[66:67]
    v_and_b32 v1, s22, v54
    ds_write_b16_d16_hi v1, v54 offset:65280
    s_mov_b64 exec, -1
    ds_read_b64 v[28:29], v2 offset:6016
    v_cvt_pk_bf16_f32 v38, v30, v31
    v_cvt_pk_bf16_f32 v39, v32, v33
    v_cvt_pk_bf16_f32 v40, v34, v35
    v_cvt_pk_bf16_f32 v41, v36, v37
    ds_read_b128 v[30:33], v5
    ds_read_b128 v[34:37], v5 offset:1024
    s_waitcnt lgkmcnt(0)
    v_mfma_f32_16x16x32_bf16 v[160:163], v[38:41], v[30:33], v[160:163]
    v_mfma_f32_16x16x32_bf16 v[164:167], v[38:41], v[34:37], v[164:167]
    v_lshrrev_b32 v0, 7, v28
    v_and_or_b32 v0, v0, s18, v3
    v_cmpx_eq_u32_sdwa s[64:65], s16, v28 src0_sel:DWORD src1_sel:BYTE_0
    v_bfe_u32 v1, v28, 8, 4
    v_lshl_add_u32 v53, v1, 4, v4
    v_lshrrev_b32_sdwa v53, v3, v29 dst_sel:WORD_1 dst_unused:UNUSED_PRESERVE src0_sel:DWORD src1_sel:DWORD
    s_waitcnt vmcnt(2)
    v_mfma_f32_16x16x32_bf16 v[30:33], v[24:27], v[8:11], 0
    v_mfma_f32_16x16x32_bf16 v[34:37], v[24:27], v[12:15], 0
    buffer_load_dwordx4 v[24:27], v0, s[4:7], 0 offen
    s_mov_b64 exec, s[66:67]
    v_and_b32 v0, s22, v54
    ds_write_b16_d16_hi v0, v3 offset:65280
    s_mov_b64 exec, s[68:69]
    v_and_b32 v1, s22, v55
    ds_write_b16_d16_hi v1, v55 offset:65280
    s_mov_b64 exec, -1
    ds_read_b64 v[28:29], v2 offset:6272
    v_cvt_pk_bf16_f32 v38, v30, v31
    v_cvt_pk_bf16_f32 v39, v32, v33
    v_cvt_pk_bf16_f32 v40, v34, v35
    v_cvt_pk_bf16_f32 v41, v36, v37
    ds_read_b128 v[30:33], v5
    ds_read_b128 v[34:37], v5 offset:1024
    s_waitcnt lgkmcnt(0)
    v_mfma_f32_16x16x32_bf16 v[168:171], v[38:41], v[30:33], v[168:171]
    v_mfma_f32_16x16x32_bf16 v[172:175], v[38:41], v[34:37], v[172:175]
    v_lshrrev_b32 v0, 7, v28
    v_and_or_b32 v0, v0, s18, v3
    v_cmpx_eq_u32_sdwa s[66:67], s16, v28 src0_sel:DWORD src1_sel:BYTE_0
    v_bfe_u32 v1, v28, 8, 4
    v_lshl_add_u32 v54, v1, 4, v4
    v_lshrrev_b32_sdwa v54, v3, v29 dst_sel:WORD_1 dst_unused:UNUSED_PRESERVE src0_sel:DWORD src1_sel:DWORD
    s_waitcnt vmcnt(2)
    v_mfma_f32_16x16x32_bf16 v[30:33], v[16:19], v[8:11], 0
    v_mfma_f32_16x16x32_bf16 v[34:37], v[16:19], v[12:15], 0
    buffer_load_dwordx4 v[16:19], v0, s[4:7], 0 offen
    s_mov_b64 exec, s[68:69]
    v_and_b32 v0, s22, v55
    ds_write_b16_d16_hi v0, v3 offset:65280
    s_mov_b64 exec, s[60:61]
    v_and_b32 v1, s22, v7
    ds_write_b16_d16_hi v1, v7 offset:65280
    s_mov_b64 exec, -1
    ds_read_b64 v[28:29], v2 offset:6528
    v_cvt_pk_bf16_f32 v38, v30, v31
    v_cvt_pk_bf16_f32 v39, v32, v33
    v_cvt_pk_bf16_f32 v40, v34, v35
    v_cvt_pk_bf16_f32 v41, v36, v37
    ds_read_b128 v[30:33], v5
    ds_read_b128 v[34:37], v5 offset:1024
    s_waitcnt lgkmcnt(0)
    v_mfma_f32_16x16x32_bf16 v[176:179], v[38:41], v[30:33], v[176:179]
    v_mfma_f32_16x16x32_bf16 v[180:183], v[38:41], v[34:37], v[180:183]
    v_lshrrev_b32 v0, 7, v28
    v_and_or_b32 v0, v0, s18, v3
    v_cmpx_eq_u32_sdwa s[68:69], s16, v28 src0_sel:DWORD src1_sel:BYTE_0
    v_bfe_u32 v1, v28, 8, 4
    v_lshl_add_u32 v55, v1, 4, v4
    v_lshrrev_b32_sdwa v55, v3, v29 dst_sel:WORD_1 dst_unused:UNUSED_PRESERVE src0_sel:DWORD src1_sel:DWORD
    s_waitcnt vmcnt(2)
    v_mfma_f32_16x16x32_bf16 v[30:33], v[20:23], v[8:11], 0
    v_mfma_f32_16x16x32_bf16 v[34:37], v[20:23], v[12:15], 0
    buffer_load_dwordx4 v[20:23], v0, s[4:7], 0 offen
    s_mov_b64 exec, s[60:61]
    v_and_b32 v0, s22, v7
    ds_write_b16_d16_hi v0, v3 offset:65280
    s_mov_b64 exec, s[62:63]
    v_and_b32 v1, s22, v52
    ds_write_b16_d16_hi v1, v52 offset:65280
    s_mov_b64 exec, -1
    ds_read_b64 v[28:29], v2 offset:6784
    v_cvt_pk_bf16_f32 v38, v30, v31
    v_cvt_pk_bf16_f32 v39, v32, v33
    v_cvt_pk_bf16_f32 v40, v34, v35
    v_cvt_pk_bf16_f32 v41, v36, v37
    ds_read_b128 v[30:33], v5
    ds_read_b128 v[34:37], v5 offset:1024
    s_waitcnt lgkmcnt(0)
    v_mfma_f32_16x16x32_bf16 v[184:187], v[38:41], v[30:33], v[184:187]
    v_mfma_f32_16x16x32_bf16 v[188:191], v[38:41], v[34:37], v[188:191]
    v_lshrrev_b32 v0, 7, v28
    v_and_or_b32 v0, v0, s18, v3
    v_cmpx_eq_u32_sdwa s[60:61], s16, v28 src0_sel:DWORD src1_sel:BYTE_0
    v_bfe_u32 v1, v28, 8, 4
    v_lshl_add_u32 v7, v1, 4, v4
    v_lshrrev_b32_sdwa v7, v3, v29 dst_sel:WORD_1 dst_unused:UNUSED_PRESERVE src0_sel:DWORD src1_sel:DWORD
    s_waitcnt vmcnt(2)
    v_mfma_f32_16x16x32_bf16 v[30:33], v[24:27], v[8:11], 0
    v_mfma_f32_16x16x32_bf16 v[34:37], v[24:27], v[12:15], 0
    buffer_load_dwordx4 v[24:27], v0, s[4:7], 0 offen
    s_mov_b64 exec, s[62:63]
    v_and_b32 v0, s22, v52
    ds_write_b16_d16_hi v0, v3 offset:65280
    s_mov_b64 exec, s[64:65]
    v_and_b32 v1, s22, v53
    ds_write_b16_d16_hi v1, v53 offset:65280
    s_mov_b64 exec, -1
    ds_read_b64 v[28:29], v2 offset:7040
    v_cvt_pk_bf16_f32 v38, v30, v31
    v_cvt_pk_bf16_f32 v39, v32, v33
    v_cvt_pk_bf16_f32 v40, v34, v35
    v_cvt_pk_bf16_f32 v41, v36, v37
    ds_read_b128 v[30:33], v5
    ds_read_b128 v[34:37], v5 offset:1024
    s_waitcnt lgkmcnt(0)
    v_mfma_f32_16x16x32_bf16 v[192:195], v[38:41], v[30:33], v[192:195]
    v_mfma_f32_16x16x32_bf16 v[196:199], v[38:41], v[34:37], v[196:199]
    v_lshrrev_b32 v0, 7, v28
    v_and_or_b32 v0, v0, s18, v3
    v_cmpx_eq_u32_sdwa s[62:63], s16, v28 src0_sel:DWORD src1_sel:BYTE_0
    v_bfe_u32 v1, v28, 8, 4
    v_lshl_add_u32 v52, v1, 4, v4
    v_lshrrev_b32_sdwa v52, v3, v29 dst_sel:WORD_1 dst_unused:UNUSED_PRESERVE src0_sel:DWORD src1_sel:DWORD
    s_waitcnt vmcnt(2)
    v_mfma_f32_16x16x32_bf16 v[30:33], v[16:19], v[8:11], 0
    v_mfma_f32_16x16x32_bf16 v[34:37], v[16:19], v[12:15], 0
    buffer_load_dwordx4 v[16:19], v0, s[4:7], 0 offen
    s_mov_b64 exec, s[64:65]
    v_and_b32 v0, s22, v53
    ds_write_b16_d16_hi v0, v3 offset:65280
    s_mov_b64 exec, s[66:67]
    v_and_b32 v1, s22, v54
    ds_write_b16_d16_hi v1, v54 offset:65280
    s_mov_b64 exec, -1
    ds_read_b64 v[28:29], v2 offset:7296
    v_cvt_pk_bf16_f32 v38, v30, v31
    v_cvt_pk_bf16_f32 v39, v32, v33
    v_cvt_pk_bf16_f32 v40, v34, v35
    v_cvt_pk_bf16_f32 v41, v36, v37
    ds_read_b128 v[30:33], v5
    ds_read_b128 v[34:37], v5 offset:1024
    s_waitcnt lgkmcnt(0)
    v_mfma_f32_16x16x32_bf16 v[200:203], v[38:41], v[30:33], v[200:203]
    v_mfma_f32_16x16x32_bf16 v[204:207], v[38:41], v[34:37], v[204:207]
    v_lshrrev_b32 v0, 7, v28
    v_and_or_b32 v0, v0, s18, v3
    v_cmpx_eq_u32_sdwa s[64:65], s16, v28 src0_sel:DWORD src1_sel:BYTE_0
    v_bfe_u32 v1, v28, 8, 4
    v_lshl_add_u32 v53, v1, 4, v4
    v_lshrrev_b32_sdwa v53, v3, v29 dst_sel:WORD_1 dst_unused:UNUSED_PRESERVE src0_sel:DWORD src1_sel:DWORD
    s_waitcnt vmcnt(2)
    v_mfma_f32_16x16x32_bf16 v[30:33], v[20:23], v[8:11], 0
    v_mfma_f32_16x16x32_bf16 v[34:37], v[20:23], v[12:15], 0
    buffer_load_dwordx4 v[20:23], v0, s[4:7], 0 offen
    s_mov_b64 exec, s[66:67]
    v_and_b32 v0, s22, v54
    ds_write_b16_d16_hi v0, v3 offset:65280
    s_mov_b64 exec, s[68:69]
    v_and_b32 v1, s22, v55
    ds_write_b16_d16_hi v1, v55 offset:65280
    s_mov_b64 exec, -1
    ds_read_b64 v[28:29], v2 offset:7552
    v_cvt_pk_bf16_f32 v38, v30, v31
    v_cvt_pk_bf16_f32 v39, v32, v33
    v_cvt_pk_bf16_f32 v40, v34, v35
    v_cvt_pk_bf16_f32 v41, v36, v37
    ds_read_b128 v[30:33], v5
    ds_read_b128 v[34:37], v5 offset:1024
    s_waitcnt lgkmcnt(0)
    v_mfma_f32_16x16x32_bf16 v[208:211], v[38:41], v[30:33], v[208:211]
    v_mfma_f32_16x16x32_bf16 v[212:215], v[38:41], v[34:37], v[212:215]
    v_lshrrev_b32 v0, 7, v28
    v_and_or_b32 v0, v0, s18, v3
    v_cmpx_eq_u32_sdwa s[66:67], s16, v28 src0_sel:DWORD src1_sel:BYTE_0
    v_bfe_u32 v1, v28, 8, 4
    v_lshl_add_u32 v54, v1, 4, v4
    v_lshrrev_b32_sdwa v54, v3, v29 dst_sel:WORD_1 dst_unused:UNUSED_PRESERVE src0_sel:DWORD src1_sel:DWORD
    s_waitcnt vmcnt(2)
    v_mfma_f32_16x16x32_bf16 v[30:33], v[24:27], v[8:11], 0
    v_mfma_f32_16x16x32_bf16 v[34:37], v[24:27], v[12:15], 0
    buffer_load_dwordx4 v[24:27], v0, s[4:7], 0 offen
    s_mov_b64 exec, s[68:69]
    v_and_b32 v0, s22, v55
    ds_write_b16_d16_hi v0, v3 offset:65280
    s_mov_b64 exec, s[60:61]
    v_and_b32 v1, s22, v7
    ds_write_b16_d16_hi v1, v7 offset:65280
    s_mov_b64 exec, -1
    ds_read_b64 v[28:29], v2 offset:7808
    v_cvt_pk_bf16_f32 v38, v30, v31
    v_cvt_pk_bf16_f32 v39, v32, v33
    v_cvt_pk_bf16_f32 v40, v34, v35
    v_cvt_pk_bf16_f32 v41, v36, v37
    ds_read_b128 v[30:33], v5
    ds_read_b128 v[34:37], v5 offset:1024
    v_mov_b32 v42, 0
    v_mov_b32 v43, 0
    v_mov_b32 v44, 0
    v_mov_b32 v45, 0
    s_add_u32 s36, s34, 1
    s_and_b32 s36, s36, 126
    s_cbranch_scc0 B_cl87
B_clb87:
    s_mov_b64 exec, 1
    v_mov_b32 v0, 0
    v_mov_b32 v1, 1
    ds_add_u32 v0, v1 offset:1608
    s_mov_b64 exec, -1
    s_waitcnt lgkmcnt(1)
    v_mfma_f32_16x16x32_bf16 v[216:219], v[38:41], v[30:33], v[216:219]
    v_mfma_f32_16x16x32_bf16 v[220:223], v[38:41], v[34:37], v[220:223]
    v_lshrrev_b32 v0, 7, v28
    v_and_or_b32 v0, v0, s18, v3
    v_cmpx_eq_u32_sdwa s[68:69], s17, v28 src0_sel:DWORD src1_sel:BYTE_0
    v_bfe_u32 v1, v28, 8, 4
    v_lshl_add_u32 v55, v1, 4, v4
    v_lshrrev_b32_sdwa v55, v3, v29 dst_sel:WORD_1 dst_unused:UNUSED_PRESERVE src0_sel:DWORD src1_sel:DWORD
    s_waitcnt vmcnt(2)
    v_mfma_f32_16x16x32_bf16 v[30:33], v[16:19], v[8:11], 0
    v_mfma_f32_16x16x32_bf16 v[34:37], v[16:19], v[12:15], 0
    buffer_load_dwordx4 v[42:45], v0, s[4:7], 0 offen
    s_mov_b64 exec, s[60:61]
    v_and_b32 v0, s22, v7
    ds_write_b16_d16_hi v0, v3 offset:65280
    s_mov_b64 exec, s[62:63]
    v_and_b32 v1, s22, v52
    ds_write_b16_d16_hi v1, v52 offset:65280
    s_mov_b64 exec, -1
    v_cvt_pk_bf16_f32 v38, v30, v31
    v_cvt_pk_bf16_f32 v39, v32, v33
    v_cvt_pk_bf16_f32 v40, v34, v35
    v_cvt_pk_bf16_f32 v41, v36, v37
    ds_read_b128 v[30:33], v5
    ds_read_b128 v[34:37], v5 offset:1024
    v_mov_b32 v0, 0
    ds_read_b32 v50, v0 offset:1604
    s_add_u32 s34, s34, 1
    s_add_u32 s72, s72, 8
    s_mov_b32 s16, s21
    s_add_u32 s21, s21, 1
    s_and_b32 s21, s21, 255
    s_or_b32 s17, s16, s50
    s_waitcnt lgkmcnt(0)
    v_readfirstlane_b32 s36, v50
    s_cmp_lt_u32 s36, s72
    s_cbranch_scc1 B_sy89
B_syb89:
    v_subrev_u32 v2, s29, v2
    s_cmp_lg_u32 s29, 0
    s_cbranch_scc1 B_loop0
    s_branch B_loop1
B_epi:
    s_setprio 0
    s_load_dwordx2 s[72:73], s[0:1], 88
    s_lshl_b32 s36, s100, 5
    s_lshl_b32 s43, s101, 5
    v_mbcnt_lo_u32_b32 v2, -1, 0
    v_mbcnt_hi_u32_b32 v2, -1, v2
    s_lshl_b32 s38, s51, 9
    s_lshl_b32 s39, s51, 8
    s_add_u32 s40, s39, 51840
    s_add_u32 s39, s39, 1664
    s_mul_i32 s41, s3, 3328
    s_add_u32 s41, s41, 118400
    v_lshlrev_b32 v6, 4, v2
    s_add_u32 s12, s54, s36
    s_addc_u32 s13, s55, 0
    s_mov_b32 s14, s43
    s_mov_b32 s15, 0x20000
    s_waitcnt lgkmcnt(0)
    s_add_u32 m0, s39, 0
    s_add_u32 s42, s38, 0
    buffer_load_dwordx4 v6, s[12:15], s42 offen lds
    s_add_u32 m0, s39, 1024
    s_add_u32 s42, s38, 1024
    buffer_load_dwordx4 v6, s[12:15], s42 offen lds
    v_mfma_f32_16x16x32_bf16 v[224:227], v[38:41], v[30:33], v[224:227]
    v_mfma_f32_16x16x32_bf16 v[228:231], v[38:41], v[34:37], v[228:231]
    s_waitcnt vmcnt(4)
    v_mfma_f32_16x16x32_bf16 v[30:33], v[20:23], v[8:11], 0
    v_mfma_f32_16x16x32_bf16 v[34:37], v[20:23], v[12:15], 0
    s_mov_b64 exec, s[62:63]
    v_and_b32 v0, s22, v52
    ds_write_b16_d16_hi v0, v3 offset:65280
    s_mov_b64 exec, s[64:65]
    v_and_b32 v1, s22, v53
    ds_write_b16_d16_hi v1, v53 offset:65280
    s_mov_b64 exec, -1
    v_cvt_pk_bf16_f32 v38, v30, v31
    v_cvt_pk_bf16_f32 v39, v32, v33
    v_cvt_pk_bf16_f32 v40, v34, v35
    v_cvt_pk_bf16_f32 v41, v36, v37
    ds_read_b128 v[30:33], v5
    ds_read_b128 v[34:37], v5 offset:1024
    s_add_u32 m0, s39, 2048
    s_add_u32 s42, s38, 2048
    buffer_load_dwordx4 v6, s[12:15], s42 offen lds
    s_add_u32 m0, s39, 3072
    s_add_u32 s42, s38, 3072
    buffer_load_dwordx4 v6, s[12:15], s42 offen lds
    s_waitcnt lgkmcnt(0)
    v_mfma_f32_16x16x32_bf16 v[232:235], v[38:41], v[30:33], v[232:235]
    v_mfma_f32_16x16x32_bf16 v[236:239], v[38:41], v[34:37], v[236:239]
    s_waitcnt vmcnt(5)
    v_mfma_f32_16x16x32_bf16 v[30:33], v[24:27], v[8:11], 0
    v_mfma_f32_16x16x32_bf16 v[34:37], v[24:27], v[12:15], 0
    s_mov_b64 exec, s[64:65]
    v_and_b32 v0, s22, v53
    ds_write_b16_d16_hi v0, v3 offset:65280
    s_mov_b64 exec, s[66:67]
    v_and_b32 v1, s22, v54
    ds_write_b16_d16_hi v1, v54 offset:65280
    s_mov_b64 exec, -1
    v_cvt_pk_bf16_f32 v38, v30, v31
    v_cvt_pk_bf16_f32 v39, v32, v33
    v_cvt_pk_bf16_f32 v40, v34, v35
    v_cvt_pk_bf16_f32 v41, v36, v37
    ds_read_b128 v[30:33], v5
    ds_read_b128 v[34:37], v5 offset:1024
    s_add_u32 m0, s39, 4096
    s_add_u32 s42, s38, 4096
    buffer_load_dwordx4 v6, s[12:15], s42 offen lds
    s_add_u32 m0, s39, 5120
    s_add_u32 s42, s38, 5120
    buffer_load_dwordx4 v6, s[12:15], s42 offen lds
    s_waitcnt lgkmcnt(0)
    v_mfma_f32_16x16x32_bf16 v[240:243], v[38:41], v[30:33], v[240:243]
    v_mfma_f32_16x16x32_bf16 v[244:247], v[38:41], v[34:37], v[244:247]
    s_waitcnt vmcnt(6)
    v_mfma_f32_16x16x32_bf16 v[30:33], v[42:45], v[8:11], 0
    v_mfma_f32_16x16x32_bf16 v[34:37], v[42:45], v[12:15], 0
    s_mov_b64 exec, s[66:67]
    v_and_b32 v0, s22, v54
    ds_write_b16_d16_hi v0, v3 offset:65280
    s_mov_b64 exec, s[68:69]
    v_and_b32 v1, s22, v55
    ds_write_b16_d16_hi v1, v55 offset:65280
    s_mov_b64 exec, -1
    v_cvt_pk_bf16_f32 v38, v30, v31
    v_cvt_pk_bf16_f32 v39, v32, v33
    v_cvt_pk_bf16_f32 v40, v34, v35
    v_cvt_pk_bf16_f32 v41, v36, v37
    ds_read_b128 v[30:33], v5
    ds_read_b128 v[34:37], v5 offset:1024
    s_add_u32 m0, s40, 0
    s_add_u32 s42, s38, 6144
    buffer_load_dwordx4 v6, s[12:15], s42 offen lds
    s_add_u32 m0, s40, 1024
    s_add_u32 s42, s38, 7168
    buffer_load_dwordx4 v6, s[12:15], s42 offen lds
    s_waitcnt lgkmcnt(0)
    v_mfma_f32_16x16x32_bf16 v[248:251], v[38:41], v[30:33], v[248:251]
    v_mfma_f32_16x16x32_bf16 v[252:255], v[38:41], v[34:37], v[252:255]
    s_add_u32 s8, s72, s36
    s_addc_u32 s9, s73, 0
    s_mov_b32 s10, s43
    s_mov_b32 s11, 0x20000
    v_lshrrev_b32 v3, 4, v2
    v_and_b32 v2, 15, v2
    v_add_u32 v5, 161408, v6
    ds_read_b128 v[44:47], v5
    ds_read_b128 v[48:51], v5 offset:1024
    s_lshl_b32 s37, s3, 10
    s_add_u32 s37, s37, 153216
    v_lshl_add_u32 v5, v2, 1, s37
    v_lshlrev_b32 v4, 5, v2
    v_lshl_add_u32 v4, v3, 3, v4
    v_add_u32 v2, s39, v4
    v_add_u32 v3, s40, v4
    v_add_u32 v4, s41, v4
    s_mov_b32 s43, 0xffff0000
    s_mov_b32 s44, 0x40731710
    s_mov_b32 s45, 0x40731710
    v_mov_b32 v17, 0
    v_mov_b32 v19, 0
    v_mov_b32 v11, 0
    v_mov_b32 v13, 0
    v_mov_b32 v15, 0
    ds_read_u16 v24, v5 offset:0
    ds_read_u16 v25, v5 offset:32
    ds_read_u16 v26, v5 offset:64
    ds_read_u16 v27, v5 offset:96
    s_waitcnt lgkmcnt(4)
    v_mov_b32 v8, v44
    v_mov_b32 v9, v45
    v_mov_b32 v10, v46
    v_mov_b32 v12, v47
    v_mov_b32 v14, v48
    v_mov_b32 v0, v50
    v_mov_b32 v1, v51
    s_waitcnt lgkmcnt(2)
    v_lshlrev_b32 v24, 16, v24
    v_lshlrev_b32 v25, 16, v25
    v_pk_fma_f32 v[20:21], v[24:25], s[44:45], v[0:1] op_sel:[0,0,0] op_sel_hi:[0,0,1]
    v_pk_fma_f32 v[22:23], v[24:25], s[44:45], v[0:1] op_sel:[1,0,0] op_sel_hi:[1,0,1]
    ds_read_u16 v24, v5 offset:128
    ds_read_u16 v25, v5 offset:160
    v_pk_mul_f32 v[20:21], v[20:21], v[20:21] neg_lo:[0,1] neg_hi:[0,1]
    v_pk_mul_f32 v[22:23], v[22:23], v[22:23] neg_lo:[0,1] neg_hi:[0,1]
    v_exp_f32 v20, v20
    v_exp_f32 v21, v21
    v_exp_f32 v22, v22
    v_exp_f32 v23, v23
    s_add_u32 m0, s40, 2048
    s_add_u32 s42, s38, 8192
    buffer_load_dwordx4 v6, s[12:15], s42 offen lds
    v_cvt_pk_bf16_f32 v16, v20, v21
    v_cvt_pk_bf16_f32 v18, v22, v23
    s_nop 0
    v_mfma_f32_16x16x16_bf16 v[32:35], v[10:11], v[16:17], 0
    v_mfma_f32_16x16x16_bf16 v[36:39], v[12:13], v[16:17], 0
    v_mfma_f32_16x16x16_bf16 v[40:43], v[10:11], v[18:19], 0
    v_mfma_f32_16x16x16_bf16 v[44:47], v[12:13], v[18:19], 0
    s_waitcnt vmcnt(8)
    ds_read_b64 v[28:29], v2 offset:0
    ds_read_b64 v[30:31], v2 offset:512
    s_nop 1
    v_pk_mul_f32 v[56:57], v[56:57], v[32:33]
    s_nop 0
    v_pk_mul_f32 v[64:65], v[64:65], v[40:41]
    v_pk_mul_f32 v[58:59], v[58:59], v[34:35]
    v_pk_mul_f32 v[66:67], v[66:67], v[42:43]
    v_pk_fma_f32 v[56:57], v[60:61], v[36:37], v[56:57]
    v_pk_fma_f32 v[64:65], v[68:69], v[44:45], v[64:65]
    v_pk_fma_f32 v[58:59], v[62:63], v[38:39], v[58:59]
    v_pk_fma_f32 v[66:67], v[70:71], v[46:47], v[66:67]
    v_cvt_pk_bf16_f32 v56, v56, v57
    v_cvt_pk_bf16_f32 v64, v64, v65
    v_cvt_pk_bf16_f32 v57, v58, v59
    v_cvt_pk_bf16_f32 v65, v66, v67
    v_mfma_f32_16x16x16_bf16 v[48:51], v[14:15], v[16:17], 0
    v_mfma_f32_16x16x16_bf16 v[52:55], v[14:15], v[18:19], 0
    v_mfma_f32_16x16x16_bf16 v[60:63], v[8:9], v[56:57], 0
    v_mfma_f32_16x16x16_bf16 v[68:71], v[8:9], v[64:65], 0
    s_waitcnt lgkmcnt(4)
    v_lshlrev_b32 v26, 16, v26
    v_lshlrev_b32 v27, 16, v27
    v_pk_fma_f32 v[20:21], v[26:27], s[44:45], v[0:1] op_sel:[0,0,0] op_sel_hi:[0,0,1]
    v_pk_fma_f32 v[22:23], v[26:27], s[44:45], v[0:1] op_sel:[1,0,0] op_sel_hi:[1,0,1]
    ds_read_u16 v26, v5 offset:192
    ds_read_u16 v27, v5 offset:224
    v_pk_mul_f32 v[20:21], v[20:21], v[20:21] neg_lo:[0,1] neg_hi:[0,1]
    v_pk_mul_f32 v[22:23], v[22:23], v[22:23] neg_lo:[0,1] neg_hi:[0,1]
    v_exp_f32 v20, v20
    v_exp_f32 v21, v21
    v_exp_f32 v22, v22
    v_exp_f32 v23, v23
    s_add_u32 m0, s40, 3072
    s_add_u32 s42, s38, 9216
    buffer_load_dwordx4 v6, s[12:15], s42 offen lds
    v_cvt_pk_bf16_f32 v16, v20, v21
    v_cvt_pk_bf16_f32 v18, v22, v23
    s_nop 0
    v_mfma_f32_16x16x16_bf16 v[32:35], v[10:11], v[16:17], 0
    v_mfma_f32_16x16x16_bf16 v[36:39], v[12:13], v[16:17], 0
    v_mfma_f32_16x16x16_bf16 v[40:43], v[10:11], v[18:19], 0
    v_mfma_f32_16x16x16_bf16 v[44:47], v[12:13], v[18:19], 0
    s_waitcnt lgkmcnt(2)
    v_lshlrev_b32 v56, 16, v28
    v_and_b32 v57, s43, v28
    v_lshlrev_b32 v64, 16, v30
    v_and_b32 v65, s43, v30
    v_lshlrev_b32 v58, 16, v29
    v_and_b32 v59, s43, v29
    v_lshlrev_b32 v66, 16, v31
    v_and_b32 v67, s43, v31
    v_pk_fma_f32 v[56:57], v[60:61], v[48:49], v[56:57]
    v_pk_fma_f32 v[64:65], v[68:69], v[52:53], v[64:65]
    v_pk_fma_f32 v[58:59], v[62:63], v[50:51], v[58:59]
    v_pk_fma_f32 v[66:67], v[70:71], v[54:55], v[66:67]
    v_cvt_pk_bf16_f32 v56, v56, v57
    v_cvt_pk_bf16_f32 v64, v64, v65
    v_cvt_pk_bf16_f32 v57, v58, v59
    v_cvt_pk_bf16_f32 v65, v66, v67
    s_add_u32 s42, s39, 0
    v_add_u32 v7, s42, v6
    ds_write_b64 v2, v[56:57] offset:0
    ds_write_b64 v2, v[64:65] offset:512
    ds_read_b128 v[64:67], v7
    s_waitcnt vmcnt(8)
    ds_read_b64 v[28:29], v2 offset:1024
    ds_read_b64 v[30:31], v2 offset:1536
    v_pk_mul_f32 v[72:73], v[72:73], v[32:33]
    v_pk_mul_f32 v[80:81], v[80:81], v[40:41]
    v_pk_mul_f32 v[74:75], v[74:75], v[34:35]
    v_pk_mul_f32 v[82:83], v[82:83], v[42:43]
    v_pk_fma_f32 v[72:73], v[76:77], v[36:37], v[72:73]
    v_pk_fma_f32 v[80:81], v[84:85], v[44:45], v[80:81]
    v_pk_fma_f32 v[74:75], v[78:79], v[38:39], v[74:75]
    v_pk_fma_f32 v[82:83], v[86:87], v[46:47], v[82:83]
    v_cvt_pk_bf16_f32 v72, v72, v73
    v_cvt_pk_bf16_f32 v80, v80, v81
    v_cvt_pk_bf16_f32 v73, v74, v75
    v_cvt_pk_bf16_f32 v81, v82, v83
    v_mfma_f32_16x16x16_bf16 v[48:51], v[14:15], v[16:17], 0
    v_mfma_f32_16x16x16_bf16 v[52:55], v[14:15], v[18:19], 0
    v_mfma_f32_16x16x16_bf16 v[76:79], v[8:9], v[72:73], 0
    v_mfma_f32_16x16x16_bf16 v[84:87], v[8:9], v[80:81], 0
    s_waitcnt lgkmcnt(9)
    v_lshlrev_b32 v24, 16, v24
    v_lshlrev_b32 v25, 16, v25
    v_pk_fma_f32 v[20:21], v[24:25], s[44:45], v[0:1] op_sel:[0,0,0] op_sel_hi:[0,0,1]
    v_pk_fma_f32 v[22:23], v[24:25], s[44:45], v[0:1] op_sel:[1,0,0] op_sel_hi:[1,0,1]
    ds_read_u16 v24, v5 offset:256
    ds_read_u16 v25, v5 offset:288
    v_pk_mul_f32 v[20:21], v[20:21], v[20:21] neg_lo:[0,1] neg_hi:[0,1]
    v_pk_mul_f32 v[22:23], v[22:23], v[22:23] neg_lo:[0,1] neg_hi:[0,1]
    v_exp_f32 v20, v20
    v_exp_f32 v21, v21
    v_exp_f32 v22, v22
    v_exp_f32 v23, v23
    s_add_u32 m0, s40, 4096
    s_add_u32 s42, s38, 10240
    buffer_load_dwordx4 v6, s[12:15], s42 offen lds
    v_cvt_pk_bf16_f32 v16, v20, v21
    v_cvt_pk_bf16_f32 v18, v22, v23
    s_nop 0
    v_mfma_f32_16x16x16_bf16 v[32:35], v[10:11], v[16:17], 0
    v_mfma_f32_16x16x16_bf16 v[36:39], v[12:13], v[16:17], 0
    v_mfma_f32_16x16x16_bf16 v[40:43], v[10:11], v[18:19], 0
    v_mfma_f32_16x16x16_bf16 v[44:47], v[12:13], v[18:19], 0
    s_add_u32 s42, s38, 0
    s_waitcnt lgkmcnt(4)
    buffer_store_dwordx4 v[64:67], v6, s[8:11], s42 offen nt
    s_waitcnt lgkmcnt(2)
    v_lshlrev_b32 v72, 16, v28
    v_and_b32 v73, s43, v28
    v_lshlrev_b32 v80, 16, v30
    v_and_b32 v81, s43, v30
    v_lshlrev_b32 v74, 16, v29
    v_and_b32 v75, s43, v29
    v_lshlrev_b32 v82, 16, v31
    v_and_b32 v83, s43, v31
    v_pk_fma_f32 v[72:73], v[76:77], v[48:49], v[72:73]
    v_pk_fma_f32 v[80:81], v[84:85], v[52:53], v[80:81]
    v_pk_fma_f32 v[74:75], v[78:79], v[50:51], v[74:75]
    v_pk_fma_f32 v[82:83], v[86:87], v[54:55], v[82:83]
    v_cvt_pk_bf16_f32 v72, v72, v73
    v_cvt_pk_bf16_f32 v80, v80, v81
    v_cvt_pk_bf16_f32 v73, v74, v75
    v_cvt_pk_bf16_f32 v81, v82, v83
    s_add_u32 s42, s39, 1024
    v_add_u32 v7, s42, v6
    ds_write_b64 v2, v[72:73] offset:1024
    ds_write_b64 v2, v[80:81] offset:1536
    ds_read_b128 v[80:83], v7
    s_waitcnt vmcnt(9)
    ds_read_b64 v[28:29], v2 offset:2048
    ds_read_b64 v[30:31], v2 offset:2560
    v_pk_mul_f32 v[88:89], v[88:89], v[32:33]
    v_pk_mul_f32 v[96:97], v[96:97], v[40:41]
    v_pk_mul_f32 v[90:91], v[90:91], v[34:35]
    v_pk_mul_f32 v[98:99], v[98:99], v[42:43]
    v_pk_fma_f32 v[88:89], v[92:93], v[36:37], v[88:89]
    v_pk_fma_f32 v[96:97], v[100:101], v[44:45], v[96:97]
    v_pk_fma_f32 v[90:91], v[94:95], v[38:39], v[90:91]
    v_pk_fma_f32 v[98:99], v[102:103], v[46:47], v[98:99]
    v_cvt_pk_bf16_f32 v88, v88, v89
    v_cvt_pk_bf16_f32 v96, v96, v97
    v_cvt_pk_bf16_f32 v89, v90, v91
    v_cvt_pk_bf16_f32 v97, v98, v99
    v_mfma_f32_16x16x16_bf16 v[48:51], v[14:15], v[16:17], 0
    v_mfma_f32_16x16x16_bf16 v[52:55], v[14:15], v[18:19], 0
    v_mfma_f32_16x16x16_bf16 v[92:95], v[8:9], v[88:89], 0
    v_mfma_f32_16x16x16_bf16 v[100:103], v[8:9], v[96:97], 0
    s_waitcnt lgkmcnt(12)
    v_lshlrev_b32 v26, 16, v26
    v_lshlrev_b32 v27, 16, v27
    v_pk_fma_f32 v[20:21], v[26:27], s[44:45], v[0:1] op_sel:[0,0,0] op_sel_hi:[0,0,1]
    v_pk_fma_f32 v[22:23], v[26:27], s[44:45], v[0:1] op_sel:[1,0,0] op_sel_hi:[1,0,1]
    ds_read_u16 v26, v5 offset:320
    ds_read_u16 v27, v5 offset:352
    v_pk_mul_f32 v[20:21], v[20:21], v[20:21] neg_lo:[0,1] neg_hi:[0,1]
    v_pk_mul_f32 v[22:23], v[22:23], v[22:23] neg_lo:[0,1] neg_hi:[0,1]
    v_exp_f32 v20, v20
    v_exp_f32 v21, v21
    v_exp_f32 v22, v22
    v_exp_f32 v23, v23
    s_add_u32 m0, s40, 5120
    s_add_u32 s42, s38, 11264
    buffer_load_dwordx4 v6, s[12:15], s42 offen lds
    v_cvt_pk_bf16_f32 v16, v20, v21
    v_cvt_pk_bf16_f32 v18, v22, v23
    s_nop 0
    v_mfma_f32_16x16x16_bf16 v[32:35], v[10:11], v[16:17], 0
    v_mfma_f32_16x16x16_bf16 v[36:39], v[12:13], v[16:17], 0
    v_mfma_f32_16x16x16_bf16 v[40:43], v[10:11], v[18:19], 0
    v_mfma_f32_16x16x16_bf16 v[44:47], v[12:13], v[18:19], 0
    s_add_u32 s42, s38, 1024
    s_waitcnt lgkmcnt(4)
    buffer_store_dwordx4 v[80:83], v6, s[8:11], s42 offen nt
    s_waitcnt lgkmcnt(2)
    v_lshlrev_b32 v88, 16, v28
    v_and_b32 v89, s43, v28
    v_lshlrev_b32 v96, 16, v30
    v_and_b32 v97, s43, v30
    v_lshlrev_b32 v90, 16, v29
    v_and_b32 v91, s43, v29
    v_lshlrev_b32 v98, 16, v31
    v_and_b32 v99, s43, v31
    v_pk_fma_f32 v[88:89], v[92:93], v[48:49], v[88:89]
    v_pk_fma_f32 v[96:97], v[100:101], v[52:53], v[96:97]
    v_pk_fma_f32 v[90:91], v[94:95], v[50:51], v[90:91]
    v_pk_fma_f32 v[98:99], v[102:103], v[54:55], v[98:99]
    v_cvt_pk_bf16_f32 v88, v88, v89
    v_cvt_pk_bf16_f32 v96, v96, v97
    v_cvt_pk_bf16_f32 v89, v90, v91
    v_cvt_pk_bf16_f32 v97, v98, v99
    s_add_u32 s42, s39, 2048
    v_add_u32 v7, s42, v6
    ds_write_b64 v2, v[88:89] offset:2048
    ds_write_b64 v2, v[96:97] offset:2560
    ds_read_b128 v[96:99], v7
    s_waitcnt vmcnt(10)
    ds_read_b64 v[28:29], v2 offset:3072
    ds_read_b64 v[30:31], v2 offset:3584
    v_pk_mul_f32 v[104:105], v[104:105], v[32:33]
    v_pk_mul_f32 v[112:113], v[112:113], v[40:41]
    v_pk_mul_f32 v[106:107], v[106:107], v[34:35]
    v_pk_mul_f32 v[114:115], v[114:115], v[42:43]
    v_pk_fma_f32 v[104:105], v[108:109], v[36:37], v[104:105]
    v_pk_fma_f32 v[112:113], v[116:117], v[44:45], v[112:113]
    v_pk_fma_f32 v[106:107], v[110:111], v[38:39], v[106:107]
    v_pk_fma_f32 v[114:115], v[118:119], v[46:47], v[114:115]
    v_cvt_pk_bf16_f32 v104, v104, v105
    v_cvt_pk_bf16_f32 v112, v112, v113
    v_cvt_pk_bf16_f32 v105, v106, v107
    v_cvt_pk_bf16_f32 v113, v114, v115
    v_mfma_f32_16x16x16_bf16 v[48:51], v[14:15], v[16:17], 0
    v_mfma_f32_16x16x16_bf16 v[52:55], v[14:15], v[18:19], 0
    v_mfma_f32_16x16x16_bf16 v[108:111], v[8:9], v[104:105], 0
    v_mfma_f32_16x16x16_bf16 v[116:119], v[8:9], v[112:113], 0
    s_waitcnt lgkmcnt(12)
    v_lshlrev_b32 v24, 16, v24
    v_lshlrev_b32 v25, 16, v25
    v_pk_fma_f32 v[20:21], v[24:25], s[44:45], v[0:1] op_sel:[0,0,0] op_sel_hi:[0,0,1]
    v_pk_fma_f32 v[22:23], v[24:25], s[44:45], v[0:1] op_sel:[1,0,0] op_sel_hi:[1,0,1]
    ds_read_u16 v24, v5 offset:384
    ds_read_u16 v25, v5 offset:416
    v_pk_mul_f32 v[20:21], v[20:21], v[20:21] neg_lo:[0,1] neg_hi:[0,1]
    v_pk_mul_f32 v[22:23], v[22:23], v[22:23] neg_lo:[0,1] neg_hi:[0,1]
    v_exp_f32 v20, v20
    v_exp_f32 v21, v21
    v_exp_f32 v22, v22
    v_exp_f32 v23, v23
    s_add_u32 m0, s41, 0
    s_add_u32 s42, s38, 12288
    buffer_load_dwordx4 v6, s[12:15], s42 offen lds
    v_cvt_pk_bf16_f32 v16, v20, v21
    v_cvt_pk_bf16_f32 v18, v22, v23
    s_nop 0
    v_mfma_f32_16x16x16_bf16 v[32:35], v[10:11], v[16:17], 0
    v_mfma_f32_16x16x16_bf16 v[36:39], v[12:13], v[16:17], 0
    v_mfma_f32_16x16x16_bf16 v[40:43], v[10:11], v[18:19], 0
    v_mfma_f32_16x16x16_bf16 v[44:47], v[12:13], v[18:19], 0
    s_add_u32 s42, s38, 2048
    s_waitcnt lgkmcnt(4)
    buffer_store_dwordx4 v[96:99], v6, s[8:11], s42 offen nt
    s_waitcnt lgkmcnt(2)
    v_lshlrev_b32 v104, 16, v28
    v_and_b32 v105, s43, v28
    v_lshlrev_b32 v112, 16, v30
    v_and_b32 v113, s43, v30
    v_lshlrev_b32 v106, 16, v29
    v_and_b32 v107, s43, v29
    v_lshlrev_b32 v114, 16, v31
    v_and_b32 v115, s43, v31
    v_pk_fma_f32 v[104:105], v[108:109], v[48:49], v[104:105]
    v_pk_fma_f32 v[112:113], v[116:117], v[52:53], v[112:113]
    v_pk_fma_f32 v[106:107], v[110:111], v[50:51], v[106:107]
    v_pk_fma_f32 v[114:115], v[118:119], v[54:55], v[114:115]
    v_cvt_pk_bf16_f32 v104, v104, v105
    v_cvt_pk_bf16_f32 v112, v112, v113
    v_cvt_pk_bf16_f32 v105, v106, v107
    v_cvt_pk_bf16_f32 v113, v114, v115
    s_add_u32 s42, s39, 3072
    v_add_u32 v7, s42, v6
    ds_write_b64 v2, v[104:105] offset:3072
    ds_write_b64 v2, v[112:113] offset:3584
    ds_read_b128 v[112:115], v7
    s_waitcnt vmcnt(11)
    ds_read_b64 v[28:29], v2 offset:4096
    ds_read_b64 v[30:31], v2 offset:4608
    v_pk_mul_f32 v[120:121], v[120:121], v[32:33]
    v_pk_mul_f32 v[128:129], v[128:129], v[40:41]
    v_pk_mul_f32 v[122:123], v[122:123], v[34:35]
    v_pk_mul_f32 v[130:131], v[130:131], v[42:43]
    v_pk_fma_f32 v[120:121], v[124:125], v[36:37], v[120:121]
    v_pk_fma_f32 v[128:129], v[132:133], v[44:45], v[128:129]
    v_pk_fma_f32 v[122:123], v[126:127], v[38:39], v[122:123]
    v_pk_fma_f32 v[130:131], v[134:135], v[46:47], v[130:131]
    v_cvt_pk_bf16_f32 v120, v120, v121
    v_cvt_pk_bf16_f32 v128, v128, v129
    v_cvt_pk_bf16_f32 v121, v122, v123
    v_cvt_pk_bf16_f32 v129, v130, v131
    v_mfma_f32_16x16x16_bf16 v[48:51], v[14:15], v[16:17], 0
    v_mfma_f32_16x16x16_bf16 v[52:55], v[14:15], v[18:19], 0
    v_mfma_f32_16x16x16_bf16 v[124:127], v[8:9], v[120:121], 0
    v_mfma_f32_16x16x16_bf16 v[132:135], v[8:9], v[128:129], 0
    s_waitcnt lgkmcnt(12)
    v_lshlrev_b32 v26, 16, v26
    v_lshlrev_b32 v27, 16, v27
    v_pk_fma_f32 v[20:21], v[26:27], s[44:45], v[0:1] op_sel:[0,0,0] op_sel_hi:[0,0,1]
    v_pk_fma_f32 v[22:23], v[26:27], s[44:45], v[0:1] op_sel:[1,0,0] op_sel_hi:[1,0,1]
    ds_read_u16 v26, v5 offset:448
    ds_read_u16 v27, v5 offset:480
    v_pk_mul_f32 v[20:21], v[20:21], v[20:21] neg_lo:[0,1] neg_hi:[0,1]
    v_pk_mul_f32 v[22:23], v[22:23], v[22:23] neg_lo:[0,1] neg_hi:[0,1]
    v_exp_f32 v20, v20
    v_exp_f32 v21, v21
    v_exp_f32 v22, v22
    v_exp_f32 v23, v23
    v_cvt_pk_bf16_f32 v16, v20, v21
    v_cvt_pk_bf16_f32 v18, v22, v23
    s_nop 0
    v_mfma_f32_16x16x16_bf16 v[32:35], v[10:11], v[16:17], 0
    v_mfma_f32_16x16x16_bf16 v[36:39], v[12:13], v[16:17], 0
    v_mfma_f32_16x16x16_bf16 v[40:43], v[10:11], v[18:19], 0
    v_mfma_f32_16x16x16_bf16 v[44:47], v[12:13], v[18:19], 0
    s_add_u32 s42, s38, 3072
    s_waitcnt lgkmcnt(4)
    buffer_store_dwordx4 v[112:115], v6, s[8:11], s42 offen nt
    s_waitcnt lgkmcnt(2)
    v_lshlrev_b32 v120, 16, v28
    v_and_b32 v121, s43, v28
    v_lshlrev_b32 v128, 16, v30
    v_and_b32 v129, s43, v30
    v_lshlrev_b32 v122, 16, v29
    v_and_b32 v123, s43, v29
    v_lshlrev_b32 v130, 16, v31
    v_and_b32 v131, s43, v31
    v_pk_fma_f32 v[120:121], v[124:125], v[48:49], v[120:121]
    v_pk_fma_f32 v[128:129], v[132:133], v[52:53], v[128:129]
    v_pk_fma_f32 v[122:123], v[126:127], v[50:51], v[122:123]
    v_pk_fma_f32 v[130:131], v[134:135], v[54:55], v[130:131]
    v_cvt_pk_bf16_f32 v120, v120, v121
    v_cvt_pk_bf16_f32 v128, v128, v129
    v_cvt_pk_bf16_f32 v121, v122, v123
    v_cvt_pk_bf16_f32 v129, v130, v131
    s_add_u32 s42, s39, 4096
    v_add_u32 v7, s42, v6
    ds_write_b64 v2, v[120:121] offset:4096
    ds_write_b64 v2, v[128:129] offset:4608
    ds_read_b128 v[128:131], v7
    s_waitcnt vmcnt(11)
    ds_read_b64 v[28:29], v2 offset:5120
    ds_read_b64 v[30:31], v2 offset:5632
    v_pk_mul_f32 v[136:137], v[136:137], v[32:33]
    v_pk_mul_f32 v[144:145], v[144:145], v[40:41]
    v_pk_mul_f32 v[138:139], v[138:139], v[34:35]
    v_pk_mul_f32 v[146:147], v[146:147], v[42:43]
    v_pk_fma_f32 v[136:137], v[140:141], v[36:37], v[136:137]
    v_pk_fma_f32 v[144:145], v[148:149], v[44:45], v[144:145]
    v_pk_fma_f32 v[138:139], v[142:143], v[38:39], v[138:139]
    v_pk_fma_f32 v[146:147], v[150:151], v[46:47], v[146:147]
    v_cvt_pk_bf16_f32 v136, v136, v137
    v_cvt_pk_bf16_f32 v144, v144, v145
    v_cvt_pk_bf16_f32 v137, v138, v139
    v_cvt_pk_bf16_f32 v145, v146, v147
    v_mfma_f32_16x16x16_bf16 v[48:51], v[14:15], v[16:17], 0
    v_mfma_f32_16x16x16_bf16 v[52:55], v[14:15], v[18:19], 0
    v_mfma_f32_16x16x16_bf16 v[140:143], v[8:9], v[136:137], 0
    v_mfma_f32_16x16x16_bf16 v[148:151], v[8:9], v[144:145], 0
    s_waitcnt lgkmcnt(12)
    v_lshlrev_b32 v24, 16, v24
    v_lshlrev_b32 v25, 16, v25
    v_pk_fma_f32 v[20:21], v[24:25], s[44:45], v[0:1] op_sel:[0,0,0] op_sel_hi:[0,0,1]
    v_pk_fma_f32 v[22:23], v[24:25], s[44:45], v[0:1] op_sel:[1,0,0] op_sel_hi:[1,0,1]
    ds_read_u16 v24, v5 offset:512
    ds_read_u16 v25, v5 offset:544
    v_pk_mul_f32 v[20:21], v[20:21], v[20:21] neg_lo:[0,1] neg_hi:[0,1]
    v_pk_mul_f32 v[22:23], v[22:23], v[22:23] neg_lo:[0,1] neg_hi:[0,1]
    v_exp_f32 v20, v20
    v_exp_f32 v21, v21
    v_exp_f32 v22, v22
    v_exp_f32 v23, v23
    v_cvt_pk_bf16_f32 v16, v20, v21
    v_cvt_pk_bf16_f32 v18, v22, v23
    s_nop 0
    v_mfma_f32_16x16x16_bf16 v[32:35], v[10:11], v[16:17], 0
    v_mfma_f32_16x16x16_bf16 v[36:39], v[12:13], v[16:17], 0
    v_mfma_f32_16x16x16_bf16 v[40:43], v[10:11], v[18:19], 0
    v_mfma_f32_16x16x16_bf16 v[44:47], v[12:13], v[18:19], 0
    s_add_u32 s42, s38, 4096
    s_waitcnt lgkmcnt(4)
    buffer_store_dwordx4 v[128:131], v6, s[8:11], s42 offen nt
    s_waitcnt lgkmcnt(2)
    v_lshlrev_b32 v136, 16, v28
    v_and_b32 v137, s43, v28
    v_lshlrev_b32 v144, 16, v30
    v_and_b32 v145, s43, v30
    v_lshlrev_b32 v138, 16, v29
    v_and_b32 v139, s43, v29
    v_lshlrev_b32 v146, 16, v31
    v_and_b32 v147, s43, v31
    v_pk_fma_f32 v[136:137], v[140:141], v[48:49], v[136:137]
    v_pk_fma_f32 v[144:145], v[148:149], v[52:53], v[144:145]
    v_pk_fma_f32 v[138:139], v[142:143], v[50:51], v[138:139]
    v_pk_fma_f32 v[146:147], v[150:151], v[54:55], v[146:147]
    v_cvt_pk_bf16_f32 v136, v136, v137
    v_cvt_pk_bf16_f32 v144, v144, v145
    v_cvt_pk_bf16_f32 v137, v138, v139
    v_cvt_pk_bf16_f32 v145, v146, v147
    s_add_u32 s42, s39, 5120
    v_add_u32 v7, s42, v6
    ds_write_b64 v2, v[136:137] offset:5120
    ds_write_b64 v2, v[144:145] offset:5632
    ds_read_b128 v[144:147], v7
    s_waitcnt vmcnt(11)
    ds_read_b64 v[28:29], v3 offset:0
    ds_read_b64 v[30:31], v3 offset:512
    v_pk_mul_f32 v[152:153], v[152:153], v[32:33]
    v_pk_mul_f32 v[160:161], v[160:161], v[40:41]
    v_pk_mul_f32 v[154:155], v[154:155], v[34:35]
    v_pk_mul_f32 v[162:163], v[162:163], v[42:43]
    v_pk_fma_f32 v[152:153], v[156:157], v[36:37], v[152:153]
    v_pk_fma_f32 v[160:161], v[164:165], v[44:45], v[160:161]
    v_pk_fma_f32 v[154:155], v[158:159], v[38:39], v[154:155]
    v_pk_fma_f32 v[162:163], v[166:167], v[46:47], v[162:163]
    v_cvt_pk_bf16_f32 v152, v152, v153
    v_cvt_pk_bf16_f32 v160, v160, v161
    v_cvt_pk_bf16_f32 v153, v154, v155
    v_cvt_pk_bf16_f32 v161, v162, v163
    v_mfma_f32_16x16x16_bf16 v[48:51], v[14:15], v[16:17], 0
    v_mfma_f32_16x16x16_bf16 v[52:55], v[14:15], v[18:19], 0
    v_mfma_f32_16x16x16_bf16 v[156:159], v[8:9], v[152:153], 0
    v_mfma_f32_16x16x16_bf16 v[164:167], v[8:9], v[160:161], 0
    s_waitcnt lgkmcnt(12)
    v_lshlrev_b32 v26, 16, v26
    v_lshlrev_b32 v27, 16, v27
    v_pk_fma_f32 v[20:21], v[26:27], s[44:45], v[0:1] op_sel:[0,0,0] op_sel_hi:[0,0,1]
    v_pk_fma_f32 v[22:23], v[26:27], s[44:45], v[0:1] op_sel:[1,0,0] op_sel_hi:[1,0,1]
    ds_read_u16 v26, v5 offset:576
    ds_read_u16 v27, v5 offset:608
    v_pk_mul_f32 v[20:21], v[20:21], v[20:21] neg_lo:[0,1] neg_hi:[0,1]
    v_pk_mul_f32 v[22:23], v[22:23], v[22:23] neg_lo:[0,1] neg_hi:[0,1]
    v_exp_f32 v20, v20
    v_exp_f32 v21, v21
    v_exp_f32 v22, v22
    v_exp_f32 v23, v23
    v_cvt_pk_bf16_f32 v16, v20, v21
    v_cvt_pk_bf16_f32 v18, v22, v23
    s_nop 0
    v_mfma_f32_16x16x16_bf16 v[32:35], v[10:11], v[16:17], 0
    v_mfma_f32_16x16x16_bf16 v[36:39], v[12:13], v[16:17], 0
    v_mfma_f32_16x16x16_bf16 v[40:43], v[10:11], v[18:19], 0
    v_mfma_f32_16x16x16_bf16 v[44:47], v[12:13], v[18:19], 0
    s_add_u32 s42, s38, 5120
    s_waitcnt lgkmcnt(4)
    buffer_store_dwordx4 v[144:147], v6, s[8:11], s42 offen nt
    s_waitcnt lgkmcnt(2)
    v_lshlrev_b32 v152, 16, v28
    v_and_b32 v153, s43, v28
    v_lshlrev_b32 v160, 16, v30
    v_and_b32 v161, s43, v30
    v_lshlrev_b32 v154, 16, v29
    v_and_b32 v155, s43, v29
    v_lshlrev_b32 v162, 16, v31
    v_and_b32 v163, s43, v31
    v_pk_fma_f32 v[152:153], v[156:157], v[48:49], v[152:153]
    v_pk_fma_f32 v[160:161], v[164:165], v[52:53], v[160:161]
    v_pk_fma_f32 v[154:155], v[158:159], v[50:51], v[154:155]
    v_pk_fma_f32 v[162:163], v[166:167], v[54:55], v[162:163]
    v_cvt_pk_bf16_f32 v152, v152, v153
    v_cvt_pk_bf16_f32 v160, v160, v161
    v_cvt_pk_bf16_f32 v153, v154, v155
    v_cvt_pk_bf16_f32 v161, v162, v163
    s_add_u32 s42, s40, 0
    v_add_u32 v7, s42, v6
    ds_write_b64 v3, v[152:153] offset:0
    ds_write_b64 v3, v[160:161] offset:512
    ds_read_b128 v[160:163], v7
    s_waitcnt vmcnt(11)
    ds_read_b64 v[28:29], v3 offset:1024
    ds_read_b64 v[30:31], v3 offset:1536
    v_pk_mul_f32 v[168:169], v[168:169], v[32:33]
    v_pk_mul_f32 v[176:177], v[176:177], v[40:41]
    v_pk_mul_f32 v[170:171], v[170:171], v[34:35]
    v_pk_mul_f32 v[178:179], v[178:179], v[42:43]
    v_pk_fma_f32 v[168:169], v[172:173], v[36:37], v[168:169]
    v_pk_fma_f32 v[176:177], v[180:181], v[44:45], v[176:177]
    v_pk_fma_f32 v[170:171], v[174:175], v[38:39], v[170:171]
    v_pk_fma_f32 v[178:179], v[182:183], v[46:47], v[178:179]
    v_cvt_pk_bf16_f32 v168, v168, v169
    v_cvt_pk_bf16_f32 v176, v176, v177
    v_cvt_pk_bf16_f32 v169, v170, v171
    v_cvt_pk_bf16_f32 v177, v178, v179
    v_mfma_f32_16x16x16_bf16 v[48:51], v[14:15], v[16:17], 0
    v_mfma_f32_16x16x16_bf16 v[52:55], v[14:15], v[18:19], 0
    v_mfma_f32_16x16x16_bf16 v[172:175], v[8:9], v[168:169], 0
    v_mfma_f32_16x16x16_bf16 v[180:183], v[8:9], v[176:177], 0
    s_waitcnt lgkmcnt(12)
    v_lshlrev_b32 v24, 16, v24
    v_lshlrev_b32 v25, 16, v25
    v_pk_fma_f32 v[20:21], v[24:25], s[44:45], v[0:1] op_sel:[0,0,0] op_sel_hi:[0,0,1]
    v_pk_fma_f32 v[22:23], v[24:25], s[44:45], v[0:1] op_sel:[1,0,0] op_sel_hi:[1,0,1]
    ds_read_u16 v24, v5 offset:640
    ds_read_u16 v25, v5 offset:672
    v_pk_mul_f32 v[20:21], v[20:21], v[20:21] neg_lo:[0,1] neg_hi:[0,1]
    v_pk_mul_f32 v[22:23], v[22:23], v[22:23] neg_lo:[0,1] neg_hi:[0,1]
    v_exp_f32 v20, v20
    v_exp_f32 v21, v21
    v_exp_f32 v22, v22
    v_exp_f32 v23, v23
    v_cvt_pk_bf16_f32 v16, v20, v21
    v_cvt_pk_bf16_f32 v18, v22, v23
    s_nop 0
    v_mfma_f32_16x16x16_bf16 v[32:35], v[10:11], v[16:17], 0
    v_mfma_f32_16x16x16_bf16 v[36:39], v[12:13], v[16:17], 0
    v_mfma_f32_16x16x16_bf16 v[40:43], v[10:11], v[18:19], 0
    v_mfma_f32_16x16x16_bf16 v[44:47], v[12:13], v[18:19], 0
    s_add_u32 s42, s38, 6144
    s_waitcnt lgkmcnt(4)
    buffer_store_dwordx4 v[160:163], v6, s[8:11], s42 offen nt
    s_waitcnt lgkmcnt(2)
    v_lshlrev_b32 v168, 16, v28
    v_and_b32 v169, s43, v28
    v_lshlrev_b32 v176, 16, v30
    v_and_b32 v177, s43, v30
    v_lshlrev_b32 v170, 16, v29
    v_and_b32 v171, s43, v29
    v_lshlrev_b32 v178, 16, v31
    v_and_b32 v179, s43, v31
    v_pk_fma_f32 v[168:169], v[172:173], v[48:49], v[168:169]
    v_pk_fma_f32 v[176:177], v[180:181], v[52:53], v[176:177]
    v_pk_fma_f32 v[170:171], v[174:175], v[50:51], v[170:171]
    v_pk_fma_f32 v[178:179], v[182:183], v[54:55], v[178:179]
    v_cvt_pk_bf16_f32 v168, v168, v169
    v_cvt_pk_bf16_f32 v176, v176, v177
    v_cvt_pk_bf16_f32 v169, v170, v171
    v_cvt_pk_bf16_f32 v177, v178, v179
    s_add_u32 s42, s40, 1024
    v_add_u32 v7, s42, v6
    ds_write_b64 v3, v[168:169] offset:1024
    ds_write_b64 v3, v[176:177] offset:1536
    ds_read_b128 v[176:179], v7
    s_waitcnt vmcnt(11)
    ds_read_b64 v[28:29], v3 offset:2048
    ds_read_b64 v[30:31], v3 offset:2560
    v_pk_mul_f32 v[184:185], v[184:185], v[32:33]
    v_pk_mul_f32 v[192:193], v[192:193], v[40:41]
    v_pk_mul_f32 v[186:187], v[186:187], v[34:35]
    v_pk_mul_f32 v[194:195], v[194:195], v[42:43]
    v_pk_fma_f32 v[184:185], v[188:189], v[36:37], v[184:185]
    v_pk_fma_f32 v[192:193], v[196:197], v[44:45], v[192:193]
    v_pk_fma_f32 v[186:187], v[190:191], v[38:39], v[186:187]
    v_pk_fma_f32 v[194:195], v[198:199], v[46:47], v[194:195]
    v_cvt_pk_bf16_f32 v184, v184, v185
    v_cvt_pk_bf16_f32 v192, v192, v193
    v_cvt_pk_bf16_f32 v185, v186, v187
    v_cvt_pk_bf16_f32 v193, v194, v195
    v_mfma_f32_16x16x16_bf16 v[48:51], v[14:15], v[16:17], 0
    v_mfma_f32_16x16x16_bf16 v[52:55], v[14:15], v[18:19], 0
    v_mfma_f32_16x16x16_bf16 v[188:191], v[8:9], v[184:185], 0
    v_mfma_f32_16x16x16_bf16 v[196:199], v[8:9], v[192:193], 0
    s_waitcnt lgkmcnt(12)
    v_lshlrev_b32 v26, 16, v26
    v_lshlrev_b32 v27, 16, v27
    v_pk_fma_f32 v[20:21], v[26:27], s[44:45], v[0:1] op_sel:[0,0,0] op_sel_hi:[0,0,1]
    v_pk_fma_f32 v[22:23], v[26:27], s[44:45], v[0:1] op_sel:[1,0,0] op_sel_hi:[1,0,1]
    ds_read_u16 v26, v5 offset:704
    ds_read_u16 v27, v5 offset:736
    v_pk_mul_f32 v[20:21], v[20:21], v[20:21] neg_lo:[0,1] neg_hi:[0,1]
    v_pk_mul_f32 v[22:23], v[22:23], v[22:23] neg_lo:[0,1] neg_hi:[0,1]
    v_exp_f32 v20, v20
    v_exp_f32 v21, v21
    v_exp_f32 v22, v22
    v_exp_f32 v23, v23
    v_cvt_pk_bf16_f32 v16, v20, v21
    v_cvt_pk_bf16_f32 v18, v22, v23
    s_nop 0
    v_mfma_f32_16x16x16_bf16 v[32:35], v[10:11], v[16:17], 0
    v_mfma_f32_16x16x16_bf16 v[36:39], v[12:13], v[16:17], 0
    v_mfma_f32_16x16x16_bf16 v[40:43], v[10:11], v[18:19], 0
    v_mfma_f32_16x16x16_bf16 v[44:47], v[12:13], v[18:19], 0
    s_add_u32 s42, s38, 7168
    s_waitcnt lgkmcnt(4)
    buffer_store_dwordx4 v[176:179], v6, s[8:11], s42 offen nt
    s_waitcnt lgkmcnt(2)
    v_lshlrev_b32 v184, 16, v28
    v_and_b32 v185, s43, v28
    v_lshlrev_b32 v192, 16, v30
    v_and_b32 v193, s43, v30
    v_lshlrev_b32 v186, 16, v29
    v_and_b32 v187, s43, v29
    v_lshlrev_b32 v194, 16, v31
    v_and_b32 v195, s43, v31
    v_pk_fma_f32 v[184:185], v[188:189], v[48:49], v[184:185]
    v_pk_fma_f32 v[192:193], v[196:197], v[52:53], v[192:193]
    v_pk_fma_f32 v[186:187], v[190:191], v[50:51], v[186:187]
    v_pk_fma_f32 v[194:195], v[198:199], v[54:55], v[194:195]
    v_cvt_pk_bf16_f32 v184, v184, v185
    v_cvt_pk_bf16_f32 v192, v192, v193
    v_cvt_pk_bf16_f32 v185, v186, v187
    v_cvt_pk_bf16_f32 v193, v194, v195
    s_add_u32 s42, s40, 2048
    v_add_u32 v7, s42, v6
    ds_write_b64 v3, v[184:185] offset:2048
    ds_write_b64 v3, v[192:193] offset:2560
    ds_read_b128 v[192:195], v7
    s_waitcnt vmcnt(11)
    ds_read_b64 v[28:29], v3 offset:3072
    ds_read_b64 v[30:31], v3 offset:3584
    v_pk_mul_f32 v[200:201], v[200:201], v[32:33]
    v_pk_mul_f32 v[208:209], v[208:209], v[40:41]
    v_pk_mul_f32 v[202:203], v[202:203], v[34:35]
    v_pk_mul_f32 v[210:211], v[210:211], v[42:43]
    v_pk_fma_f32 v[200:201], v[204:205], v[36:37], v[200:201]
    v_pk_fma_f32 v[208:209], v[212:213], v[44:45], v[208:209]
    v_pk_fma_f32 v[202:203], v[206:207], v[38:39], v[202:203]
    v_pk_fma_f32 v[210:211], v[214:215], v[46:47], v[210:211]
    v_cvt_pk_bf16_f32 v200, v200, v201
    v_cvt_pk_bf16_f32 v208, v208, v209
    v_cvt_pk_bf16_f32 v201, v202, v203
    v_cvt_pk_bf16_f32 v209, v210, v211
    v_mfma_f32_16x16x16_bf16 v[48:51], v[14:15], v[16:17], 0
    v_mfma_f32_16x16x16_bf16 v[52:55], v[14:15], v[18:19], 0
    v_mfma_f32_16x16x16_bf16 v[204:207], v[8:9], v[200:201], 0
    v_mfma_f32_16x16x16_bf16 v[212:215], v[8:9], v[208:209], 0
    s_waitcnt lgkmcnt(12)
    v_lshlrev_b32 v24, 16, v24
    v_lshlrev_b32 v25, 16, v25
    v_pk_fma_f32 v[20:21], v[24:25], s[44:45], v[0:1] op_sel:[0,0,0] op_sel_hi:[0,0,1]
    v_pk_fma_f32 v[22:23], v[24:25], s[44:45], v[0:1] op_sel:[1,0,0] op_sel_hi:[1,0,1]
    ds_read_u16 v24, v5 offset:768
    ds_read_u16 v25, v5 offset:800
    v_pk_mul_f32 v[20:21], v[20:21], v[20:21] neg_lo:[0,1] neg_hi:[0,1]
    v_pk_mul_f32 v[22:23], v[22:23], v[22:23] neg_lo:[0,1] neg_hi:[0,1]
    v_exp_f32 v20, v20
    v_exp_f32 v21, v21
    v_exp_f32 v22, v22
    v_exp_f32 v23, v23
    v_cvt_pk_bf16_f32 v16, v20, v21
    v_cvt_pk_bf16_f32 v18, v22, v23
    s_nop 0
    v_mfma_f32_16x16x16_bf16 v[32:35], v[10:11], v[16:17], 0
    v_mfma_f32_16x16x16_bf16 v[36:39], v[12:13], v[16:17], 0
    v_mfma_f32_16x16x16_bf16 v[40:43], v[10:11], v[18:19], 0
    v_mfma_f32_16x16x16_bf16 v[44:47], v[12:13], v[18:19], 0
    s_add_u32 s42, s38, 8192
    s_waitcnt lgkmcnt(4)
    buffer_store_dwordx4 v[192:195], v6, s[8:11], s42 offen nt
    s_waitcnt lgkmcnt(2)
    v_lshlrev_b32 v200, 16, v28
    v_and_b32 v201, s43, v28
    v_lshlrev_b32 v208, 16, v30
    v_and_b32 v209, s43, v30
    v_lshlrev_b32 v202, 16, v29
    v_and_b32 v203, s43, v29
    v_lshlrev_b32 v210, 16, v31
    v_and_b32 v211, s43, v31
    v_pk_fma_f32 v[200:201], v[204:205], v[48:49], v[200:201]
    v_pk_fma_f32 v[208:209], v[212:213], v[52:53], v[208:209]
    v_pk_fma_f32 v[202:203], v[206:207], v[50:51], v[202:203]
    v_pk_fma_f32 v[210:211], v[214:215], v[54:55], v[210:211]
    v_cvt_pk_bf16_f32 v200, v200, v201
    v_cvt_pk_bf16_f32 v208, v208, v209
    v_cvt_pk_bf16_f32 v201, v202, v203
    v_cvt_pk_bf16_f32 v209, v210, v211
    s_add_u32 s42, s40, 3072
    v_add_u32 v7, s42, v6
    ds_write_b64 v3, v[200:201] offset:3072
    ds_write_b64 v3, v[208:209] offset:3584
    ds_read_b128 v[208:211], v7
    s_waitcnt vmcnt(11)
    ds_read_b64 v[28:29], v3 offset:4096
    ds_read_b64 v[30:31], v3 offset:4608
    v_pk_mul_f32 v[216:217], v[216:217], v[32:33]
    v_pk_mul_f32 v[224:225], v[224:225], v[40:41]
    v_pk_mul_f32 v[218:219], v[218:219], v[34:35]
    v_pk_mul_f32 v[226:227], v[226:227], v[42:43]
    v_pk_fma_f32 v[216:217], v[220:221], v[36:37], v[216:217]
    v_pk_fma_f32 v[224:225], v[228:229], v[44:45], v[224:225]
    v_pk_fma_f32 v[218:219], v[222:223], v[38:39], v[218:219]
    v_pk_fma_f32 v[226:227], v[230:231], v[46:47], v[226:227]
    v_cvt_pk_bf16_f32 v216, v216, v217
    v_cvt_pk_bf16_f32 v224, v224, v225
    v_cvt_pk_bf16_f32 v217, v218, v219
    v_cvt_pk_bf16_f32 v225, v226, v227
    v_mfma_f32_16x16x16_bf16 v[48:51], v[14:15], v[16:17], 0
    v_mfma_f32_16x16x16_bf16 v[52:55], v[14:15], v[18:19], 0
    v_mfma_f32_16x16x16_bf16 v[220:223], v[8:9], v[216:217], 0
    v_mfma_f32_16x16x16_bf16 v[228:231], v[8:9], v[224:225], 0
    s_waitcnt lgkmcnt(12)
    v_lshlrev_b32 v26, 16, v26
    v_lshlrev_b32 v27, 16, v27
    v_pk_fma_f32 v[20:21], v[26:27], s[44:45], v[0:1] op_sel:[0,0,0] op_sel_hi:[0,0,1]
    v_pk_fma_f32 v[22:23], v[26:27], s[44:45], v[0:1] op_sel:[1,0,0] op_sel_hi:[1,0,1]
    v_pk_mul_f32 v[20:21], v[20:21], v[20:21] neg_lo:[0,1] neg_hi:[0,1]
    v_pk_mul_f32 v[22:23], v[22:23], v[22:23] neg_lo:[0,1] neg_hi:[0,1]
    v_exp_f32 v20, v20
    v_exp_f32 v21, v21
    v_exp_f32 v22, v22
    v_exp_f32 v23, v23
    v_cvt_pk_bf16_f32 v16, v20, v21
    v_cvt_pk_bf16_f32 v18, v22, v23
    s_nop 0
    v_mfma_f32_16x16x16_bf16 v[32:35], v[10:11], v[16:17], 0
    v_mfma_f32_16x16x16_bf16 v[36:39], v[12:13], v[16:17], 0
    v_mfma_f32_16x16x16_bf16 v[40:43], v[10:11], v[18:19], 0
    v_mfma_f32_16x16x16_bf16 v[44:47], v[12:13], v[18:19], 0
    s_add_u32 s42, s38, 9216
    s_waitcnt lgkmcnt(2)
    buffer_store_dwordx4 v[208:211], v6, s[8:11], s42 offen nt
    s_waitcnt lgkmcnt(0)
    v_lshlrev_b32 v216, 16, v28
    v_and_b32 v217, s43, v28
    v_lshlrev_b32 v224, 16, v30
    v_and_b32 v225, s43, v30
    v_lshlrev_b32 v218, 16, v29
    v_and_b32 v219, s43, v29
    v_lshlrev_b32 v226, 16, v31
    v_and_b32 v227, s43, v31
    v_pk_fma_f32 v[216:217], v[220:221], v[48:49], v[216:217]
    v_pk_fma_f32 v[224:225], v[228:229], v[52:53], v[224:225]
    v_pk_fma_f32 v[218:219], v[222:223], v[50:51], v[218:219]
    v_pk_fma_f32 v[226:227], v[230:231], v[54:55], v[226:227]
    v_cvt_pk_bf16_f32 v216, v216, v217
    v_cvt_pk_bf16_f32 v224, v224, v225
    v_cvt_pk_bf16_f32 v217, v218, v219
    v_cvt_pk_bf16_f32 v225, v226, v227
    s_add_u32 s42, s40, 4096
    v_add_u32 v7, s42, v6
    ds_write_b64 v3, v[216:217] offset:4096
    ds_write_b64 v3, v[224:225] offset:4608
    ds_read_b128 v[224:227], v7
    s_waitcnt vmcnt(10)
    ds_read_b64 v[28:29], v3 offset:5120
    ds_read_b64 v[30:31], v3 offset:5632
    v_pk_mul_f32 v[232:233], v[232:233], v[32:33]
    v_pk_mul_f32 v[240:241], v[240:241], v[40:41]
    v_pk_mul_f32 v[234:235], v[234:235], v[34:35]
    v_pk_mul_f32 v[242:243], v[242:243], v[42:43]
    v_pk_fma_f32 v[232:233], v[236:237], v[36:37], v[232:233]
    v_pk_fma_f32 v[240:241], v[244:245], v[44:45], v[240:241]
    v_pk_fma_f32 v[234:235], v[238:239], v[38:39], v[234:235]
    v_pk_fma_f32 v[242:243], v[246:247], v[46:47], v[242:243]
    v_cvt_pk_bf16_f32 v232, v232, v233
    v_cvt_pk_bf16_f32 v240, v240, v241
    v_cvt_pk_bf16_f32 v233, v234, v235
    v_cvt_pk_bf16_f32 v241, v242, v243
    v_mfma_f32_16x16x16_bf16 v[48:51], v[14:15], v[16:17], 0
    v_mfma_f32_16x16x16_bf16 v[52:55], v[14:15], v[18:19], 0
    v_mfma_f32_16x16x16_bf16 v[236:239], v[8:9], v[232:233], 0
    v_mfma_f32_16x16x16_bf16 v[244:247], v[8:9], v[240:241], 0
    s_waitcnt lgkmcnt(10)
    v_lshlrev_b32 v24, 16, v24
    v_pk_fma_f32 v[20:21], v[24:25], s[44:45], v[0:1] op_sel:[0,0,0] op_sel_hi:[0,0,1]
    v_pk_mul_f32 v[20:21], v[20:21], v[20:21] neg_lo:[0,1] neg_hi:[0,1]
    v_exp_f32 v20, v20
    v_exp_f32 v21, v21
    s_nop 0
    v_cvt_pk_bf16_f32 v16, v20, v21
    s_nop 1
    v_mfma_f32_16x16x16_bf16 v[32:35], v[10:11], v[16:17], 0
    v_mfma_f32_16x16x16_bf16 v[36:39], v[12:13], v[16:17], 0
    s_add_u32 s42, s38, 10240
    s_waitcnt lgkmcnt(2)
    buffer_store_dwordx4 v[224:227], v6, s[8:11], s42 offen nt
    s_waitcnt lgkmcnt(0)
    v_lshlrev_b32 v232, 16, v28
    v_and_b32 v233, s43, v28
    v_lshlrev_b32 v240, 16, v30
    v_and_b32 v241, s43, v30
    v_lshlrev_b32 v234, 16, v29
    v_and_b32 v235, s43, v29
    v_lshlrev_b32 v242, 16, v31
    v_and_b32 v243, s43, v31
    v_pk_fma_f32 v[232:233], v[236:237], v[48:49], v[232:233]
    v_pk_fma_f32 v[240:241], v[244:245], v[52:53], v[240:241]
    v_pk_fma_f32 v[234:235], v[238:239], v[50:51], v[234:235]
    v_pk_fma_f32 v[242:243], v[246:247], v[54:55], v[242:243]
    v_cvt_pk_bf16_f32 v232, v232, v233
    v_cvt_pk_bf16_f32 v240, v240, v241
    v_cvt_pk_bf16_f32 v233, v234, v235
    v_cvt_pk_bf16_f32 v241, v242, v243
    s_add_u32 s42, s40, 5120
    v_add_u32 v7, s42, v6
    ds_write_b64 v3, v[232:233] offset:5120
    ds_write_b64 v3, v[240:241] offset:5632
    ds_read_b128 v[240:243], v7
    s_add_u32 s42, s38, 11264
    s_waitcnt lgkmcnt(0)
    buffer_store_dwordx4 v[240:243], v6, s[8:11], s42 offen nt
    s_cmp_ge_u32 s3, 4
    s_cbranch_scc1 B_last
    s_waitcnt vmcnt(10)
    ds_read_b64 v[28:29], v4 offset:0
    v_pk_mul_f32 v[248:249], v[248:249], v[32:33]
    v_pk_mul_f32 v[250:251], v[250:251], v[34:35]
    v_pk_fma_f32 v[248:249], v[252:253], v[36:37], v[248:249]
    v_pk_fma_f32 v[250:251], v[254:255], v[38:39], v[250:251]
    v_cvt_pk_bf16_f32 v248, v248, v249
    v_cvt_pk_bf16_f32 v249, v250, v251
    v_mfma_f32_16x16x16_bf16 v[48:51], v[14:15], v[16:17], 0
    s_nop 0
    v_mfma_f32_16x16x16_bf16 v[252:255], v[8:9], v[248:249], 0
    s_waitcnt lgkmcnt(0)
    v_lshlrev_b32 v248, 16, v28
    v_and_b32 v249, s43, v28
    v_lshlrev_b32 v250, 16, v29
    v_and_b32 v251, s43, v29
    s_nop 2
    v_pk_fma_f32 v[248:249], v[252:253], v[48:49], v[248:249]
    v_pk_fma_f32 v[250:251], v[254:255], v[50:51], v[250:251]
    v_cvt_pk_bf16_f32 v248, v248, v249
    v_cvt_pk_bf16_f32 v249, v250, v251
    s_add_u32 s42, s41, 0
    v_add_u32 v7, s42, v6
    ds_write_b64 v4, v[248:249] offset:0
    ds_read_b128 v[248:251], v7
    s_mov_b32 exec_hi, 0
    s_add_u32 s42, s38, 12288
    s_waitcnt lgkmcnt(0)
    buffer_store_dwordx4 v[248:251], v6, s[8:11], s42 offen nt
B_last:
B_end:
    s_endpgm
B_x:
    s_mov_b32 s24, 0
    v_max_u32 v119, 1, v110
    v_mad_u32_u16 v118, v104, 6, v120
    v_subrev_u32 v119, 1, v119
    v_lshl_or_b32 v119, v119, 16, v110
    v_cmp_lt_u32 vcc, 32, v110
    v_add_u32 v118, 192, v118
    v_subrev_u32 v119, 2097184, v119
    v_mbcnt_lo_u32_b32 v117, vcc_lo, 0
    v_mbcnt_hi_u32_b32 v117, vcc_hi, v117
    s_bcnt1_i32_b64 s37, vcc
    v_add_u32 v117, s24, v117
    s_add_u32 s24, s24, s37
    s_cmp_gt_u32 s24, 28
    s_cselect_b64 vcc, 0, vcc
    s_sub_u32 s37, s23, 8
    v_lshlrev_b32 v117, 3, v117
    v_sub_u32 v117, s37, v117
    s_mov_b64 exec, vcc
    ds_write_b64 v117, v[118:119]
    s_mov_b64 exec, -1
    v_max_u32 v119, 1, v111
    v_mad_u32_u16 v118, v105, 6, v120
    v_subrev_u32 v119, 1, v119
    v_lshl_or_b32 v119, v119, 16, v111
    v_cmp_lt_u32 vcc, 32, v111
    v_add_u32 v118, 192, v118
    v_subrev_u32 v119, 2097184, v119
    v_mbcnt_lo_u32_b32 v117, vcc_lo, 0
    v_mbcnt_hi_u32_b32 v117, vcc_hi, v117
    s_bcnt1_i32_b64 s37, vcc
    v_add_u32 v117, s24, v117
    s_add_u32 s24, s24, s37
    s_cmp_gt_u32 s24, 28
    s_cselect_b64 vcc, 0, vcc
    s_sub_u32 s37, s23, 8
    v_lshlrev_b32 v117, 3, v117
    v_sub_u32 v117, s37, v117
    s_mov_b64 exec, vcc
    ds_write_b64 v117, v[118:119]
    s_mov_b64 exec, -1
    v_max_u32 v119, 1, v112
    v_mad_u32_u16 v118, v106, 6, v120
    v_subrev_u32 v119, 1, v119
    v_lshl_or_b32 v119, v119, 16, v112
    v_cmp_lt_u32 vcc, 32, v112
    v_add_u32 v118, 192, v118
    v_subrev_u32 v119, 2097184, v119
    v_mbcnt_lo_u32_b32 v117, vcc_lo, 0
    v_mbcnt_hi_u32_b32 v117, vcc_hi, v117
    s_bcnt1_i32_b64 s37, vcc
    v_add_u32 v117, s24, v117
    s_add_u32 s24, s24, s37
    s_cmp_gt_u32 s24, 28
    s_cselect_b64 vcc, 0, vcc
    s_sub_u32 s37, s23, 8
    v_lshlrev_b32 v117, 3, v117
    v_sub_u32 v117, s37, v117
    s_mov_b64 exec, vcc
    ds_write_b64 v117, v[118:119]
    s_mov_b64 exec, -1
    v_max_u32 v119, 1, v113
    v_mad_u32_u16 v118, v107, 6, v120
    v_subrev_u32 v119, 1, v119
    v_lshl_or_b32 v119, v119, 16, v113
    v_cmp_lt_u32 vcc, 32, v113
    v_add_u32 v118, 192, v118
    v_subrev_u32 v119, 2097184, v119
    v_mbcnt_lo_u32_b32 v117, vcc_lo, 0
    v_mbcnt_hi_u32_b32 v117, vcc_hi, v117
    s_bcnt1_i32_b64 s37, vcc
    v_add_u32 v117, s24, v117
    s_add_u32 s24, s24, s37
    s_cmp_gt_u32 s24, 28
    s_cselect_b64 vcc, 0, vcc
    s_sub_u32 s37, s23, 8
    v_lshlrev_b32 v117, 3, v117
    v_sub_u32 v117, s37, v117
    s_mov_b64 exec, vcc
    ds_write_b64 v117, v[118:119]
    s_mov_b64 exec, -1
    v_max_u32 v119, 1, v114
    v_mad_u32_u16 v118, v108, 6, v120
    v_subrev_u32 v119, 1, v119
    v_lshl_or_b32 v119, v119, 16, v114
    v_cmp_lt_u32 vcc, 32, v114
    v_add_u32 v118, 192, v118
    v_subrev_u32 v119, 2097184, v119
    v_mbcnt_lo_u32_b32 v117, vcc_lo, 0
    v_mbcnt_hi_u32_b32 v117, vcc_hi, v117
    s_bcnt1_i32_b64 s37, vcc
    v_add_u32 v117, s24, v117
    s_add_u32 s24, s24, s37
    s_cmp_gt_u32 s24, 28
    s_cselect_b64 vcc, 0, vcc
    s_sub_u32 s37, s23, 8
    v_lshlrev_b32 v117, 3, v117
    v_sub_u32 v117, s37, v117
    s_mov_b64 exec, vcc
    ds_write_b64 v117, v[118:119]
    s_mov_b64 exec, -1
    v_max_u32 v119, 1, v115
    v_mad_u32_u16 v118, v109, 6, v120
    v_subrev_u32 v119, 1, v119
    v_lshl_or_b32 v119, v119, 16, v115
    v_cmp_lt_u32 vcc, 32, v115
    v_add_u32 v118, 192, v118
    v_subrev_u32 v119, 2097184, v119
    v_mbcnt_lo_u32_b32 v117, vcc_lo, 0
    v_mbcnt_hi_u32_b32 v117, vcc_hi, v117
    s_bcnt1_i32_b64 s37, vcc
    v_add_u32 v117, s24, v117
    s_add_u32 s24, s24, s37
    s_cmp_gt_u32 s24, 28
    s_cselect_b64 vcc, 0, vcc
    s_sub_u32 s37, s23, 8
    v_lshlrev_b32 v117, 3, v117
    v_sub_u32 v117, s37, v117
    s_mov_b64 exec, vcc
    ds_write_b64 v117, v[118:119]
    s_mov_b64 exec, -1
    v_max_u32_dpp v116, v116, v116 row_shr:1 row_mask:0xf bank_mask:0xf
    s_nop 1
    v_max_u32_dpp v116, v116, v116 row_shr:2 row_mask:0xf bank_mask:0xf
    s_nop 1
    v_max_u32_dpp v116, v116, v116 row_shr:4 row_mask:0xf bank_mask:0xf
    s_nop 1
    v_max_u32_dpp v116, v116, v116 row_shr:8 row_mask:0xf bank_mask:0xf
    s_nop 1
    v_max_u32_dpp v116, v116, v116 row_bcast:15 row_mask:0xa bank_mask:0xf
    s_nop 1
    v_max_u32_dpp v116, v116, v116 row_bcast:31 row_mask:0xc bank_mask:0xf
    s_nop 0
    v_readlane_b32 s36, v116, 63
    s_add_u32 s37, s24, 3
    s_lshr_b32 s37, s37, 2
    s_lshl_b32 s37, s37, 5
    s_sub_u32 s25, s23, s37
    s_cmp_gt_u32 s24, 28
    s_cselect_b32 s37, 65, 0
    s_max_u32 s37, s37, s36
    s_cmp_gt_u32 s37, 64
    s_cbranch_scc0 B_xb
    s_mov_b32 s25, s23
    s_add_u32 s36, s36, 31
    s_lshr_b32 s36, s36, 5
    s_mul_i32 s36, s36, 3072
    s_add_u32 s26, s23, s36
    s_mov_b32 s13, s49
    s_branch B_xb
B_far1:
    s_cmp_ge_u32 s36, s26
    s_cselect_b32 s36, s49, s36
    s_cbranch_scc1 B_farb1
    s_sub_u32 s37, s36, s23
    s_lshr_b32 s37, s37, 5
    s_mov_b32 s38, 44739243
    s_mul_hi_u32 s37, s37, s38
    s_mul_i32 s38, s37, 3072
    s_sub_u32 s36, s36, s38
    s_lshl_b32 s37, s37, 5
    v_mbcnt_lo_u32_b32 v0, -1, 0
    v_mbcnt_hi_u32_b32 v0, -1, v0
    v_and_b32 v0, 15, v0
    v_lshl_add_u32 v0, v0, 1, s37
    v_mov_b32_sdwa v6, v0 dst_sel:WORD_1 dst_unused:UNUSED_PRESERVE src0_sel:WORD_0
    s_branch B_farb1
B_sp2:
    v_mbcnt_lo_u32_b32 v1, vcc_lo, 0
    v_mbcnt_hi_u32_b32 v1, vcc_hi, v1
    s_lshl_b32 s36, s27, 3
    s_add_u32 s36, s36, s48
    v_lshl_add_u32 v1, v1, 3, s36
    s_bcnt1_i32_b64 s37, vcc
    s_add_u32 s27, s27, s37
    s_andn2_b64 s[36:37], exec, vcc
    s_mov_b64 exec, vcc
    ds_write_b64 v1, v[104:105]
    s_mov_b64 exec, s[36:37]
    s_cmp_le_u32 s27, 64
    s_cbranch_scc1 B_spb2
    s_mov_b64 s[30:31], 0
    s_add_u32 s28, s25, 16
    s_branch B_spb2
B_sp3:
    v_mbcnt_lo_u32_b32 v1, vcc_lo, 0
    v_mbcnt_hi_u32_b32 v1, vcc_hi, v1
    s_lshl_b32 s36, s27, 3
    s_add_u32 s36, s36, s48
    v_lshl_add_u32 v1, v1, 3, s36
    s_bcnt1_i32_b64 s37, vcc
    s_add_u32 s27, s27, s37
    s_andn2_b64 s[36:37], exec, vcc
    s_mov_b64 exec, vcc
    ds_write_b64 v1, v[106:107]
    s_mov_b64 exec, s[36:37]
    s_cmp_le_u32 s27, 64
    s_cbranch_scc1 B_spb3
    s_mov_b64 s[30:31], 0
    s_add_u32 s28, s25, 32
    s_branch B_spb3
B_sp4:
    v_mbcnt_lo_u32_b32 v1, vcc_lo, 0
    v_mbcnt_hi_u32_b32 v1, vcc_hi, v1
    s_lshl_b32 s36, s27, 3
    s_add_u32 s36, s36, s48
    v_lshl_add_u32 v1, v1, 3, s36
    s_bcnt1_i32_b64 s37, vcc
    s_add_u32 s27, s27, s37
    s_andn2_b64 s[36:37], exec, vcc
    s_mov_b64 exec, vcc
    ds_write_b64 v1, v[16:17]
    s_mov_b64 exec, s[36:37]
    s_cmp_le_u32 s27, 64
    s_cbranch_scc1 B_spb4
    s_mov_b64 s[30:31], 0
    s_add_u32 s28, s25, -16
    s_branch B_spb4
B_sp5:
    v_mbcnt_lo_u32_b32 v1, vcc_lo, 0
    v_mbcnt_hi_u32_b32 v1, vcc_hi, v1
    s_lshl_b32 s36, s27, 3
    s_add_u32 s36, s36, s48
    v_lshl_add_u32 v1, v1, 3, s36
    s_bcnt1_i32_b64 s37, vcc
    s_add_u32 s27, s27, s37
    s_andn2_b64 s[36:37], exec, vcc
    s_mov_b64 exec, vcc
    ds_write_b64 v1, v[18:19]
    s_mov_b64 exec, s[36:37]
    s_cmp_le_u32 s27, 64
    s_cbranch_scc1 B_spb5
    s_mov_b64 s[30:31], 0
    s_add_u32 s28, s25, 0
    s_branch B_spb5
B_sp6:
    v_mbcnt_lo_u32_b32 v1, vcc_lo, 0
    v_mbcnt_hi_u32_b32 v1, vcc_hi, v1
    s_lshl_b32 s36, s27, 3
    s_add_u32 s36, s36, s48
    v_lshl_add_u32 v1, v1, 3, s36
    s_bcnt1_i32_b64 s37, vcc
    s_add_u32 s27, s27, s37
    s_andn2_b64 s[36:37], exec, vcc
    s_mov_b64 exec, vcc
    ds_write_b64 v1, v[20:21]
    s_mov_b64 exec, s[36:37]
    s_cmp_le_u32 s27, 64
    s_cbranch_scc1 B_spb6
    s_mov_b64 s[30:31], 0
    s_add_u32 s28, s25, 16
    s_branch B_spb6
B_sp7:
    v_mbcnt_lo_u32_b32 v1, vcc_lo, 0
    v_mbcnt_hi_u32_b32 v1, vcc_hi, v1
    s_lshl_b32 s36, s27, 3
    s_add_u32 s36, s36, s48
    v_lshl_add_u32 v1, v1, 3, s36
    s_bcnt1_i32_b64 s37, vcc
    s_add_u32 s27, s27, s37
    s_andn2_b64 s[36:37], exec, vcc
    s_mov_b64 exec, vcc
    ds_write_b64 v1, v[22:23]
    s_mov_b64 exec, s[36:37]
    s_cmp_le_u32 s27, 64
    s_cbranch_scc1 B_spb7
    s_mov_b64 s[30:31], 0
    s_add_u32 s28, s25, 32
    s_branch B_spb7
B_sp8:
    v_mbcnt_lo_u32_b32 v1, vcc_lo, 0
    v_mbcnt_hi_u32_b32 v1, vcc_hi, v1
    s_lshl_b32 s36, s27, 3
    s_add_u32 s36, s36, s48
    v_lshl_add_u32 v1, v1, 3, s36
    s_bcnt1_i32_b64 s37, vcc
    s_add_u32 s27, s27, s37
    s_andn2_b64 s[36:37], exec, vcc
    s_mov_b64 exec, vcc
    ds_write_b64 v1, v[24:25]
    s_mov_b64 exec, s[36:37]
    s_cmp_le_u32 s27, 64
    s_cbranch_scc1 B_spb8
    s_mov_b64 s[30:31], 0
    s_add_u32 s28, s25, 48
    s_branch B_spb8
B_sp9:
    v_mbcnt_lo_u32_b32 v1, vcc_lo, 0
    v_mbcnt_hi_u32_b32 v1, vcc_hi, v1
    s_lshl_b32 s36, s27, 3
    s_add_u32 s36, s36, s48
    v_lshl_add_u32 v1, v1, 3, s36
    s_bcnt1_i32_b64 s37, vcc
    s_add_u32 s27, s27, s37
    s_andn2_b64 s[36:37], exec, vcc
    s_mov_b64 exec, vcc
    ds_write_b64 v1, v[26:27]
    s_mov_b64 exec, s[36:37]
    s_cmp_le_u32 s27, 64
    s_cbranch_scc1 B_spb9
    s_mov_b64 s[30:31], 0
    s_add_u32 s28, s25, 64
    s_branch B_spb9
B_sp10:
    v_mbcnt_lo_u32_b32 v1, vcc_lo, 0
    v_mbcnt_hi_u32_b32 v1, vcc_hi, v1
    s_lshl_b32 s36, s27, 3
    s_add_u32 s36, s36, s48
    v_lshl_add_u32 v1, v1, 3, s36
    s_bcnt1_i32_b64 s37, vcc
    s_add_u32 s27, s27, s37
    s_andn2_b64 s[36:37], exec, vcc
    s_mov_b64 exec, vcc
    ds_write_b64 v1, v[28:29]
    s_mov_b64 exec, s[36:37]
    s_cmp_le_u32 s27, 64
    s_cbranch_scc1 B_spb10
    s_mov_b64 s[30:31], 0
    s_add_u32 s28, s25, 80
    s_branch B_spb10
B_sp11:
    v_mbcnt_lo_u32_b32 v1, vcc_lo, 0
    v_mbcnt_hi_u32_b32 v1, vcc_hi, v1
    s_lshl_b32 s36, s27, 3
    s_add_u32 s36, s36, s48
    v_lshl_add_u32 v1, v1, 3, s36
    s_bcnt1_i32_b64 s37, vcc
    s_add_u32 s27, s27, s37
    s_andn2_b64 s[36:37], exec, vcc
    s_mov_b64 exec, vcc
    ds_write_b64 v1, v[30:31]
    s_mov_b64 exec, s[36:37]
    s_cmp_le_u32 s27, 64
    s_cbranch_scc1 B_spb11
    s_mov_b64 s[30:31], 0
    s_add_u32 s28, s25, 96
    s_branch B_spb11
B_sp12:
    v_mbcnt_lo_u32_b32 v1, vcc_lo, 0
    v_mbcnt_hi_u32_b32 v1, vcc_hi, v1
    s_lshl_b32 s36, s27, 3
    s_add_u32 s36, s36, s48
    v_lshl_add_u32 v1, v1, 3, s36
    s_bcnt1_i32_b64 s37, vcc
    s_add_u32 s27, s27, s37
    s_andn2_b64 s[36:37], exec, vcc
    s_mov_b64 exec, vcc
    ds_write_b64 v1, v[32:33]
    s_mov_b64 exec, s[36:37]
    s_cmp_le_u32 s27, 64
    s_cbranch_scc1 B_spb12
    s_mov_b64 s[30:31], 0
    s_add_u32 s28, s25, 112
    s_branch B_spb12
B_sp13:
    v_mbcnt_lo_u32_b32 v1, vcc_lo, 0
    v_mbcnt_hi_u32_b32 v1, vcc_hi, v1
    s_lshl_b32 s36, s27, 3
    s_add_u32 s36, s36, s48
    v_lshl_add_u32 v1, v1, 3, s36
    s_bcnt1_i32_b64 s37, vcc
    s_add_u32 s27, s27, s37
    s_andn2_b64 s[36:37], exec, vcc
    s_mov_b64 exec, vcc
    ds_write_b64 v1, v[34:35]
    s_mov_b64 exec, s[36:37]
    s_cmp_le_u32 s27, 64
    s_cbranch_scc1 B_spb13
    s_mov_b64 s[30:31], 0
    s_add_u32 s28, s25, 128
    s_branch B_spb13
B_sp14:
    v_mbcnt_lo_u32_b32 v1, vcc_lo, 0
    v_mbcnt_hi_u32_b32 v1, vcc_hi, v1
    s_lshl_b32 s36, s27, 3
    s_add_u32 s36, s36, s48
    v_lshl_add_u32 v1, v1, 3, s36
    s_bcnt1_i32_b64 s37, vcc
    s_add_u32 s27, s27, s37
    s_andn2_b64 s[36:37], exec, vcc
    s_mov_b64 exec, vcc
    ds_write_b64 v1, v[36:37]
    s_mov_b64 exec, s[36:37]
    s_cmp_le_u32 s27, 64
    s_cbranch_scc1 B_spb14
    s_mov_b64 s[30:31], 0
    s_add_u32 s28, s25, 144
    s_branch B_spb14
B_sp15:
    v_mbcnt_lo_u32_b32 v1, vcc_lo, 0
    v_mbcnt_hi_u32_b32 v1, vcc_hi, v1
    s_lshl_b32 s36, s27, 3
    s_add_u32 s36, s36, s48
    v_lshl_add_u32 v1, v1, 3, s36
    s_bcnt1_i32_b64 s37, vcc
    s_add_u32 s27, s27, s37
    s_andn2_b64 s[36:37], exec, vcc
    s_mov_b64 exec, vcc
    ds_write_b64 v1, v[38:39]
    s_mov_b64 exec, s[36:37]
    s_cmp_le_u32 s27, 64
    s_cbranch_scc1 B_spb15
    s_mov_b64 s[30:31], 0
    s_add_u32 s28, s25, 160
    s_branch B_spb15
B_sp16:
    v_mbcnt_lo_u32_b32 v1, vcc_lo, 0
    v_mbcnt_hi_u32_b32 v1, vcc_hi, v1
    s_lshl_b32 s36, s27, 3
    s_add_u32 s36, s36, s48
    v_lshl_add_u32 v1, v1, 3, s36
    s_bcnt1_i32_b64 s37, vcc
    s_add_u32 s27, s27, s37
    s_andn2_b64 s[36:37], exec, vcc
    s_mov_b64 exec, vcc
    ds_write_b64 v1, v[40:41]
    s_mov_b64 exec, s[36:37]
    s_cmp_le_u32 s27, 64
    s_cbranch_scc1 B_spb16
    s_mov_b64 s[30:31], 0
    s_add_u32 s28, s25, 176
    s_branch B_spb16
B_sp17:
    v_mbcnt_lo_u32_b32 v1, vcc_lo, 0
    v_mbcnt_hi_u32_b32 v1, vcc_hi, v1
    s_lshl_b32 s36, s27, 3
    s_add_u32 s36, s36, s48
    v_lshl_add_u32 v1, v1, 3, s36
    s_bcnt1_i32_b64 s37, vcc
    s_add_u32 s27, s27, s37
    s_andn2_b64 s[36:37], exec, vcc
    s_mov_b64 exec, vcc
    ds_write_b64 v1, v[42:43]
    s_mov_b64 exec, s[36:37]
    s_cmp_le_u32 s27, 64
    s_cbranch_scc1 B_spb17
    s_mov_b64 s[30:31], 0
    s_add_u32 s28, s25, 192
    s_branch B_spb17
B_sp18:
    v_mbcnt_lo_u32_b32 v1, vcc_lo, 0
    v_mbcnt_hi_u32_b32 v1, vcc_hi, v1
    s_lshl_b32 s36, s27, 3
    s_add_u32 s36, s36, s48
    v_lshl_add_u32 v1, v1, 3, s36
    s_bcnt1_i32_b64 s37, vcc
    s_add_u32 s27, s27, s37
    s_andn2_b64 s[36:37], exec, vcc
    s_mov_b64 exec, vcc
    ds_write_b64 v1, v[44:45]
    s_mov_b64 exec, s[36:37]
    s_cmp_le_u32 s27, 64
    s_cbranch_scc1 B_spb18
    s_mov_b64 s[30:31], 0
    s_add_u32 s28, s25, 208
    s_branch B_spb18
B_sp19:
    v_mbcnt_lo_u32_b32 v1, vcc_lo, 0
    v_mbcnt_hi_u32_b32 v1, vcc_hi, v1
    s_lshl_b32 s36, s27, 3
    s_add_u32 s36, s36, s48
    v_lshl_add_u32 v1, v1, 3, s36
    s_bcnt1_i32_b64 s37, vcc
    s_add_u32 s27, s27, s37
    s_andn2_b64 s[36:37], exec, vcc
    s_mov_b64 exec, vcc
    ds_write_b64 v1, v[46:47]
    s_mov_b64 exec, s[36:37]
    s_cmp_le_u32 s27, 64
    s_cbranch_scc1 B_spb19
    s_mov_b64 s[30:31], 0
    s_add_u32 s28, s25, 224
    s_branch B_spb19
B_sp20:
    v_mbcnt_lo_u32_b32 v1, vcc_lo, 0
    v_mbcnt_hi_u32_b32 v1, vcc_hi, v1
    s_lshl_b32 s36, s27, 3
    s_add_u32 s36, s36, s48
    v_lshl_add_u32 v1, v1, 3, s36
    s_bcnt1_i32_b64 s37, vcc
    s_add_u32 s27, s27, s37
    s_andn2_b64 s[36:37], exec, vcc
    s_mov_b64 exec, vcc
    ds_write_b64 v1, v[48:49]
    s_mov_b64 exec, s[36:37]
    s_cmp_le_u32 s27, 64
    s_cbranch_scc1 B_spb20
    s_mov_b64 s[30:31], 0
    s_add_u32 s28, s25, 240
    s_branch B_spb20
B_sp21:
    v_mbcnt_lo_u32_b32 v1, vcc_lo, 0
    v_mbcnt_hi_u32_b32 v1, vcc_hi, v1
    s_lshl_b32 s36, s27, 3
    s_add_u32 s36, s36, s48
    v_lshl_add_u32 v1, v1, 3, s36
    s_bcnt1_i32_b64 s37, vcc
    s_add_u32 s27, s27, s37
    s_andn2_b64 s[36:37], exec, vcc
    s_mov_b64 exec, vcc
    ds_write_b64 v1, v[50:51]
    s_mov_b64 exec, s[36:37]
    s_cmp_le_u32 s27, 64
    s_cbranch_scc1 B_spb21
    s_mov_b64 s[30:31], 0
    s_add_u32 s28, s25, 256
    s_branch B_spb21
B_st22:
    s_and_b32 s25, s28, 0xffffffe0
    s_bitcmp1_b32 s28, 4
    s_cselect_b64 s[32:33], -1, 0
    s_mov_b64 s[30:31], -1
    v_mbcnt_lo_u32_b32 v0, -1, 0
    v_mbcnt_hi_u32_b32 v0, -1, v0
    v_and_b32 v0, 15, v0
    v_lshl_add_u32 v0, v0, 1, 0
    v_mov_b32_sdwa v6, v0 dst_sel:WORD_1 dst_unused:UNUSED_PRESERVE src0_sel:WORD_0
    s_branch B_stb22
B_far23:
    s_cmp_ge_u32 s36, s26
    s_cselect_b32 s36, s49, s36
    s_cbranch_scc1 B_farb23
    s_sub_u32 s37, s36, s23
    s_lshr_b32 s37, s37, 5
    s_mov_b32 s38, 44739243
    s_mul_hi_u32 s37, s37, s38
    s_mul_i32 s38, s37, 3072
    s_sub_u32 s36, s36, s38
    s_lshl_b32 s37, s37, 5
    v_mbcnt_lo_u32_b32 v0, -1, 0
    v_mbcnt_hi_u32_b32 v0, -1, v0
    v_and_b32 v0, 15, v0
    v_lshl_add_u32 v0, v0, 1, s37
    v_mov_b32_sdwa v6, v0 dst_sel:WORD_1 dst_unused:UNUSED_PRESERVE src0_sel:WORD_0
    s_branch B_farb23
B_sy24:
    v_mov_b32 v0, 0
    ds_read_b32 v50, v0 offset:1608
    s_waitcnt lgkmcnt(0)
    v_readfirstlane_b32 s36, v50
    s_cmp_lt_u32 s36, s72
    s_cbranch_scc1 B_sy24
    s_branch B_syb24
B_sp26:
    v_mbcnt_lo_u32_b32 v1, vcc_lo, 0
    v_mbcnt_hi_u32_b32 v1, vcc_hi, v1
    s_lshl_b32 s36, s27, 3
    s_add_u32 s36, s36, s48
    v_lshl_add_u32 v1, v1, 3, s36
    s_bcnt1_i32_b64 s37, vcc
    s_add_u32 s27, s27, s37
    s_andn2_b64 s[36:37], exec, vcc
    s_mov_b64 exec, vcc
    ds_write_b64 v1, v[42:43]
    s_mov_b64 exec, s[36:37]
    s_branch B_spb26
B_sp27:
    v_mbcnt_lo_u32_b32 v1, vcc_lo, 0
    v_mbcnt_hi_u32_b32 v1, vcc_hi, v1
    s_lshl_b32 s36, s27, 3
    s_add_u32 s36, s36, s48
    v_lshl_add_u32 v1, v1, 3, s36
    s_bcnt1_i32_b64 s37, vcc
    s_add_u32 s27, s27, s37
    s_andn2_b64 s[36:37], exec, vcc
    s_mov_b64 exec, vcc
    ds_write_b64 v1, v[42:43]
    s_mov_b64 exec, s[36:37]
    s_branch B_spb27
B_sp28:
    v_mbcnt_lo_u32_b32 v1, vcc_lo, 0
    v_mbcnt_hi_u32_b32 v1, vcc_hi, v1
    s_lshl_b32 s36, s27, 3
    s_add_u32 s36, s36, s48
    v_lshl_add_u32 v1, v1, 3, s36
    s_bcnt1_i32_b64 s37, vcc
    s_add_u32 s27, s27, s37
    s_andn2_b64 s[36:37], exec, vcc
    s_mov_b64 exec, vcc
    ds_write_b64 v1, v[44:45]
    s_mov_b64 exec, s[36:37]
    s_branch B_spb28
B_far29:
    s_cmp_ge_u32 s36, s26
    s_cselect_b32 s36, s49, s36
    s_cbranch_scc1 B_farb29
    s_sub_u32 s37, s36, s23
    s_lshr_b32 s37, s37, 5
    s_mov_b32 s38, 44739243
    s_mul_hi_u32 s37, s37, s38
    s_mul_i32 s38, s37, 3072
    s_sub_u32 s36, s36, s38
    s_lshl_b32 s37, s37, 5
    v_mbcnt_lo_u32_b32 v0, -1, 0
    v_mbcnt_hi_u32_b32 v0, -1, v0
    v_and_b32 v0, 15, v0
    v_lshl_add_u32 v0, v0, 1, s37
    v_mov_b32_sdwa v6, v0 dst_sel:WORD_1 dst_unused:UNUSED_PRESERVE src0_sel:WORD_0
    s_branch B_farb29
B_sp30:
    v_mbcnt_lo_u32_b32 v1, vcc_lo, 0
    v_mbcnt_hi_u32_b32 v1, vcc_hi, v1
    s_lshl_b32 s36, s27, 3
    s_add_u32 s36, s36, s48
    v_lshl_add_u32 v1, v1, 3, s36
    s_bcnt1_i32_b64 s37, vcc
    s_add_u32 s27, s27, s37
    s_andn2_b64 s[36:37], exec, vcc
    s_mov_b64 exec, vcc
    ds_write_b64 v1, v[46:47]
    s_mov_b64 exec, s[36:37]
    s_cmp_le_u32 s27, 64
    s_cbranch_scc1 B_spb30
    s_mov_b64 s[30:31], 0
    s_add_u32 s28, s25, 16
    s_branch B_spb30
B_sp31:
    v_mbcnt_lo_u32_b32 v1, vcc_lo, 0
    v_mbcnt_hi_u32_b32 v1, vcc_hi, v1
    s_lshl_b32 s36, s27, 3
    s_add_u32 s36, s36, s48
    v_lshl_add_u32 v1, v1, 3, s36
    s_bcnt1_i32_b64 s37, vcc
    s_add_u32 s27, s27, s37
    s_andn2_b64 s[36:37], exec, vcc
    s_mov_b64 exec, vcc
    ds_write_b64 v1, v[48:49]
    s_mov_b64 exec, s[36:37]
    s_cmp_le_u32 s27, 64
    s_cbranch_scc1 B_spb31
    s_mov_b64 s[30:31], 0
    s_add_u32 s28, s25, 32
    s_branch B_spb31
B_far32:
    s_cmp_ge_u32 s36, s26
    s_cselect_b32 s36, s49, s36
    s_cbranch_scc1 B_farb32
    s_sub_u32 s37, s36, s23
    s_lshr_b32 s37, s37, 5
    s_mov_b32 s38, 44739243
    s_mul_hi_u32 s37, s37, s38
    s_mul_i32 s38, s37, 3072
    s_sub_u32 s36, s36, s38
    s_lshl_b32 s37, s37, 5
    v_mbcnt_lo_u32_b32 v0, -1, 0
    v_mbcnt_hi_u32_b32 v0, -1, v0
    v_and_b32 v0, 15, v0
    v_lshl_add_u32 v0, v0, 1, s37
    v_mov_b32_sdwa v6, v0 dst_sel:WORD_1 dst_unused:UNUSED_PRESERVE src0_sel:WORD_0
    s_branch B_farb32
B_sp33:
    v_mbcnt_lo_u32_b32 v1, vcc_lo, 0
    v_mbcnt_hi_u32_b32 v1, vcc_hi, v1
    s_lshl_b32 s36, s27, 3
    s_add_u32 s36, s36, s48
    v_lshl_add_u32 v1, v1, 3, s36
    s_bcnt1_i32_b64 s37, vcc
    s_add_u32 s27, s27, s37
    s_andn2_b64 s[36:37], exec, vcc
    s_mov_b64 exec, vcc
    ds_write_b64 v1, v[42:43]
    s_mov_b64 exec, s[36:37]
    s_cmp_le_u32 s27, 64
    s_cbranch_scc1 B_spb33
    s_mov_b64 s[30:31], 0
    s_add_u32 s28, s25, 48
    s_branch B_spb33
B_sp34:
    v_mbcnt_lo_u32_b32 v1, vcc_lo, 0
    v_mbcnt_hi_u32_b32 v1, vcc_hi, v1
    s_lshl_b32 s36, s27, 3
    s_add_u32 s36, s36, s48
    v_lshl_add_u32 v1, v1, 3, s36
    s_bcnt1_i32_b64 s37, vcc
    s_add_u32 s27, s27, s37
    s_andn2_b64 s[36:37], exec, vcc
    s_mov_b64 exec, vcc
    ds_write_b64 v1, v[44:45]
    s_mov_b64 exec, s[36:37]
    s_cmp_le_u32 s27, 64
    s_cbranch_scc1 B_spb34
    s_mov_b64 s[30:31], 0
    s_add_u32 s28, s25, 64
    s_branch B_spb34
B_far35:
    s_cmp_ge_u32 s36, s26
    s_cselect_b32 s36, s49, s36
    s_cbranch_scc1 B_farb35
    s_sub_u32 s37, s36, s23
    s_lshr_b32 s37, s37, 5
    s_mov_b32 s38, 44739243
    s_mul_hi_u32 s37, s37, s38
    s_mul_i32 s38, s37, 3072
    s_sub_u32 s36, s36, s38
    s_lshl_b32 s37, s37, 5
    v_mbcnt_lo_u32_b32 v0, -1, 0
    v_mbcnt_hi_u32_b32 v0, -1, v0
    v_and_b32 v0, 15, v0
    v_lshl_add_u32 v0, v0, 1, s37
    v_mov_b32_sdwa v6, v0 dst_sel:WORD_1 dst_unused:UNUSED_PRESERVE src0_sel:WORD_0
    s_branch B_farb35
B_sp36:
    v_mbcnt_lo_u32_b32 v1, vcc_lo, 0
    v_mbcnt_hi_u32_b32 v1, vcc_hi, v1
    s_lshl_b32 s36, s27, 3
    s_add_u32 s36, s36, s48
    v_lshl_add_u32 v1, v1, 3, s36
    s_bcnt1_i32_b64 s37, vcc
    s_add_u32 s27, s27, s37
    s_andn2_b64 s[36:37], exec, vcc
    s_mov_b64 exec, vcc
    ds_write_b64 v1, v[46:47]
    s_mov_b64 exec, s[36:37]
    s_cmp_le_u32 s27, 64
    s_cbranch_scc1 B_spb36
    s_mov_b64 s[30:31], 0
    s_add_u32 s28, s25, 80
    s_branch B_spb36
B_sp37:
    v_mbcnt_lo_u32_b32 v1, vcc_lo, 0
    v_mbcnt_hi_u32_b32 v1, vcc_hi, v1
    s_lshl_b32 s36, s27, 3
    s_add_u32 s36, s36, s48
    v_lshl_add_u32 v1, v1, 3, s36
    s_bcnt1_i32_b64 s37, vcc
    s_add_u32 s27, s27, s37
    s_andn2_b64 s[36:37], exec, vcc
    s_mov_b64 exec, vcc
    ds_write_b64 v1, v[48:49]
    s_mov_b64 exec, s[36:37]
    s_cmp_le_u32 s27, 64
    s_cbranch_scc1 B_spb37
    s_mov_b64 s[30:31], 0
    s_add_u32 s28, s25, 96
    s_branch B_spb37
B_far38:
    s_cmp_ge_u32 s36, s26
    s_cselect_b32 s36, s49, s36
    s_cbranch_scc1 B_farb38
    s_sub_u32 s37, s36, s23
    s_lshr_b32 s37, s37, 5
    s_mov_b32 s38, 44739243
    s_mul_hi_u32 s37, s37, s38
    s_mul_i32 s38, s37, 3072
    s_sub_u32 s36, s36, s38
    s_lshl_b32 s37, s37, 5
    v_mbcnt_lo_u32_b32 v0, -1, 0
    v_mbcnt_hi_u32_b32 v0, -1, v0
    v_and_b32 v0, 15, v0
    v_lshl_add_u32 v0, v0, 1, s37
    v_mov_b32_sdwa v6, v0 dst_sel:WORD_1 dst_unused:UNUSED_PRESERVE src0_sel:WORD_0
    s_branch B_farb38
B_sp39:
    v_mbcnt_lo_u32_b32 v1, vcc_lo, 0
    v_mbcnt_hi_u32_b32 v1, vcc_hi, v1
    s_lshl_b32 s36, s27, 3
    s_add_u32 s36, s36, s48
    v_lshl_add_u32 v1, v1, 3, s36
    s_bcnt1_i32_b64 s37, vcc
    s_add_u32 s27, s27, s37
    s_andn2_b64 s[36:37], exec, vcc
    s_mov_b64 exec, vcc
    ds_write_b64 v1, v[42:43]
    s_mov_b64 exec, s[36:37]
    s_cmp_le_u32 s27, 64
    s_cbranch_scc1 B_spb39
    s_mov_b64 s[30:31], 0
    s_add_u32 s28, s25, 112
    s_branch B_spb39
B_sp40:
    v_mbcnt_lo_u32_b32 v1, vcc_lo, 0
    v_mbcnt_hi_u32_b32 v1, vcc_hi, v1
    s_lshl_b32 s36, s27, 3
    s_add_u32 s36, s36, s48
    v_lshl_add_u32 v1, v1, 3, s36
    s_bcnt1_i32_b64 s37, vcc
    s_add_u32 s27, s27, s37
    s_andn2_b64 s[36:37], exec, vcc
    s_mov_b64 exec, vcc
    ds_write_b64 v1, v[44:45]
    s_mov_b64 exec, s[36:37]
    s_cmp_le_u32 s27, 64
    s_cbranch_scc1 B_spb40
    s_mov_b64 s[30:31], 0
    s_add_u32 s28, s25, 128
    s_branch B_spb40
B_far41:
    s_cmp_ge_u32 s36, s26
    s_cselect_b32 s36, s49, s36
    s_cbranch_scc1 B_farb41
    s_sub_u32 s37, s36, s23
    s_lshr_b32 s37, s37, 5
    s_mov_b32 s38, 44739243
    s_mul_hi_u32 s37, s37, s38
    s_mul_i32 s38, s37, 3072
    s_sub_u32 s36, s36, s38
    s_lshl_b32 s37, s37, 5
    v_mbcnt_lo_u32_b32 v0, -1, 0
    v_mbcnt_hi_u32_b32 v0, -1, v0
    v_and_b32 v0, 15, v0
    v_lshl_add_u32 v0, v0, 1, s37
    v_mov_b32_sdwa v6, v0 dst_sel:WORD_1 dst_unused:UNUSED_PRESERVE src0_sel:WORD_0
    s_branch B_farb41
B_sp42:
    v_mbcnt_lo_u32_b32 v1, vcc_lo, 0
    v_mbcnt_hi_u32_b32 v1, vcc_hi, v1
    s_lshl_b32 s36, s27, 3
    s_add_u32 s36, s36, s48
    v_lshl_add_u32 v1, v1, 3, s36
    s_bcnt1_i32_b64 s37, vcc
    s_add_u32 s27, s27, s37
    s_andn2_b64 s[36:37], exec, vcc
    s_mov_b64 exec, vcc
    ds_write_b64 v1, v[46:47]
    s_mov_b64 exec, s[36:37]
    s_cmp_le_u32 s27, 64
    s_cbranch_scc1 B_spb42
    s_mov_b64 s[30:31], 0
    s_add_u32 s28, s25, 144
    s_branch B_spb42
B_sp43:
    v_mbcnt_lo_u32_b32 v1, vcc_lo, 0
    v_mbcnt_hi_u32_b32 v1, vcc_hi, v1
    s_lshl_b32 s36, s27, 3
    s_add_u32 s36, s36, s48
    v_lshl_add_u32 v1, v1, 3, s36
    s_bcnt1_i32_b64 s37, vcc
    s_add_u32 s27, s27, s37
    s_andn2_b64 s[36:37], exec, vcc
    s_mov_b64 exec, vcc
    ds_write_b64 v1, v[48:49]
    s_mov_b64 exec, s[36:37]
    s_cmp_le_u32 s27, 64
    s_cbranch_scc1 B_spb43
    s_mov_b64 s[30:31], 0
    s_add_u32 s28, s25, 160
    s_branch B_spb43
B_far44:
    s_cmp_ge_u32 s36, s26
    s_cselect_b32 s36, s49, s36
    s_cbranch_scc1 B_farb44
    s_sub_u32 s37, s36, s23
    s_lshr_b32 s37, s37, 5
    s_mov_b32 s38, 44739243
    s_mul_hi_u32 s37, s37, s38
    s_mul_i32 s38, s37, 3072
    s_sub_u32 s36, s36, s38
    s_lshl_b32 s37, s37, 5
    v_mbcnt_lo_u32_b32 v0, -1, 0
    v_mbcnt_hi_u32_b32 v0, -1, v0
    v_and_b32 v0, 15, v0
    v_lshl_add_u32 v0, v0, 1, s37
    v_mov_b32_sdwa v6, v0 dst_sel:WORD_1 dst_unused:UNUSED_PRESERVE src0_sel:WORD_0
    s_branch B_farb44
B_sp45:
    v_mbcnt_lo_u32_b32 v1, vcc_lo, 0
    v_mbcnt_hi_u32_b32 v1, vcc_hi, v1
    s_lshl_b32 s36, s27, 3
    s_add_u32 s36, s36, s48
    v_lshl_add_u32 v1, v1, 3, s36
    s_bcnt1_i32_b64 s37, vcc
    s_add_u32 s27, s27, s37
    s_andn2_b64 s[36:37], exec, vcc
    s_mov_b64 exec, vcc
    ds_write_b64 v1, v[42:43]
    s_mov_b64 exec, s[36:37]
    s_cmp_le_u32 s27, 64
    s_cbranch_scc1 B_spb45
    s_mov_b64 s[30:31], 0
    s_add_u32 s28, s25, 176
    s_branch B_spb45
B_sp46:
    v_mbcnt_lo_u32_b32 v1, vcc_lo, 0
    v_mbcnt_hi_u32_b32 v1, vcc_hi, v1
    s_lshl_b32 s36, s27, 3
    s_add_u32 s36, s36, s48
    v_lshl_add_u32 v1, v1, 3, s36
    s_bcnt1_i32_b64 s37, vcc
    s_add_u32 s27, s27, s37
    s_andn2_b64 s[36:37], exec, vcc
    s_mov_b64 exec, vcc
    ds_write_b64 v1, v[44:45]
    s_mov_b64 exec, s[36:37]
    s_cmp_le_u32 s27, 64
    s_cbranch_scc1 B_spb46
    s_mov_b64 s[30:31], 0
    s_add_u32 s28, s25, 192
    s_branch B_spb46
B_far47:
    s_cmp_ge_u32 s36, s26
    s_cselect_b32 s36, s49, s36
    s_cbranch_scc1 B_farb47
    s_sub_u32 s37, s36, s23
    s_lshr_b32 s37, s37, 5
    s_mov_b32 s38, 44739243
    s_mul_hi_u32 s37, s37, s38
    s_mul_i32 s38, s37, 3072
    s_sub_u32 s36, s36, s38
    s_lshl_b32 s37, s37, 5
    v_mbcnt_lo_u32_b32 v0, -1, 0
    v_mbcnt_hi_u32_b32 v0, -1, v0
    v_and_b32 v0, 15, v0
    v_lshl_add_u32 v0, v0, 1, s37
    v_mov_b32_sdwa v6, v0 dst_sel:WORD_1 dst_unused:UNUSED_PRESERVE src0_sel:WORD_0
    s_branch B_farb47
B_sp48:
    v_mbcnt_lo_u32_b32 v1, vcc_lo, 0
    v_mbcnt_hi_u32_b32 v1, vcc_hi, v1
    s_lshl_b32 s36, s27, 3
    s_add_u32 s36, s36, s48
    v_lshl_add_u32 v1, v1, 3, s36
    s_bcnt1_i32_b64 s37, vcc
    s_add_u32 s27, s27, s37
    s_andn2_b64 s[36:37], exec, vcc
    s_mov_b64 exec, vcc
    ds_write_b64 v1, v[46:47]
    s_mov_b64 exec, s[36:37]
    s_cmp_le_u32 s27, 64
    s_cbranch_scc1 B_spb48
    s_mov_b64 s[30:31], 0
    s_add_u32 s28, s25, 208
    s_branch B_spb48
B_sp49:
    v_mbcnt_lo_u32_b32 v1, vcc_lo, 0
    v_mbcnt_hi_u32_b32 v1, vcc_hi, v1
    s_lshl_b32 s36, s27, 3
    s_add_u32 s36, s36, s48
    v_lshl_add_u32 v1, v1, 3, s36
    s_bcnt1_i32_b64 s37, vcc
    s_add_u32 s27, s27, s37
    s_andn2_b64 s[36:37], exec, vcc
    s_mov_b64 exec, vcc
    ds_write_b64 v1, v[48:49]
    s_mov_b64 exec, s[36:37]
    s_cmp_le_u32 s27, 64
    s_cbranch_scc1 B_spb49
    s_mov_b64 s[30:31], 0
    s_add_u32 s28, s25, 224
    s_branch B_spb49
B_sp50:
    v_mbcnt_lo_u32_b32 v1, vcc_lo, 0
    v_mbcnt_hi_u32_b32 v1, vcc_hi, v1
    s_lshl_b32 s36, s27, 3
    s_add_u32 s36, s36, s48
    v_lshl_add_u32 v1, v1, 3, s36
    s_bcnt1_i32_b64 s37, vcc
    s_add_u32 s27, s27, s37
    s_andn2_b64 s[36:37], exec, vcc
    s_mov_b64 exec, vcc
    ds_write_b64 v1, v[42:43]
    s_mov_b64 exec, s[36:37]
    s_cmp_le_u32 s27, 64
    s_cbranch_scc1 B_spb50
    s_mov_b64 s[30:31], 0
    s_add_u32 s28, s25, 240
    s_branch B_spb50
B_sp51:
    v_mbcnt_lo_u32_b32 v1, vcc_lo, 0
    v_mbcnt_hi_u32_b32 v1, vcc_hi, v1
    s_lshl_b32 s36, s27, 3
    s_add_u32 s36, s36, s48
    v_lshl_add_u32 v1, v1, 3, s36
    s_bcnt1_i32_b64 s37, vcc
    s_add_u32 s27, s27, s37
    s_andn2_b64 s[36:37], exec, vcc
    s_mov_b64 exec, vcc
    ds_write_b64 v1, v[44:45]
    s_mov_b64 exec, s[36:37]
    s_cmp_le_u32 s27, 64
    s_cbranch_scc1 B_spb51
    s_mov_b64 s[30:31], 0
    s_add_u32 s28, s25, 256
    s_branch B_spb51
B_cl52:
    v_mov_b32 v46, s16
    v_mov_b32 v47, 0
    ds_write_b64 v2, v[46:47] offset:1664
    ds_write_b64 v2, v[46:47] offset:1920
    ds_write_b64 v2, v[46:47] offset:2176
    ds_write_b64 v2, v[46:47] offset:2432
    ds_write_b64 v2, v[46:47] offset:2688
    ds_write_b64 v2, v[46:47] offset:2944
    ds_write_b64 v2, v[46:47] offset:3200
    ds_write_b64 v2, v[46:47] offset:3456
    ds_write_b64 v2, v[46:47] offset:3712
    ds_write_b64 v2, v[46:47] offset:3968
    ds_write_b64 v2, v[46:47] offset:4224
    ds_write_b64 v2, v[46:47] offset:4480
    ds_write_b64 v2, v[46:47] offset:4736
    ds_write_b64 v2, v[46:47] offset:4992
    ds_write_b64 v2, v[46:47] offset:5248
    ds_write_b64 v2, v[46:47] offset:5504
    ds_write_b64 v2, v[46:47] offset:5760
    ds_write_b64 v2, v[46:47] offset:6016
    ds_write_b64 v2, v[46:47] offset:6272
    ds_write_b64 v2, v[46:47] offset:6528
    ds_write_b64 v2, v[46:47] offset:6784
    ds_write_b64 v2, v[46:47] offset:7040
    ds_write_b64 v2, v[46:47] offset:7296
    ds_write_b64 v2, v[46:47] offset:7552
    s_cmp_lg_u32 s50, 0
    s_cbranch_scc1 B_clb52
    ds_write_b64 v2, v[46:47] offset:7808
    s_branch B_clb52
B_sy54:
    v_mov_b32 v0, 0
    ds_read_b32 v50, v0 offset:1604
    s_waitcnt lgkmcnt(0)
    v_readfirstlane_b32 s36, v50
    s_cmp_lt_u32 s36, s72
    s_cbranch_scc1 B_sy54
    s_branch B_syb54
B_st53:
    s_and_b32 s25, s28, 0xffffffe0
    s_bitcmp1_b32 s28, 4
    s_cselect_b64 s[32:33], -1, 0
    s_mov_b64 s[30:31], -1
    v_mbcnt_lo_u32_b32 v0, -1, 0
    v_mbcnt_hi_u32_b32 v0, -1, v0
    v_and_b32 v0, 15, v0
    v_lshl_add_u32 v0, v0, 1, 0
    v_mov_b32_sdwa v6, v0 dst_sel:WORD_1 dst_unused:UNUSED_PRESERVE src0_sel:WORD_0
    s_branch B_stb53
B_far55:
    s_cmp_ge_u32 s36, s26
    s_cselect_b32 s36, s49, s36
    s_cbranch_scc1 B_farb55
    s_sub_u32 s37, s36, s23
    s_lshr_b32 s37, s37, 5
    s_mov_b32 s38, 44739243
    s_mul_hi_u32 s37, s37, s38
    s_mul_i32 s38, s37, 3072
    s_sub_u32 s36, s36, s38
    s_lshl_b32 s37, s37, 5
    v_mbcnt_lo_u32_b32 v0, -1, 0
    v_mbcnt_hi_u32_b32 v0, -1, v0
    v_and_b32 v0, 15, v0
    v_lshl_add_u32 v0, v0, 1, s37
    v_mov_b32_sdwa v6, v0 dst_sel:WORD_1 dst_unused:UNUSED_PRESERVE src0_sel:WORD_0
    s_branch B_farb55
B_sy56:
    v_mov_b32 v0, 0
    ds_read_b32 v50, v0 offset:1608
    s_waitcnt lgkmcnt(0)
    v_readfirstlane_b32 s36, v50
    s_cmp_lt_u32 s36, s72
    s_cbranch_scc1 B_sy56
    s_branch B_syb56
B_sp58:
    v_mbcnt_lo_u32_b32 v1, vcc_lo, 0
    v_mbcnt_hi_u32_b32 v1, vcc_hi, v1
    s_lshl_b32 s36, s27, 3
    s_add_u32 s36, s36, s48
    v_lshl_add_u32 v1, v1, 3, s36
    s_bcnt1_i32_b64 s37, vcc
    s_add_u32 s27, s27, s37
    s_andn2_b64 s[36:37], exec, vcc
    s_mov_b64 exec, vcc
    ds_write_b64 v1, v[42:43]
    s_mov_b64 exec, s[36:37]
    s_branch B_spb58
B_sp59:
    v_mbcnt_lo_u32_b32 v1, vcc_lo, 0
    v_mbcnt_hi_u32_b32 v1, vcc_hi, v1
    s_lshl_b32 s36, s27, 3
    s_add_u32 s36, s36, s48
    v_lshl_add_u32 v1, v1, 3, s36
    s_bcnt1_i32_b64 s37, vcc
    s_add_u32 s27, s27, s37
    s_andn2_b64 s[36:37], exec, vcc
    s_mov_b64 exec, vcc
    ds_write_b64 v1, v[42:43]
    s_mov_b64 exec, s[36:37]
    s_branch B_spb59
B_sp60:
    v_mbcnt_lo_u32_b32 v1, vcc_lo, 0
    v_mbcnt_hi_u32_b32 v1, vcc_hi, v1
    s_lshl_b32 s36, s27, 3
    s_add_u32 s36, s36, s48
    v_lshl_add_u32 v1, v1, 3, s36
    s_bcnt1_i32_b64 s37, vcc
    s_add_u32 s27, s27, s37
    s_andn2_b64 s[36:37], exec, vcc
    s_mov_b64 exec, vcc
    ds_write_b64 v1, v[44:45]
    s_mov_b64 exec, s[36:37]
    s_branch B_spb60
B_far61:
    s_cmp_ge_u32 s36, s26
    s_cselect_b32 s36, s49, s36
    s_cbranch_scc1 B_farb61
    s_sub_u32 s37, s36, s23
    s_lshr_b32 s37, s37, 5
    s_mov_b32 s38, 44739243
    s_mul_hi_u32 s37, s37, s38
    s_mul_i32 s38, s37, 3072
    s_sub_u32 s36, s36, s38
    s_lshl_b32 s37, s37, 5
    v_mbcnt_lo_u32_b32 v0, -1, 0
    v_mbcnt_hi_u32_b32 v0, -1, v0
    v_and_b32 v0, 15, v0
    v_lshl_add_u32 v0, v0, 1, s37
    v_mov_b32_sdwa v6, v0 dst_sel:WORD_1 dst_unused:UNUSED_PRESERVE src0_sel:WORD_0
    s_branch B_farb61
B_sp62:
    v_mbcnt_lo_u32_b32 v1, vcc_lo, 0
    v_mbcnt_hi_u32_b32 v1, vcc_hi, v1
    s_lshl_b32 s36, s27, 3
    s_add_u32 s36, s36, s48
    v_lshl_add_u32 v1, v1, 3, s36
    s_bcnt1_i32_b64 s37, vcc
    s_add_u32 s27, s27, s37
    s_andn2_b64 s[36:37], exec, vcc
    s_mov_b64 exec, vcc
    ds_write_b64 v1, v[46:47]
    s_mov_b64 exec, s[36:37]
    s_cmp_le_u32 s27, 64
    s_cbranch_scc1 B_spb62
    s_mov_b64 s[30:31], 0
    s_add_u32 s28, s25, 16
    s_branch B_spb62
B_sp63:
    v_mbcnt_lo_u32_b32 v1, vcc_lo, 0
    v_mbcnt_hi_u32_b32 v1, vcc_hi, v1
    s_lshl_b32 s36, s27, 3
    s_add_u32 s36, s36, s48
    v_lshl_add_u32 v1, v1, 3, s36
    s_bcnt1_i32_b64 s37, vcc
    s_add_u32 s27, s27, s37
    s_andn2_b64 s[36:37], exec, vcc
    s_mov_b64 exec, vcc
    ds_write_b64 v1, v[48:49]
    s_mov_b64 exec, s[36:37]
    s_cmp_le_u32 s27, 64
    s_cbranch_scc1 B_spb63
    s_mov_b64 s[30:31], 0
    s_add_u32 s28, s25, 32
    s_branch B_spb63
B_far64:
    s_cmp_ge_u32 s36, s26
    s_cselect_b32 s36, s49, s36
    s_cbranch_scc1 B_farb64
    s_sub_u32 s37, s36, s23
    s_lshr_b32 s37, s37, 5
    s_mov_b32 s38, 44739243
    s_mul_hi_u32 s37, s37, s38
    s_mul_i32 s38, s37, 3072
    s_sub_u32 s36, s36, s38
    s_lshl_b32 s37, s37, 5
    v_mbcnt_lo_u32_b32 v0, -1, 0
    v_mbcnt_hi_u32_b32 v0, -1, v0
    v_and_b32 v0, 15, v0
    v_lshl_add_u32 v0, v0, 1, s37
    v_mov_b32_sdwa v6, v0 dst_sel:WORD_1 dst_unused:UNUSED_PRESERVE src0_sel:WORD_0
    s_branch B_farb64
B_sp65:
    v_mbcnt_lo_u32_b32 v1, vcc_lo, 0
    v_mbcnt_hi_u32_b32 v1, vcc_hi, v1
    s_lshl_b32 s36, s27, 3
    s_add_u32 s36, s36, s48
    v_lshl_add_u32 v1, v1, 3, s36
    s_bcnt1_i32_b64 s37, vcc
    s_add_u32 s27, s27, s37
    s_andn2_b64 s[36:37], exec, vcc
    s_mov_b64 exec, vcc
    ds_write_b64 v1, v[42:43]
    s_mov_b64 exec, s[36:37]
    s_cmp_le_u32 s27, 64
    s_cbranch_scc1 B_spb65
    s_mov_b64 s[30:31], 0
    s_add_u32 s28, s25, 48
    s_branch B_spb65
B_sp66:
    v_mbcnt_lo_u32_b32 v1, vcc_lo, 0
    v_mbcnt_hi_u32_b32 v1, vcc_hi, v1
    s_lshl_b32 s36, s27, 3
    s_add_u32 s36, s36, s48
    v_lshl_add_u32 v1, v1, 3, s36
    s_bcnt1_i32_b64 s37, vcc
    s_add_u32 s27, s27, s37
    s_andn2_b64 s[36:37], exec, vcc
    s_mov_b64 exec, vcc
    ds_write_b64 v1, v[44:45]
    s_mov_b64 exec, s[36:37]
    s_cmp_le_u32 s27, 64
    s_cbranch_scc1 B_spb66
    s_mov_b64 s[30:31], 0
    s_add_u32 s28, s25, 64
    s_branch B_spb66
B_far67:
    s_cmp_ge_u32 s36, s26
    s_cselect_b32 s36, s49, s36
    s_cbranch_scc1 B_farb67
    s_sub_u32 s37, s36, s23
    s_lshr_b32 s37, s37, 5
    s_mov_b32 s38, 44739243
    s_mul_hi_u32 s37, s37, s38
    s_mul_i32 s38, s37, 3072
    s_sub_u32 s36, s36, s38
    s_lshl_b32 s37, s37, 5
    v_mbcnt_lo_u32_b32 v0, -1, 0
    v_mbcnt_hi_u32_b32 v0, -1, v0
    v_and_b32 v0, 15, v0
    v_lshl_add_u32 v0, v0, 1, s37
    v_mov_b32_sdwa v6, v0 dst_sel:WORD_1 dst_unused:UNUSED_PRESERVE src0_sel:WORD_0
    s_branch B_farb67
B_sp68:
    v_mbcnt_lo_u32_b32 v1, vcc_lo, 0
    v_mbcnt_hi_u32_b32 v1, vcc_hi, v1
    s_lshl_b32 s36, s27, 3
    s_add_u32 s36, s36, s48
    v_lshl_add_u32 v1, v1, 3, s36
    s_bcnt1_i32_b64 s37, vcc
    s_add_u32 s27, s27, s37
    s_andn2_b64 s[36:37], exec, vcc
    s_mov_b64 exec, vcc
    ds_write_b64 v1, v[46:47]
    s_mov_b64 exec, s[36:37]
    s_cmp_le_u32 s27, 64
    s_cbranch_scc1 B_spb68
    s_mov_b64 s[30:31], 0
    s_add_u32 s28, s25, 80
    s_branch B_spb68
B_sp69:
    v_mbcnt_lo_u32_b32 v1, vcc_lo, 0
    v_mbcnt_hi_u32_b32 v1, vcc_hi, v1
    s_lshl_b32 s36, s27, 3
    s_add_u32 s36, s36, s48
    v_lshl_add_u32 v1, v1, 3, s36
    s_bcnt1_i32_b64 s37, vcc
    s_add_u32 s27, s27, s37
    s_andn2_b64 s[36:37], exec, vcc
    s_mov_b64 exec, vcc
    ds_write_b64 v1, v[48:49]
    s_mov_b64 exec, s[36:37]
    s_cmp_le_u32 s27, 64
    s_cbranch_scc1 B_spb69
    s_mov_b64 s[30:31], 0
    s_add_u32 s28, s25, 96
    s_branch B_spb69
B_far70:
    s_cmp_ge_u32 s36, s26
    s_cselect_b32 s36, s49, s36
    s_cbranch_scc1 B_farb70
    s_sub_u32 s37, s36, s23
    s_lshr_b32 s37, s37, 5
    s_mov_b32 s38, 44739243
    s_mul_hi_u32 s37, s37, s38
    s_mul_i32 s38, s37, 3072
    s_sub_u32 s36, s36, s38
    s_lshl_b32 s37, s37, 5
    v_mbcnt_lo_u32_b32 v0, -1, 0
    v_mbcnt_hi_u32_b32 v0, -1, v0
    v_and_b32 v0, 15, v0
    v_lshl_add_u32 v0, v0, 1, s37
    v_mov_b32_sdwa v6, v0 dst_sel:WORD_1 dst_unused:UNUSED_PRESERVE src0_sel:WORD_0
    s_branch B_farb70
B_sp71:
    v_mbcnt_lo_u32_b32 v1, vcc_lo, 0
    v_mbcnt_hi_u32_b32 v1, vcc_hi, v1
    s_lshl_b32 s36, s27, 3
    s_add_u32 s36, s36, s48
    v_lshl_add_u32 v1, v1, 3, s36
    s_bcnt1_i32_b64 s37, vcc
    s_add_u32 s27, s27, s37
    s_andn2_b64 s[36:37], exec, vcc
    s_mov_b64 exec, vcc
    ds_write_b64 v1, v[42:43]
    s_mov_b64 exec, s[36:37]
    s_cmp_le_u32 s27, 64
    s_cbranch_scc1 B_spb71
    s_mov_b64 s[30:31], 0
    s_add_u32 s28, s25, 112
    s_branch B_spb71
B_sp72:
    v_mbcnt_lo_u32_b32 v1, vcc_lo, 0
    v_mbcnt_hi_u32_b32 v1, vcc_hi, v1
    s_lshl_b32 s36, s27, 3
    s_add_u32 s36, s36, s48
    v_lshl_add_u32 v1, v1, 3, s36
    s_bcnt1_i32_b64 s37, vcc
    s_add_u32 s27, s27, s37
    s_andn2_b64 s[36:37], exec, vcc
    s_mov_b64 exec, vcc
    ds_write_b64 v1, v[44:45]
    s_mov_b64 exec, s[36:37]
    s_cmp_le_u32 s27, 64
    s_cbranch_scc1 B_spb72
    s_mov_b64 s[30:31], 0
    s_add_u32 s28, s25, 128
    s_branch B_spb72
B_far73:
    s_cmp_ge_u32 s36, s26
    s_cselect_b32 s36, s49, s36
    s_cbranch_scc1 B_farb73
    s_sub_u32 s37, s36, s23
    s_lshr_b32 s37, s37, 5
    s_mov_b32 s38, 44739243
    s_mul_hi_u32 s37, s37, s38
    s_mul_i32 s38, s37, 3072
    s_sub_u32 s36, s36, s38
    s_lshl_b32 s37, s37, 5
    v_mbcnt_lo_u32_b32 v0, -1, 0
    v_mbcnt_hi_u32_b32 v0, -1, v0
    v_and_b32 v0, 15, v0
    v_lshl_add_u32 v0, v0, 1, s37
    v_mov_b32_sdwa v6, v0 dst_sel:WORD_1 dst_unused:UNUSED_PRESERVE src0_sel:WORD_0
    s_branch B_farb73
B_sp74:
    v_mbcnt_lo_u32_b32 v1, vcc_lo, 0
    v_mbcnt_hi_u32_b32 v1, vcc_hi, v1
    s_lshl_b32 s36, s27, 3
    s_add_u32 s36, s36, s48
    v_lshl_add_u32 v1, v1, 3, s36
    s_bcnt1_i32_b64 s37, vcc
    s_add_u32 s27, s27, s37
    s_andn2_b64 s[36:37], exec, vcc
    s_mov_b64 exec, vcc
    ds_write_b64 v1, v[46:47]
    s_mov_b64 exec, s[36:37]
    s_cmp_le_u32 s27, 64
    s_cbranch_scc1 B_spb74
    s_mov_b64 s[30:31], 0
    s_add_u32 s28, s25, 144
    s_branch B_spb74
B_sp75:
    v_mbcnt_lo_u32_b32 v1, vcc_lo, 0
    v_mbcnt_hi_u32_b32 v1, vcc_hi, v1
    s_lshl_b32 s36, s27, 3
    s_add_u32 s36, s36, s48
    v_lshl_add_u32 v1, v1, 3, s36
    s_bcnt1_i32_b64 s37, vcc
    s_add_u32 s27, s27, s37
    s_andn2_b64 s[36:37], exec, vcc
    s_mov_b64 exec, vcc
    ds_write_b64 v1, v[48:49]
    s_mov_b64 exec, s[36:37]
    s_cmp_le_u32 s27, 64
    s_cbranch_scc1 B_spb75
    s_mov_b64 s[30:31], 0
    s_add_u32 s28, s25, 160
    s_branch B_spb75
B_far76:
    s_cmp_ge_u32 s36, s26
    s_cselect_b32 s36, s49, s36
    s_cbranch_scc1 B_farb76
    s_sub_u32 s37, s36, s23
    s_lshr_b32 s37, s37, 5
    s_mov_b32 s38, 44739243
    s_mul_hi_u32 s37, s37, s38
    s_mul_i32 s38, s37, 3072
    s_sub_u32 s36, s36, s38
    s_lshl_b32 s37, s37, 5
    v_mbcnt_lo_u32_b32 v0, -1, 0
    v_mbcnt_hi_u32_b32 v0, -1, v0
    v_and_b32 v0, 15, v0
    v_lshl_add_u32 v0, v0, 1, s37
    v_mov_b32_sdwa v6, v0 dst_sel:WORD_1 dst_unused:UNUSED_PRESERVE src0_sel:WORD_0
    s_branch B_farb76
B_sp77:
    v_mbcnt_lo_u32_b32 v1, vcc_lo, 0
    v_mbcnt_hi_u32_b32 v1, vcc_hi, v1
    s_lshl_b32 s36, s27, 3
    s_add_u32 s36, s36, s48
    v_lshl_add_u32 v1, v1, 3, s36
    s_bcnt1_i32_b64 s37, vcc
    s_add_u32 s27, s27, s37
    s_andn2_b64 s[36:37], exec, vcc
    s_mov_b64 exec, vcc
    ds_write_b64 v1, v[42:43]
    s_mov_b64 exec, s[36:37]
    s_cmp_le_u32 s27, 64
    s_cbranch_scc1 B_spb77
    s_mov_b64 s[30:31], 0
    s_add_u32 s28, s25, 176
    s_branch B_spb77
B_sp78:
    v_mbcnt_lo_u32_b32 v1, vcc_lo, 0
    v_mbcnt_hi_u32_b32 v1, vcc_hi, v1
    s_lshl_b32 s36, s27, 3
    s_add_u32 s36, s36, s48
    v_lshl_add_u32 v1, v1, 3, s36
    s_bcnt1_i32_b64 s37, vcc
    s_add_u32 s27, s27, s37
    s_andn2_b64 s[36:37], exec, vcc
    s_mov_b64 exec, vcc
    ds_write_b64 v1, v[44:45]
    s_mov_b64 exec, s[36:37]
    s_cmp_le_u32 s27, 64
    s_cbranch_scc1 B_spb78
    s_mov_b64 s[30:31], 0
    s_add_u32 s28, s25, 192
    s_branch B_spb78
B_far79:
    s_cmp_ge_u32 s36, s26
    s_cselect_b32 s36, s49, s36
    s_cbranch_scc1 B_farb79
    s_sub_u32 s37, s36, s23
    s_lshr_b32 s37, s37, 5
    s_mov_b32 s38, 44739243
    s_mul_hi_u32 s37, s37, s38
    s_mul_i32 s38, s37, 3072
    s_sub_u32 s36, s36, s38
    s_lshl_b32 s37, s37, 5
    v_mbcnt_lo_u32_b32 v0, -1, 0
    v_mbcnt_hi_u32_b32 v0, -1, v0
    v_and_b32 v0, 15, v0
    v_lshl_add_u32 v0, v0, 1, s37
    v_mov_b32_sdwa v6, v0 dst_sel:WORD_1 dst_unused:UNUSED_PRESERVE src0_sel:WORD_0
    s_branch B_farb79
B_sp80:
    v_mbcnt_lo_u32_b32 v1, vcc_lo, 0
    v_mbcnt_hi_u32_b32 v1, vcc_hi, v1
    s_lshl_b32 s36, s27, 3
    s_add_u32 s36, s36, s48
    v_lshl_add_u32 v1, v1, 3, s36
    s_bcnt1_i32_b64 s37, vcc
    s_add_u32 s27, s27, s37
    s_andn2_b64 s[36:37], exec, vcc
    s_mov_b64 exec, vcc
    ds_write_b64 v1, v[46:47]
    s_mov_b64 exec, s[36:37]
    s_cmp_le_u32 s27, 64
    s_cbranch_scc1 B_spb80
    s_mov_b64 s[30:31], 0
    s_add_u32 s28, s25, 208
    s_branch B_spb80
B_sp81:
    v_mbcnt_lo_u32_b32 v1, vcc_lo, 0
    v_mbcnt_hi_u32_b32 v1, vcc_hi, v1
    s_lshl_b32 s36, s27, 3
    s_add_u32 s36, s36, s48
    v_lshl_add_u32 v1, v1, 3, s36
    s_bcnt1_i32_b64 s37, vcc
    s_add_u32 s27, s27, s37
    s_andn2_b64 s[36:37], exec, vcc
    s_mov_b64 exec, vcc
    ds_write_b64 v1, v[48:49]
    s_mov_b64 exec, s[36:37]
    s_cmp_le_u32 s27, 64
    s_cbranch_scc1 B_spb81
    s_mov_b64 s[30:31], 0
    s_add_u32 s28, s25, 224
    s_branch B_spb81
B_sp82:
    v_mbcnt_lo_u32_b32 v1, vcc_lo, 0
    v_mbcnt_hi_u32_b32 v1, vcc_hi, v1
    s_lshl_b32 s36, s27, 3
    s_add_u32 s36, s36, s48
    v_lshl_add_u32 v1, v1, 3, s36
    s_bcnt1_i32_b64 s37, vcc
    s_add_u32 s27, s27, s37
    s_andn2_b64 s[36:37], exec, vcc
    s_mov_b64 exec, vcc
    ds_write_b64 v1, v[42:43]
    s_mov_b64 exec, s[36:37]
    s_cmp_le_u32 s27, 64
    s_cbranch_scc1 B_spb82
    s_mov_b64 s[30:31], 0
    s_add_u32 s28, s25, 240
    s_branch B_spb82
B_sp83:
    v_mbcnt_lo_u32_b32 v1, vcc_lo, 0
    v_mbcnt_hi_u32_b32 v1, vcc_hi, v1
    s_lshl_b32 s36, s27, 3
    s_add_u32 s36, s36, s48
    v_lshl_add_u32 v1, v1, 3, s36
    s_bcnt1_i32_b64 s37, vcc
    s_add_u32 s27, s27, s37
    s_andn2_b64 s[36:37], exec, vcc
    s_mov_b64 exec, vcc
    ds_write_b64 v1, v[44:45]
    s_mov_b64 exec, s[36:37]
    s_cmp_le_u32 s27, 64
    s_cbranch_scc1 B_spb83
    s_mov_b64 s[30:31], 0
    s_add_u32 s28, s25, 256
    s_branch B_spb83
B_cl84:
    v_mov_b32 v46, s16
    v_mov_b32 v47, 0
    ds_write_b64 v2, v[46:47] offset:51840
    ds_write_b64 v2, v[46:47] offset:52096
    ds_write_b64 v2, v[46:47] offset:52352
    ds_write_b64 v2, v[46:47] offset:52608
    ds_write_b64 v2, v[46:47] offset:52864
    ds_write_b64 v2, v[46:47] offset:53120
    ds_write_b64 v2, v[46:47] offset:53376
    ds_write_b64 v2, v[46:47] offset:53632
    ds_write_b64 v2, v[46:47] offset:53888
    ds_write_b64 v2, v[46:47] offset:54144
    ds_write_b64 v2, v[46:47] offset:54400
    ds_write_b64 v2, v[46:47] offset:54656
    ds_write_b64 v2, v[46:47] offset:54912
    ds_write_b64 v2, v[46:47] offset:55168
    ds_write_b64 v2, v[46:47] offset:55424
    ds_write_b64 v2, v[46:47] offset:55680
    ds_write_b64 v2, v[46:47] offset:55936
    ds_write_b64 v2, v[46:47] offset:56192
    ds_write_b64 v2, v[46:47] offset:56448
    ds_write_b64 v2, v[46:47] offset:56704
    ds_write_b64 v2, v[46:47] offset:56960
    ds_write_b64 v2, v[46:47] offset:57216
    ds_write_b64 v2, v[46:47] offset:57472
    ds_write_b64 v2, v[46:47] offset:57728
    s_cmp_lg_u32 s50, 0
    s_cbranch_scc1 B_clb84
    ds_write_b64 v2, v[46:47] offset:57984
    s_branch B_clb84
B_sy86:
    v_mov_b32 v0, 0
    ds_read_b32 v50, v0 offset:1604
    s_waitcnt lgkmcnt(0)
    v_readfirstlane_b32 s36, v50
    s_cmp_lt_u32 s36, s72
    s_cbranch_scc1 B_sy86
    s_branch B_syb86
B_st85:
    s_and_b32 s25, s28, 0xffffffe0
    s_bitcmp1_b32 s28, 4
    s_cselect_b64 s[32:33], -1, 0
    s_mov_b64 s[30:31], -1
    v_mbcnt_lo_u32_b32 v0, -1, 0
    v_mbcnt_hi_u32_b32 v0, -1, v0
    v_and_b32 v0, 15, v0
    v_lshl_add_u32 v0, v0, 1, 0
    v_mov_b32_sdwa v6, v0 dst_sel:WORD_1 dst_unused:UNUSED_PRESERVE src0_sel:WORD_0
    s_branch B_stb85
B_cl87:
    v_mov_b32 v46, s16
    v_mov_b32 v47, 0
    ds_write_b64 v2, v[46:47] offset:1664
    ds_write_b64 v2, v[46:47] offset:1920
    ds_write_b64 v2, v[46:47] offset:2176
    ds_write_b64 v2, v[46:47] offset:2432
    ds_write_b64 v2, v[46:47] offset:2688
    ds_write_b64 v2, v[46:47] offset:2944
    ds_write_b64 v2, v[46:47] offset:3200
    ds_write_b64 v2, v[46:47] offset:3456
    ds_write_b64 v2, v[46:47] offset:3712
    ds_write_b64 v2, v[46:47] offset:3968
    ds_write_b64 v2, v[46:47] offset:4224
    ds_write_b64 v2, v[46:47] offset:4480
    ds_write_b64 v2, v[46:47] offset:4736
    ds_write_b64 v2, v[46:47] offset:4992
    ds_write_b64 v2, v[46:47] offset:5248
    ds_write_b64 v2, v[46:47] offset:5504
    ds_write_b64 v2, v[46:47] offset:5760
    ds_write_b64 v2, v[46:47] offset:6016
    ds_write_b64 v2, v[46:47] offset:6272
    ds_write_b64 v2, v[46:47] offset:6528
    ds_write_b64 v2, v[46:47] offset:6784
    ds_write_b64 v2, v[46:47] offset:7040
    ds_write_b64 v2, v[46:47] offset:7296
    ds_write_b64 v2, v[46:47] offset:7552
    s_cmp_lg_u32 s50, 0
    s_cbranch_scc1 B_clb87
    ds_write_b64 v2, v[46:47] offset:7808
    s_branch B_clb87
B_sy89:
    v_mov_b32 v0, 0
    ds_read_b32 v50, v0 offset:1604
    s_waitcnt lgkmcnt(0)
    v_readfirstlane_b32 s36, v50
    s_cmp_lt_u32 s36, s72
    s_cbranch_scc1 B_sy89
    s_branch B_syb89
B_ra25:
    v_mbcnt_lo_u32_b32 v0, -1, 0
    v_mbcnt_hi_u32_b32 v0, -1, v0
    s_cmp_gt_u32 s27, 64
    v_lshl_add_u32 v1, v0, 3, s48
    v_cmp_gt_u32 s[44:45], s27, v0
    ds_read_b64 v[42:43], v1
    s_cbranch_scc1 B_rw25
    s_mov_b32 s27, 0
    s_waitcnt lgkmcnt(0)
    v_mov_b32 v51, 65544
    s_mov_b64 exec, s[44:45]
    v_lshlrev_b32_sdwa v0, 2, v42 dst_sel:DWORD dst_unused:UNUSED_PAD src0_sel:DWORD src1_sel:BYTE_0
    ds_add_rtn_u32 v50, v0, v51 offset:800
    s_mov_b64 exec, -1
    s_waitcnt lgkmcnt(0)
    s_mov_b64 exec, s[44:45]
    v_lshlrev_b32_sdwa v0, 8, v42 dst_sel:DWORD dst_unused:UNUSED_PAD src0_sel:DWORD src1_sel:BYTE_0
    v_cmp_le_u32 vcc, s19, v50
    v_and_or_b32 v0, v50, s20, v0
    s_cbranch_vccnz B_sp26
B_spb26:
    v_mov_b32_sdwa v42, s21 dst_sel:BYTE_0 dst_unused:UNUSED_PRESERVE src0_sel:BYTE_0
    ds_write_b64 v0, v[42:43] offset:51840
    s_mov_b64 exec, -1
    s_branch B_rab25
B_rw25:
    ds_read_b64 v[44:45], v1 offset:512
    v_add_u32 v0, 64, v0
    v_cmp_gt_u32 s[46:47], s27, v0
    s_mov_b32 s27, 0
    s_waitcnt lgkmcnt(0)
    v_mov_b32 v51, 65544
    s_mov_b64 exec, s[44:45]
    v_lshlrev_b32_sdwa v0, 2, v42 dst_sel:DWORD dst_unused:UNUSED_PAD src0_sel:DWORD src1_sel:BYTE_0
    ds_add_rtn_u32 v50, v0, v51 offset:800
    s_mov_b64 exec, s[46:47]
    v_lshlrev_b32_sdwa v0, 2, v44 dst_sel:DWORD dst_unused:UNUSED_PAD src0_sel:DWORD src1_sel:BYTE_0
    ds_add_rtn_u32 v51, v0, v51 offset:800
    s_mov_b64 exec, -1
    s_waitcnt lgkmcnt(0)
    s_mov_b64 exec, s[44:45]
    v_lshlrev_b32_sdwa v0, 8, v42 dst_sel:DWORD dst_unused:UNUSED_PAD src0_sel:DWORD src1_sel:BYTE_0
    v_cmp_le_u32 vcc, s19, v50
    v_and_or_b32 v0, v50, s20, v0
    s_cbranch_vccnz B_sp27
B_spb27:
    v_mov_b32_sdwa v42, s21 dst_sel:BYTE_0 dst_unused:UNUSED_PRESERVE src0_sel:BYTE_0
    ds_write_b64 v0, v[42:43] offset:51840
    s_mov_b64 exec, s[46:47]
    v_lshlrev_b32_sdwa v0, 8, v44 dst_sel:DWORD dst_unused:UNUSED_PAD src0_sel:DWORD src1_sel:BYTE_0
    v_cmp_le_u32 vcc, s19, v51
    v_and_or_b32 v0, v51, s20, v0
    s_cbranch_vccnz B_sp28
B_spb28:
    v_mov_b32_sdwa v44, s21 dst_sel:BYTE_0 dst_unused:UNUSED_PRESERVE src0_sel:BYTE_0
    ds_write_b64 v0, v[44:45] offset:51840
    s_mov_b64 exec, -1
    s_cmp_le_u32 s27, 64
    s_cbranch_scc1 B_rab25
    s_mov_b64 s[30:31], 0
    s_and_b32 s36, s32, 16
    s_add_u32 s28, s25, s36
    s_branch B_rab25
B_ra57:
    v_mbcnt_lo_u32_b32 v0, -1, 0
    v_mbcnt_hi_u32_b32 v0, -1, v0
    s_cmp_gt_u32 s27, 64
    v_lshl_add_u32 v1, v0, 3, s48
    v_cmp_gt_u32 s[44:45], s27, v0
    ds_read_b64 v[42:43], v1
    s_cbranch_scc1 B_rw57
    s_mov_b32 s27, 0
    s_waitcnt lgkmcnt(0)
    v_mov_b32 v51, 65544
    s_mov_b64 exec, s[44:45]
    v_lshlrev_b32_sdwa v0, 2, v42 dst_sel:DWORD dst_unused:UNUSED_PAD src0_sel:DWORD src1_sel:BYTE_0
    ds_add_rtn_u32 v50, v0, v51 offset:0
    s_mov_b64 exec, -1
    s_waitcnt lgkmcnt(0)
    s_mov_b64 exec, s[44:45]
    v_lshlrev_b32_sdwa v0, 8, v42 dst_sel:DWORD dst_unused:UNUSED_PAD src0_sel:DWORD src1_sel:BYTE_0
    v_cmp_le_u32 vcc, s19, v50
    v_and_or_b32 v0, v50, s20, v0
    s_cbranch_vccnz B_sp58
B_spb58:
    v_mov_b32_sdwa v42, s21 dst_sel:BYTE_0 dst_unused:UNUSED_PRESERVE src0_sel:BYTE_0
    ds_write_b64 v0, v[42:43] offset:1664
    s_mov_b64 exec, -1
    s_branch B_rab57
B_rw57:
    ds_read_b64 v[44:45], v1 offset:512
    v_add_u32 v0, 64, v0
    v_cmp_gt_u32 s[46:47], s27, v0
    s_mov_b32 s27, 0
    s_waitcnt lgkmcnt(0)
    v_mov_b32 v51, 65544
    s_mov_b64 exec, s[44:45]
    v_lshlrev_b32_sdwa v0, 2, v42 dst_sel:DWORD dst_unused:UNUSED_PAD src0_sel:DWORD src1_sel:BYTE_0
    ds_add_rtn_u32 v50, v0, v51 offset:0
    s_mov_b64 exec, s[46:47]
    v_lshlrev_b32_sdwa v0, 2, v44 dst_sel:DWORD dst_unused:UNUSED_PAD src0_sel:DWORD src1_sel:BYTE_0
    ds_add_rtn_u32 v51, v0, v51 offset:0
    s_mov_b64 exec, -1
    s_waitcnt lgkmcnt(0)
    s_mov_b64 exec, s[44:45]
    v_lshlrev_b32_sdwa v0, 8, v42 dst_sel:DWORD dst_unused:UNUSED_PAD src0_sel:DWORD src1_sel:BYTE_0
    v_cmp_le_u32 vcc, s19, v50
    v_and_or_b32 v0, v50, s20, v0
    s_cbranch_vccnz B_sp59
B_spb59:
    v_mov_b32_sdwa v42, s21 dst_sel:BYTE_0 dst_unused:UNUSED_PRESERVE src0_sel:BYTE_0
    ds_write_b64 v0, v[42:43] offset:1664
    s_mov_b64 exec, s[46:47]
    v_lshlrev_b32_sdwa v0, 8, v44 dst_sel:DWORD dst_unused:UNUSED_PAD src0_sel:DWORD src1_sel:BYTE_0
    v_cmp_le_u32 vcc, s19, v51
    v_and_or_b32 v0, v51, s20, v0
    s_cbranch_vccnz B_sp60
B_spb60:
    v_mov_b32_sdwa v44, s21 dst_sel:BYTE_0 dst_unused:UNUSED_PRESERVE src0_sel:BYTE_0
    ds_write_b64 v0, v[44:45] offset:1664
    s_mov_b64 exec, -1
    s_cmp_le_u32 s27, 64
    s_cbranch_scc1 B_rab57
    s_mov_b64 s[30:31], 0
    s_and_b32 s36, s32, 16
    s_add_u32 s28, s25, s36
    s_branch B_rab57
.section .rodata,"a"
.p2align 6
.amdhsa_kernel agg_kernel
  .amdhsa_next_free_vgpr 256
  .amdhsa_next_free_sgpr 102
  .amdhsa_accum_offset 256
  .amdhsa_group_segment_fixed_size 0
  .amdhsa_kernarg_size 112
  .amdhsa_user_sgpr_count 2
  .amdhsa_user_sgpr_kernarg_segment_ptr 1
  .amdhsa_system_sgpr_workgroup_id_x 1
.end_amdhsa_kernel
.text
```
